```python
import torch

def _softmax(x, axis=-1):
    return torch.softmax(x, dim=axis)
def _gelu(x):
    return torch.nn.functional.gelu(x, approximate="tanh")
def _silu(x):
    return torch.nn.functional.silu(x)
def _sigmoid(x):
    return torch.sigmoid(x)
def _layernorm(x, axis=-1, eps=1e-5):
    m = x.mean(dim=axis, keepdim=True)
    v = x.var(dim=axis, keepdim=True, unbiased=False)
    return (x - m) / torch.sqrt(v + eps)
def _scatter_add(tgt, idx, src, axis=0):
    return tgt.clone().index_add_(axis, idx, src)
def _segment_sum(src, seg, n):
    out = torch.zeros((n,) + src.shape[1:], dtype=src.dtype)
    return out.index_add_(0, seg, src)
def _pad(x, pw):
    flat = tuple(v for pair in reversed(pw) for v in pair)
    return torch.nn.functional.pad(x, flat)

kernel_name = 'sequential_preLN__ssm_conv_s4__geglu_ffn__prompt'

def setup_inputs():

    _w = (lambda a: (lambda t: t.to(torch.bfloat16) if t.is_floating_point() else t)(torch.as_tensor(a)))
    def _A_setup():
        B, L, D, N = 1, 2048, 640, 192
        A_re = -(lambda _x: torch.exp(torch.as_tensor(_x)))((lambda *s: torch.randn(*s, dtype=torch.bfloat16) * 6.4)(D, N))
        A_im = torch.pi * (lambda *s: torch.randn(*s, dtype=torch.bfloat16) * 0.05)(D, N)
        B_re = (lambda *s: torch.randn(*s, dtype=torch.bfloat16) * 0.05)(D, N)
        B_im = (lambda *s: torch.randn(*s, dtype=torch.bfloat16) * 0.05)(D, N)
        C_re = (lambda *s: torch.randn(*s, dtype=torch.bfloat16) * 0.05)(D, N)
        C_im = (lambda *s: torch.randn(*s, dtype=torch.bfloat16) * 0.05)(D, N)
        log_dt = (lambda *s: torch.randn(*s, dtype=torch.bfloat16) * 0.05)(D) * 0.5 - 4.0
        Dskip = (lambda *s: torch.randn(*s, dtype=torch.bfloat16) * 0.05)(D)
        return {
            "u": _w((lambda *s: torch.randn(*s, dtype=torch.bfloat16) * 0.05)(B, L, D)),
            "A_re": _w(A_re),
            "A_im": _w(A_im),
            "B_re": _w(B_re),
            "B_im": _w(B_im),
            "C_re": _w(C_re),
            "C_im": _w(C_im),
            "log_dt": _w(log_dt),
            "Dskip": _w(Dskip),
        }
    _A_in = _A_setup()

    def _B_setup():
        B, S, D, F = 1, 2048, 640, 1536
        return {
            "x": _w((lambda *s: torch.randn(*s, dtype=torch.bfloat16) * 0.05)(B, S, D)),
            "w_gate": _w((lambda *s: torch.randn(*s, dtype=torch.bfloat16) * 0.05)(D, F)),
            "w_up": _w((lambda *s: torch.randn(*s, dtype=torch.bfloat16) * 0.05)(D, F)),
            "w_down": _w((lambda *s: torch.randn(*s, dtype=torch.bfloat16) * 0.05)(F, D)),
        }
    _B_in = _B_setup()

    return {
        "A_u": _A_in["u"],
        "A_A_re": _A_in["A_re"],
        "A_A_im": _A_in["A_im"],
        "A_B_re": _A_in["B_re"],
        "A_B_im": _A_in["B_im"],
        "A_C_re": _A_in["C_re"],
        "A_C_im": _A_in["C_im"],
        "A_log_dt": _A_in["log_dt"],
        "A_Dskip": _A_in["Dskip"],
        "B_x": _B_in["x"],
        "B_w_gate": _B_in["w_gate"],
        "B_w_up": _B_in["w_up"],
        "B_w_down": _B_in["w_down"],
    }

def reference(A_u, A_A_re, A_A_im, A_B_re, A_B_im, A_C_re, A_C_im, A_log_dt, A_Dskip, B_x, B_w_gate, B_w_up, B_w_down):
    def _A_ref(u, A_re, A_im, B_re, B_im, C_re, C_im, log_dt, Dskip):
        Bsz, L, D = u.shape
        dt = torch.exp(log_dt)[:, None]
        A = A_re + 1j * A_im
        Bc = B_re + 1j * B_im
        Cc = C_re + 1j * C_im
        logdA = dt * A
        dB = dt * Bc
        l = (lambda x, dt: x.to(dt))(torch.arange(L), A_re.dtype)
        P = torch.exp(logdA[:, :, None] * l[None, None, :])
        K = torch.einsum("dn,dnl,dn->dl", Cc, P, dB).real
        L2 = 2 * L
        Kp = _pad(K, ((0, 0), (0, L)))
        up = (lambda x, *d: x.permute(*d))(u, 0, 2, 1)
        up = _pad(up, ((0, 0), (0, 0), (0, L)))
        Kf = (lambda x, axes=(-2,-1): torch.fft.rfft2(x.float(), dim=axes))(Kp[:, None, :], axes=(-2, -1))
        Uf = (lambda x, axes=(-2,-1): torch.fft.rfft2(x.float(), dim=axes))(up[:, :, None, :], axes=(-2, -1))
        Yf = Uf * Kf[None, :, :, :]
        y = (lambda x, s, axes=(-2,-1): torch.fft.irfft2(x, s=s, dim=axes).to(torch.bfloat16))(Yf, (1, L2), axes=(-2, -1))[:, :, 0, :L]
        y = (lambda x, *d: x.permute(*d))(y, 0, 2, 1) + u * Dskip[None, None, :]
        return y

    def _B_ref(x, w_gate, w_up, w_down):
        return (_gelu(x @ w_gate) * (x @ w_up)) @ w_down

    x = A_u
    h = x + _A_ref(_layernorm(x, axis=-1), A_A_re, A_A_im, A_B_re, A_B_im, A_C_re, A_C_im, A_log_dt, A_Dskip)
    h2 = h + _B_ref(_layernorm(h, axis=-1), B_w_gate, B_w_up, B_w_down)
    return h2
```

```asm
; @launch grid=(256,1,1) block=(256,1,1) lds=163840
.amdgcn_target "amdgcn-amd-amdhsa--gfx950"
.text
.p2align 12
.globl sequential_preLN__ssm_conv_s4__geglu_ffn__prompt_kernel
.p2align 8
.type sequential_preLN__ssm_conv_s4__geglu_ffn__prompt_kernel,@function
sequential_preLN__ssm_conv_s4__geglu_ffn__prompt_kernel:
    s_cmp_ge_u32 s2, 256
    s_cbranch_scc1 L_end
    s_load_dwordx16 s[4:19], s[0:1], 0
    s_load_dwordx16 s[20:35], s[0:1], 64
    s_getpc_b64 s[46:47]
L_pc:
    v_and_b32 v1, 63, v0
    v_lshrrev_b32 v2, 6, v0
    s_lshr_b32 s38, s2, 3
    v_readfirstlane_b32 s36, v2
    s_mul_i32 s48, s38, 14
    v_min_u32 v3, 13, v0
    v_add_u32 v3, s48, v3
    v_lshlrev_b32 v3, 7, v3
    v_min_u32 v3, L_code_end-sequential_preLN__ssm_conv_s4__geglu_ffn__prompt_kernel-64, v3
    global_load_dword v4, v3, s[46:47]
    s_and_b32 s37, s2, 7
    v_lshrrev_b32 v5, 5, v0
    v_and_b32 v6, 31, v0
    s_lshl_b32 s48, s2, 3
    v_add_u32 v7, s48, v5
    v_mul_u32_u24 v7, 1280, v7
    v_lshl_add_u32 v2, v6, 2, v7
    v_lshl_add_u32 v7, v6, 4, v7
    s_waitcnt lgkmcnt(0)
    global_load_dwordx4 v[10:13], v7, s[4:5]
    global_load_dwordx4 v[14:17], v7, s[4:5] offset:512
    global_load_dword v18, v2, s[4:5] offset:1024
    global_load_dword v19, v2, s[4:5] offset:1152
    s_mov_b32 s40, s34
    s_mov_b32 s41, s35
    s_mov_b32 s42, 25165824
    s_mov_b32 s43, 0x20000
    v_mov_b32 v138, 0
    s_cmp_ge_u32 s38, 20
    s_cbranch_scc1 L_helper
    s_mul_i32 s50, s37, 80
    s_lshl2_add_u32 s50, s38, s50
    s_add_u32 s50, s50, s36
    s_mul_i32 s48, s50, 384
    v_lshl_add_u32 v34, v1, 2, s48
    v_lshl_add_u32 v35, v1, 1, s48
    s_lshl_b32 s48, s50, 1
    v_mov_b32 v36, s48
    global_load_ushort v32, v36, s[18:19]
    global_load_dword v20, v34, s[6:7]
    global_load_dword v21, v34, s[8:9]
    global_load_dword v22, v34, s[10:11]
    global_load_dword v23, v34, s[12:13]
    global_load_dword v24, v34, s[14:15]
    global_load_dword v25, v34, s[16:17]
    global_load_ushort v26, v35, s[6:7] offset:256
    global_load_ushort v27, v35, s[8:9] offset:256
    global_load_ushort v28, v35, s[10:11] offset:256
    global_load_ushort v29, v35, s[12:13] offset:256
    global_load_ushort v30, v35, s[14:15] offset:256
    global_load_ushort v31, v35, s[16:17] offset:256
    global_load_ushort v33, v36, s[20:21]
    buffer_load_dword v179, v138, s[40:43], 0 offen sc1
    v_mul_u32_u24 v141, 1344, v5
    v_add_u32 v141, 123904, v141
    v_lshl_add_u32 v140, v6, 2, v141
    v_add_u32 v140, 1024, v140
    v_lshl_add_u32 v141, v6, 4, v141
    v_and_b32 v143, 3, v5
    v_mul_u32_u24 v143, 2688, v143
    v_add_u32 v143, 125184, v143
    v_mov_b32 v2, 0
    v_mov_b32 v3, 0
    ds_write_b64 v143, v[2:3]
    v_lshrrev_b32 v139, 2, v5
    v_lshl_add_u32 v143, v139, 1, v143
    v_bfe_u32 v142, v1, 2, 2
    v_mul_u32_u24 v142, 1344, v142
    v_lshrrev_b32 v139, 4, v1
    v_lshl_add_u32 v142, v139, 5, v142
    v_and_b32 v139, 3, v1
    v_lshl_add_u32 v142, v139, 3, v142
    s_lshl_b32 s48, s36, 7
    s_add_u32 s48, s48, 123904
    v_add_u32 v142, s48, v142
    s_lshr_b32 s51, s2, 2
    s_and_b32 s48, s51, 7
    s_lshl_b32 s49, s2, 1
    s_and_b32 s49, s49, 4
    s_xor_b32 s48, s48, s49
    v_xor_b32 v139, s48, v139
    v_lshrrev_b32 v8, 2, v1
    v_lshlrev_b32 v8, 8, v8
    v_lshl_add_u32 v8, v139, 4, v8
    v_cmp_gt_u32 vcc, 132, v0
    v_mov_b32 v37, 0x40000000
    s_mul_i32 s51, s51, 41216
    s_and_b32 s48, s2, 1
    v_cndmask_b32 v37, v37, v8, vcc
    s_lshl_b32 s48, s48, 7
    s_add_u32 s51, s51, s48
    s_lshl_b32 s48, s36, 12
    s_add_u32 s51, s51, s48
    s_add_u32 s51, s51, 1048576
    s_add_u32 s52, s51, 16384
    s_add_u32 s53, s51, 32768
    s_mov_b32 s54, 0x3f803f80
    s_lshl_b32 s48, s2, 6
    v_lshrrev_b32 v174, 3, v1
    v_lshl_add_u32 v174, v174, 15, s48
    v_and_b32 v175, 7, v1
    v_lshl_add_u32 v174, v175, 3, v174
    s_min_u32 s48, s36, 1
    s_lshl_b32 s48, s48, 30
    v_add_u32 v177, s48, v174
    s_mul_i32 s48, s36, 327680
    s_add_u32 s48, s48, 4194304
    buffer_store_dwordx2 v[2:3], v174, s[40:43], s48 offen sc1
    s_mov_b32 s48, 5505024
    buffer_store_dwordx2 v[2:3], v177, s[40:43], s48 offen sc1
    s_mul_i32 s70, s36, 21760
    v_lshlrev_b32 v252, 4, v1
    v_add_u32 v254, L_table-L_pc+4096, v252
    v_add_u32 v255, 8192, v254
    v_mov_b32 v190, 0
    v_mov_b32 v191, 0
    v_mov_b32 v192, 0
    v_mov_b32 v193, 0
    v_lshlrev_b32 v186, 4, v0
    v_add_u32 v187, s70, v252
    v_mov_b32 v188, 0x3f80
    s_mov_b32 m0, s70
    ds_write_b128 v186, v[190:193] offset:0
    ds_write_b128 v187, v[190:193] offset:51824
    ds_write_b128 v187, v[190:193] offset:54656
    ds_write_b128 v187, v[190:193] offset:57488
    ds_write_b128 v187, v[190:193] offset:57600
    ds_write_addtid_b32 v188 offset:36864
    s_lshl_b32 s59, s36, 12
L_padA_0:
L_padA_1:
L_padA_2:
L_padA_3:
L_backA:
L_walkedA_0:
    s_mov_b64 exec, 0
    s_mov_b32 s1, 0
    s_cmp_eq_u32 s36, 0
    s_cbranch_scc1 L_padB_0
    s_cmp_eq_u32 s36, 1
    s_cbranch_scc1 L_padB_1
    s_cmp_eq_u32 s36, 2
    s_cbranch_scc1 L_padB_2
    s_branch L_padB_3
L_backB:
L_walkedB_0:
    s_cmp_eq_u32 s1, 1
    s_cbranch_scc1 L_walkedB_1
    s_mov_b64 exec, -1
    global_load_dwordx4 v[224:227], v254, s[46:47] offset:2048
    global_load_dwordx4 v[208:211], v254, s[46:47] offset:-2048
    global_load_dwordx4 v[232:235], v255, s[46:47] offset:-4096
    s_waitcnt vmcnt(23)
    v_dot2c_f32_bf16 v2, s54, v10
    v_dot2c_f32_bf16 v3, v10, v10
    v_dot2c_f32_bf16 v2, s54, v11
    v_dot2c_f32_bf16 v3, v11, v11
    v_dot2c_f32_bf16 v2, s54, v12
    v_dot2c_f32_bf16 v3, v12, v12
    v_dot2c_f32_bf16 v2, s54, v13
    v_dot2c_f32_bf16 v3, v13, v13
    s_waitcnt vmcnt(22)
    v_dot2c_f32_bf16 v2, s54, v14
    v_dot2c_f32_bf16 v3, v14, v14
    v_dot2c_f32_bf16 v2, s54, v15
    v_dot2c_f32_bf16 v3, v15, v15
    v_dot2c_f32_bf16 v2, s54, v16
    v_dot2c_f32_bf16 v3, v16, v16
    v_dot2c_f32_bf16 v2, s54, v17
    v_dot2c_f32_bf16 v3, v17, v17
    s_waitcnt vmcnt(21)
    v_dot2c_f32_bf16 v2, s54, v18
    v_dot2c_f32_bf16 v3, v18, v18
    s_waitcnt vmcnt(20)
    v_dot2c_f32_bf16 v2, s54, v19
    v_dot2c_f32_bf16 v3, v19, v19
    v_and_b32 v99, 0xffff0000, v19
    v_and_b32 v97, 0xffff0000, v18
    v_and_b32 v95, 0xffff0000, v17
    v_add_f32_dpp v2, v2, v2 quad_perm:[1,0,3,2] row_mask:0xf bank_mask:0xf
    v_add_f32_dpp v3, v3, v3 quad_perm:[1,0,3,2] row_mask:0xf bank_mask:0xf
    v_and_b32 v93, 0xffff0000, v16
    v_add_f32_dpp v2, v2, v2 quad_perm:[2,3,0,1] row_mask:0xf bank_mask:0xf
    v_add_f32_dpp v3, v3, v3 quad_perm:[2,3,0,1] row_mask:0xf bank_mask:0xf
    v_and_b32 v91, 0xffff0000, v15
    v_add_f32_dpp v2, v2, v2 row_half_mirror row_mask:0xf bank_mask:0xf
    v_add_f32_dpp v3, v3, v3 row_half_mirror row_mask:0xf bank_mask:0xf
    v_and_b32 v89, 0xffff0000, v14
    v_add_f32_dpp v2, v2, v2 row_mirror row_mask:0xf bank_mask:0xf
    v_add_f32_dpp v3, v3, v3 row_mirror row_mask:0xf bank_mask:0xf
    v_and_b32 v87, 0xffff0000, v13
    v_mov_b32 v4, v2
    v_mov_b32 v5, v3
    v_and_b32 v85, 0xffff0000, v12
    v_and_b32 v83, 0xffff0000, v11
    v_permlane16_swap_b32 v4, v2
    v_permlane16_swap_b32 v5, v3
    v_add_f32 v2, v2, v4
    v_add_f32 v3, v3, v5
    v_mul_f32 v2, 0x3acccccd, v2
    v_mul_f32 v3, 0x3acccccd, v3
    v_fma_f32 v3, -v2, v2, v3
    v_max_f32 v3, 0, v3
    v_cvt_pk_bf16_f32 v2, v2, v3
    v_and_b32 v3, 0xffff0000, v2
    v_add_f32 v3, 0x3727c5ac, v3
    v_cvt_pk_bf16_f32 v3, v3, v3
    v_lshlrev_b32 v3, 16, v3
    v_sqrt_f32 v3, v3
    v_lshlrev_b32 v2, 16, v2
    v_cvt_pk_bf16_f32 v3, v3, v3
    v_lshlrev_b32 v3, 16, v3
    v_rcp_f32 v4, v3
    v_lshlrev_b32 v80, 16, v10
    v_lshlrev_b32 v82, 16, v11
    v_lshlrev_b32 v84, 16, v12
    v_lshlrev_b32 v86, 16, v13
    v_lshlrev_b32 v88, 16, v14
    v_lshlrev_b32 v90, 16, v15
    v_lshlrev_b32 v92, 16, v16
    v_lshlrev_b32 v94, 16, v17
    v_lshlrev_b32 v96, 16, v18
    v_lshlrev_b32 v98, 16, v19
    v_and_b32 v81, 0xffff0000, v10
    v_mul_f32_e64 v6, -v2, v4
    s_nop 0
    v_pk_fma_f32 v[80:81], v[80:81], v[4:5], v[6:7] op_sel_hi:[1,0,0]
    v_pk_fma_f32 v[82:83], v[82:83], v[4:5], v[6:7] op_sel_hi:[1,0,0]
    v_pk_fma_f32 v[84:85], v[84:85], v[4:5], v[6:7] op_sel_hi:[1,0,0]
    v_pk_fma_f32 v[86:87], v[86:87], v[4:5], v[6:7] op_sel_hi:[1,0,0]
    v_pk_fma_f32 v[88:89], v[88:89], v[4:5], v[6:7] op_sel_hi:[1,0,0]
    v_pk_fma_f32 v[90:91], v[90:91], v[4:5], v[6:7] op_sel_hi:[1,0,0]
    v_pk_fma_f32 v[92:93], v[92:93], v[4:5], v[6:7] op_sel_hi:[1,0,0]
    v_pk_fma_f32 v[94:95], v[94:95], v[4:5], v[6:7] op_sel_hi:[1,0,0]
    v_pk_fma_f32 v[96:97], v[96:97], v[4:5], v[6:7] op_sel_hi:[1,0,0]
    v_pk_fma_f32 v[98:99], v[98:99], v[4:5], v[6:7] op_sel_hi:[1,0,0]
    v_cvt_pk_bf16_f32 v128, v80, v81
    v_cvt_pk_bf16_f32 v129, v82, v83
    v_cvt_pk_bf16_f32 v130, v84, v85
    v_cvt_pk_bf16_f32 v131, v86, v87
    v_cvt_pk_bf16_f32 v132, v88, v89
    v_cvt_pk_bf16_f32 v133, v90, v91
    v_cvt_pk_bf16_f32 v134, v92, v93
    v_cvt_pk_bf16_f32 v135, v94, v95
    v_cvt_pk_bf16_f32 v136, v96, v97
    v_cvt_pk_bf16_f32 v137, v98, v99
    ds_write_b128 v141, v[128:131]
    ds_write_b128 v141, v[132:135] offset:512
    ds_write2_b32 v140, v136, v137 offset1:32
    ds_write_b16_d16_hi v143, v3 offset:1344
    ds_write_b16_d16_hi v143, v2 offset:1348
    s_waitcnt lgkmcnt(0)
    s_barrier
    ds_read_b64_tr_b16 v[100:101], v142 offset:0
    ds_read_b64_tr_b16 v[102:103], v142 offset:5376
    ds_read_b64_tr_b16 v[104:105], v142 offset:512
    ds_read_b64_tr_b16 v[106:107], v142 offset:5888
    ds_read_b64_tr_b16 v[108:109], v142 offset:1024
    ds_read_b64_tr_b16 v[110:111], v142 offset:6400
    s_waitcnt lgkmcnt(4)
    buffer_store_dwordx4 v[100:103], v8, s[40:43], s51 offen sc1
    s_waitcnt lgkmcnt(2)
    buffer_store_dwordx4 v[104:107], v8, s[40:43], s52 offen sc1
    s_waitcnt lgkmcnt(0)
    buffer_store_dwordx4 v[108:111], v37, s[40:43], s53 offen sc1
    s_waitcnt vmcnt(22)
    v_lshlrev_b32 v32, 16, v32
    v_mul_f32 v32, 0x3fb8aa3b, v32
    v_exp_f32 v32, v32
    s_waitcnt vmcnt(9)
    v_lshlrev_b32 v196, 16, v33
    v_cvt_pk_bf16_f32 v32, v32, v32
    v_lshlrev_b32 v32, 16, v32
    v_mul_f32 v34, 0x3fb8aa3b, v32
    v_mul_f32 v35, 0.15915494, v32
    v_readfirstlane_b32 s58, v32
    v_readfirstlane_b32 s56, v34
    v_readfirstlane_b32 s57, v35
    s_mov_b32 s55, s70
    v_lshlrev_b32 v146, 16, v20
    v_lshlrev_b32 v147, 16, v21
    v_lshlrev_b32 v148, 16, v22
    v_lshlrev_b32 v149, 16, v23
    v_lshlrev_b32 v150, 16, v24
    v_lshlrev_b32 v151, 16, v25
    v_mul_f32 v146, s56, v146
    v_mul_f32 v147, s57, v147
    v_mul_f32 v148, s58, v148
    v_mul_f32 v149, s58, v149
    v_mul_f32 v152, 0x41000000, v146
    v_mul_f32 v153, 0xc1000000, v147
    v_mul_f32 v154, 0x43800000, v146
    v_mul_f32 v155, 0x43800000, v147
    v_fract_f32 v147, v147
    v_fract_f32 v153, v153
    v_fract_f32 v155, v155
    v_exp_f32 v146, v146
    v_mul_f32 v44, v150, v148
    v_cos_f32 v38, v147
    v_mul_f32 v45, v150, v149
    v_sin_f32 v39, v147
    v_fma_f32 v44, -v151, v149, v44
    v_exp_f32 v152, v152
    v_fmac_f32 v45, v151, v148
    v_cos_f32 v40, v153
    v_mul_f32 v38, v146, v38
    v_sin_f32 v41, v153
    v_mul_f32 v39, v146, v39
    v_exp_f32 v154, v154
    v_mul_f32 v40, v152, v40
    v_cos_f32 v42, v155
    v_mul_f32 v41, v152, v41
    v_sin_f32 v43, v155
    v_mul_f32 v42, v154, v42
    v_mul_f32_e64 v43, v154, v43
    v_pk_mul_f32 v[60:61], v[40:41], v[40:41] op_sel:[1,1] op_sel_hi:[1,0] neg_lo:[1,0]
    v_pk_fma_f32 v[46:47], v[40:41], v[40:41], v[60:61] op_sel_hi:[0,1,1]
    v_pk_mul_f32 v[58:59], v[46:47], v[40:41] op_sel:[1,1] op_sel_hi:[1,0] neg_lo:[1,0]
    v_pk_fma_f32 v[48:49], v[46:47], v[40:41], v[58:59] op_sel_hi:[0,1,1]
    global_load_dwordx4 v[200:203], v254, s[46:47] offset:-4096
    v_cvt_pk_bf16_f32 v156, v40, v41
    v_cvt_pk_bf16_f32 v157, v46, v47
    v_cvt_pk_bf16_f32 v158, v48, v49
    v_pk_mul_f32 v[58:59], v[48:49], v[40:41] op_sel:[1,1] op_sel_hi:[1,0] neg_lo:[1,0]
    v_pk_fma_f32 v[50:51], v[48:49], v[40:41], v[58:59] op_sel_hi:[0,1,1]
    v_pk_mul_f32 v[60:61], v[50:51], v[40:41] op_sel:[1,1] op_sel_hi:[1,0] neg_lo:[1,0]
    v_pk_fma_f32 v[52:53], v[50:51], v[40:41], v[60:61] op_sel_hi:[0,1,1]
    v_pk_mul_f32 v[58:59], v[52:53], v[40:41] op_sel:[1,1] op_sel_hi:[1,0] neg_lo:[1,0]
    v_pk_fma_f32 v[54:55], v[52:53], v[40:41], v[58:59] op_sel_hi:[0,1,1]
    v_pk_mul_f32 v[60:61], v[54:55], v[40:41] op_sel:[1,1] op_sel_hi:[1,0] neg_lo:[1,0]
    v_pk_fma_f32 v[56:57], v[54:55], v[40:41], v[60:61] op_sel_hi:[0,1,1]
    ds_write_addtid_b32 v156 offset:37136
    ds_write_addtid_b32 v157 offset:37408
    ds_write_addtid_b32 v158 offset:37680
    global_load_dwordx4 v[204:207], v254, s[46:47] offset:-3072
    v_cvt_pk_bf16_f32 v156, v50, v51
    v_cvt_pk_bf16_f32 v157, v52, v53
    v_cvt_pk_bf16_f32 v158, v54, v55
    v_cvt_pk_bf16_f32 v159, v56, v57
    v_pk_mul_f32 v[58:59], v[56:57], v[40:41] op_sel:[1,1] op_sel_hi:[1,0] neg_lo:[1,0]
    v_pk_fma_f32 v[62:63], v[56:57], v[40:41], v[58:59] op_sel_hi:[0,1,1]
    v_pk_mul_f32 v[60:61], v[62:63], v[40:41] op_sel:[1,1] op_sel_hi:[1,0] neg_lo:[1,0]
    v_pk_fma_f32 v[168:169], v[62:63], v[40:41], v[60:61] op_sel_hi:[0,1,1]
    v_pk_mul_f32 v[58:59], v[168:169], v[40:41] op_sel:[1,1] op_sel_hi:[1,0] neg_lo:[1,0]
    v_pk_fma_f32 v[170:171], v[168:169], v[40:41], v[58:59] op_sel_hi:[0,1,1]
    v_pk_mul_f32 v[60:61], v[170:171], v[40:41] op_sel:[1,1] op_sel_hi:[1,0] neg_lo:[1,0]
    v_pk_fma_f32 v[172:173], v[170:171], v[40:41], v[60:61] op_sel_hi:[0,1,1]
    ds_write_addtid_b32 v156 offset:37952
    ds_write_addtid_b32 v157 offset:38224
    ds_write_addtid_b32 v158 offset:38496
    ds_write_addtid_b32 v159 offset:38768
    global_load_dwordx4 v[212:215], v254, s[46:47] offset:-1024
    v_cvt_pk_bf16_f32 v156, v62, v63
    v_cvt_pk_bf16_f32 v157, v168, v169
    v_cvt_pk_bf16_f32 v158, v170, v171
    v_cvt_pk_bf16_f32 v159, v172, v173
    v_pk_mul_f32 v[58:59], v[172:173], v[40:41] op_sel:[1,1] op_sel_hi:[1,0] neg_lo:[1,0]
    v_pk_fma_f32 v[174:175], v[172:173], v[40:41], v[58:59] op_sel_hi:[0,1,1]
    v_pk_mul_f32 v[60:61], v[174:175], v[40:41] op_sel:[1,1] op_sel_hi:[1,0] neg_lo:[1,0]
    v_pk_fma_f32 v[144:145], v[174:175], v[40:41], v[60:61] op_sel_hi:[0,1,1]
    v_pk_mul_f32 v[58:59], v[144:145], v[40:41] op_sel:[1,1] op_sel_hi:[1,0] neg_lo:[1,0]
    v_pk_fma_f32 v[46:47], v[144:145], v[40:41], v[58:59] op_sel_hi:[0,1,1]
    v_pk_mul_f32 v[60:61], v[46:47], v[40:41] op_sel:[1,1] op_sel_hi:[1,0] neg_lo:[1,0]
    v_pk_fma_f32 v[48:49], v[46:47], v[40:41], v[60:61] op_sel_hi:[0,1,1]
    ds_write_addtid_b32 v156 offset:39040
    ds_write_addtid_b32 v157 offset:39312
    ds_write_addtid_b32 v158 offset:39584
    ds_write_addtid_b32 v159 offset:39856
    global_load_dwordx4 v[216:219], v254, s[46:47] offset:0
    v_cvt_pk_bf16_f32 v156, v174, v175
    v_cvt_pk_bf16_f32 v157, v144, v145
    v_cvt_pk_bf16_f32 v158, v46, v47
    v_cvt_pk_bf16_f32 v159, v48, v49
    v_pk_mul_f32 v[58:59], v[48:49], v[40:41] op_sel:[1,1] op_sel_hi:[1,0] neg_lo:[1,0]
    v_pk_fma_f32 v[50:51], v[48:49], v[40:41], v[58:59] op_sel_hi:[0,1,1]
    v_pk_mul_f32 v[60:61], v[50:51], v[40:41] op_sel:[1,1] op_sel_hi:[1,0] neg_lo:[1,0]
    v_pk_fma_f32 v[52:53], v[50:51], v[40:41], v[60:61] op_sel_hi:[0,1,1]
    v_pk_mul_f32 v[58:59], v[52:53], v[40:41] op_sel:[1,1] op_sel_hi:[1,0] neg_lo:[1,0]
    v_pk_fma_f32 v[54:55], v[52:53], v[40:41], v[58:59] op_sel_hi:[0,1,1]
    v_pk_mul_f32 v[60:61], v[54:55], v[40:41] op_sel:[1,1] op_sel_hi:[1,0] neg_lo:[1,0]
    v_pk_fma_f32 v[56:57], v[54:55], v[40:41], v[60:61] op_sel_hi:[0,1,1]
    ds_write_addtid_b32 v156 offset:40128
    ds_write_addtid_b32 v157 offset:40400
    ds_write_addtid_b32 v158 offset:40672
    ds_write_addtid_b32 v159 offset:40944
    global_load_dwordx4 v[220:223], v254, s[46:47] offset:1024
    v_cvt_pk_bf16_f32 v156, v50, v51
    v_cvt_pk_bf16_f32 v157, v52, v53
    v_cvt_pk_bf16_f32 v158, v54, v55
    v_cvt_pk_bf16_f32 v159, v56, v57
    v_pk_mul_f32 v[58:59], v[56:57], v[40:41] op_sel:[1,1] op_sel_hi:[1,0] neg_lo:[1,0]
    v_pk_fma_f32 v[62:63], v[56:57], v[40:41], v[58:59] op_sel_hi:[0,1,1]
    v_pk_mul_f32 v[60:61], v[62:63], v[40:41] op_sel:[1,1] op_sel_hi:[1,0] neg_lo:[1,0]
    v_pk_fma_f32 v[168:169], v[62:63], v[40:41], v[60:61] op_sel_hi:[0,1,1]
    v_pk_mul_f32 v[58:59], v[168:169], v[40:41] op_sel:[1,1] op_sel_hi:[1,0] neg_lo:[1,0]
    v_pk_fma_f32 v[170:171], v[168:169], v[40:41], v[58:59] op_sel_hi:[0,1,1]
    v_pk_mul_f32 v[60:61], v[170:171], v[40:41] op_sel:[1,1] op_sel_hi:[1,0] neg_lo:[1,0]
    v_pk_fma_f32 v[172:173], v[170:171], v[40:41], v[60:61] op_sel_hi:[0,1,1]
    ds_write_addtid_b32 v156 offset:41216
    ds_write_addtid_b32 v157 offset:41488
    ds_write_addtid_b32 v158 offset:41760
    ds_write_addtid_b32 v159 offset:42032
    global_load_dwordx4 v[228:231], v254, s[46:47] offset:3072
    v_cvt_pk_bf16_f32 v156, v62, v63
    v_cvt_pk_bf16_f32 v157, v168, v169
    v_cvt_pk_bf16_f32 v158, v170, v171
    v_cvt_pk_bf16_f32 v159, v172, v173
    v_pk_mul_f32 v[58:59], v[172:173], v[40:41] op_sel:[1,1] op_sel_hi:[1,0] neg_lo:[1,0]
    v_pk_fma_f32 v[174:175], v[172:173], v[40:41], v[58:59] op_sel_hi:[0,1,1]
    v_pk_mul_f32 v[60:61], v[174:175], v[40:41] op_sel:[1,1] op_sel_hi:[1,0] neg_lo:[1,0]
    v_pk_fma_f32 v[144:145], v[174:175], v[40:41], v[60:61] op_sel_hi:[0,1,1]
    v_pk_mul_f32 v[58:59], v[144:145], v[40:41] op_sel:[1,1] op_sel_hi:[1,0] neg_lo:[1,0]
    v_pk_fma_f32 v[46:47], v[144:145], v[40:41], v[58:59] op_sel_hi:[0,1,1]
    v_pk_mul_f32 v[60:61], v[46:47], v[40:41] op_sel:[1,1] op_sel_hi:[1,0] neg_lo:[1,0]
    v_pk_fma_f32 v[48:49], v[46:47], v[40:41], v[60:61] op_sel_hi:[0,1,1]
    ds_write_addtid_b32 v156 offset:42304
    ds_write_addtid_b32 v157 offset:42576
    ds_write_addtid_b32 v158 offset:42848
    ds_write_addtid_b32 v159 offset:43120
    global_load_dwordx4 v[236:239], v255, s[46:47] offset:-3072
    s_waitcnt vmcnt(12)
    v_add_u32 v224, s70, v224
    v_add_u32 v225, s70, v225
    s_lshl_b32 s48, s37, 15
    s_lshl_b32 s49, s36, 12
    s_add_u32 s48, s48, s49
    s_waitcnt vmcnt(11)
    v_add_u32 v211, s48, v211
    s_mul_i32 s49, s36, 659456
    v_add_u32 v176, s49, v210
    s_lshr_b32 s48, s50, 2
    s_sub_u32 s48, 160, s48
    s_lshl_b32 s48, s48, 8
    v_subrev_u32 v210, s48, v176
    s_waitcnt vmcnt(10)
    v_add_u32 v233, s70, v233
    v_cvt_pk_bf16_f32 v156, v174, v175
    v_cvt_pk_bf16_f32 v157, v144, v145
    v_cvt_pk_bf16_f32 v158, v46, v47
    v_cvt_pk_bf16_f32 v159, v48, v49
    v_pk_mul_f32 v[58:59], v[48:49], v[40:41] op_sel:[1,1] op_sel_hi:[1,0] neg_lo:[1,0]
    v_pk_fma_f32 v[50:51], v[48:49], v[40:41], v[58:59] op_sel_hi:[0,1,1]
    v_pk_mul_f32 v[60:61], v[50:51], v[40:41] op_sel:[1,1] op_sel_hi:[1,0] neg_lo:[1,0]
    v_pk_fma_f32 v[52:53], v[50:51], v[40:41], v[60:61] op_sel_hi:[0,1,1]
    v_pk_mul_f32 v[58:59], v[52:53], v[40:41] op_sel:[1,1] op_sel_hi:[1,0] neg_lo:[1,0]
    v_pk_fma_f32 v[54:55], v[52:53], v[40:41], v[58:59] op_sel_hi:[0,1,1]
    v_pk_mul_f32 v[60:61], v[54:55], v[40:41] op_sel:[1,1] op_sel_hi:[1,0] neg_lo:[1,0]
    v_pk_fma_f32 v[56:57], v[54:55], v[40:41], v[60:61] op_sel_hi:[0,1,1]
    ds_write_addtid_b32 v156 offset:43392
    ds_write_addtid_b32 v157 offset:43664
    ds_write_addtid_b32 v158 offset:43936
    ds_write_addtid_b32 v159 offset:44208
    global_load_dwordx4 v[240:243], v255, s[46:47] offset:-2048
    v_readfirstlane_b32 s44, v179
    s_nop 1
    s_add_u32 s44, s44, 1
    s_xor_b32 s45, s44, 0x5bd1e995
    v_mov_b32 v178, s44
    v_mov_b32 v179, s45
    s_waitcnt vmcnt(8)
    s_barrier
    s_nop 0
    s_mov_b32 s48, 4194304
    buffer_store_dwordx2 v[178:179], v177, s[40:43], s48 offen sc1
    v_cvt_pk_bf16_f32 v156, v50, v51
    v_cvt_pk_bf16_f32 v157, v52, v53
    v_cvt_pk_bf16_f32 v158, v54, v55
    v_cvt_pk_bf16_f32 v159, v56, v57
    v_pk_mul_f32 v[60:61], v[44:45], v[38:39] op_sel:[1,1] op_sel_hi:[1,0] neg_lo:[1,0]
    v_pk_fma_f32 v[62:63], v[44:45], v[38:39], v[60:61] op_sel_hi:[0,1,1]
    v_pk_mul_f32 v[58:59], v[62:63], v[38:39] op_sel:[1,1] op_sel_hi:[1,0] neg_lo:[1,0]
    v_pk_fma_f32 v[168:169], v[62:63], v[38:39], v[58:59] op_sel_hi:[0,1,1]
    v_pk_mul_f32 v[60:61], v[168:169], v[38:39] op_sel:[1,1] op_sel_hi:[1,0] neg_lo:[1,0]
    v_pk_fma_f32 v[170:171], v[168:169], v[38:39], v[60:61] op_sel_hi:[0,1,1]
    ds_write_addtid_b32 v156 offset:44480
    ds_write_addtid_b32 v157 offset:44752
    ds_write_addtid_b32 v158 offset:45024
    ds_write_addtid_b32 v159 offset:45296
    ds_read_b128 v[68:71], v225 offset:0
    ds_read_b128 v[76:79], v225 offset:32
    global_load_dwordx4 v[244:247], v255, s[46:47] offset:-1024
    v_cvt_pk_bf16_f32 v156, v44, v45
    v_cvt_pk_bf16_f32 v157, v62, v63
    v_cvt_pk_bf16_f32 v158, v168, v169
    v_cvt_pk_bf16_f32 v159, v170, v171
    v_pk_mul_f32 v[58:59], v[170:171], v[38:39] op_sel:[1,1] op_sel_hi:[1,0] neg_lo:[1,0]
    v_pk_fma_f32 v[172:173], v[170:171], v[38:39], v[58:59] op_sel_hi:[0,1,1]
    v_pk_mul_f32 v[60:61], v[172:173], v[38:39] op_sel:[1,1] op_sel_hi:[1,0] neg_lo:[1,0]
    v_pk_fma_f32 v[174:175], v[172:173], v[38:39], v[60:61] op_sel_hi:[0,1,1]
    v_pk_mul_f32 v[58:59], v[174:175], v[38:39] op_sel:[1,1] op_sel_hi:[1,0] neg_lo:[1,0]
    v_pk_fma_f32 v[144:145], v[174:175], v[38:39], v[58:59] op_sel_hi:[0,1,1]
    v_pk_mul_f32 v[60:61], v[144:145], v[38:39] op_sel:[1,1] op_sel_hi:[1,0] neg_lo:[1,0]
    v_pk_fma_f32 v[46:47], v[144:145], v[38:39], v[60:61] op_sel_hi:[0,1,1]
    ds_write_addtid_b32 v156 offset:45568
    ds_write_addtid_b32 v157 offset:45840
    ds_write_addtid_b32 v158 offset:46112
    ds_write_addtid_b32 v159 offset:46384
    ds_read_b128 v[84:87], v225 offset:64
    ds_read_b128 v[92:95], v225 offset:96
    global_load_dwordx4 v[248:251], v255, s[46:47] offset:0
    v_cvt_pk_bf16_f32 v156, v172, v173
    v_cvt_pk_bf16_f32 v157, v174, v175
    v_cvt_pk_bf16_f32 v158, v144, v145
    v_cvt_pk_bf16_f32 v159, v46, v47
    v_pk_mul_f32 v[58:59], v[46:47], v[38:39] op_sel:[1,1] op_sel_hi:[1,0] neg_lo:[1,0]
    v_pk_fma_f32 v[48:49], v[46:47], v[38:39], v[58:59] op_sel_hi:[0,1,1]
    v_pk_mul_f32 v[60:61], v[44:45], v[42:43] op_sel:[1,1] op_sel_hi:[1,0] neg_lo:[1,0]
    v_pk_fma_f32 v[50:51], v[44:45], v[42:43], v[60:61] op_sel_hi:[0,1,1]
    v_pk_mul_f32 v[58:59], v[168:169], v[42:43] op_sel:[1,1] op_sel_hi:[1,0] neg_lo:[1,0]
    v_pk_fma_f32 v[52:53], v[168:169], v[42:43], v[58:59] op_sel_hi:[0,1,1]
    v_pk_mul_f32 v[60:61], v[172:173], v[42:43] op_sel:[1,1] op_sel_hi:[1,0] neg_lo:[1,0]
    v_pk_fma_f32 v[54:55], v[172:173], v[42:43], v[60:61] op_sel_hi:[0,1,1]
    v_pk_mul_f32 v[58:59], v[144:145], v[42:43] op_sel:[1,1] op_sel_hi:[1,0] neg_lo:[1,0]
    v_pk_fma_f32 v[56:57], v[144:145], v[42:43], v[58:59] op_sel_hi:[0,1,1]
L_padB_0:
    s_cbranch_execz L_padB_4
    ds_write_addtid_b32 v156 offset:46656
    ds_write_addtid_b32 v157 offset:46928
    ds_write_addtid_b32 v158 offset:47200
    ds_write_addtid_b32 v159 offset:47472
    ds_read_b128 v[100:103], v225 offset:128
    ds_read_b128 v[108:111], v225 offset:160
    v_cvt_pk_bf16_f32 v156, v50, v51
    v_cvt_pk_bf16_f32 v157, v52, v53
    v_cvt_pk_bf16_f32 v158, v54, v55
    v_cvt_pk_bf16_f32 v159, v56, v57
    v_pk_mul_f32 v[58:59], v[48:49], v[42:43] op_sel:[1,1] op_sel_hi:[1,0] neg_lo:[1,0]
    v_pk_fma_f32 v[62:63], v[48:49], v[42:43], v[58:59] op_sel_hi:[0,1,1]
    v_pk_mul_f32 v[60:61], v[54:55], v[42:43] op_sel:[1,1] op_sel_hi:[1,0] neg_lo:[1,0]
    v_pk_fma_f32 v[170:171], v[54:55], v[42:43], v[60:61] op_sel_hi:[0,1,1]
    v_pk_mul_f32 v[58:59], v[62:63], v[42:43] op_sel:[1,1] op_sel_hi:[1,0] neg_lo:[1,0]
    v_pk_fma_f32 v[174:175], v[62:63], v[42:43], v[58:59] op_sel_hi:[0,1,1]
    v_pk_mul_f32 v[60:61], v[170:171], v[42:43] op_sel:[1,1] op_sel_hi:[1,0] neg_lo:[1,0]
    v_pk_fma_f32 v[168:169], v[170:171], v[42:43], v[60:61] op_sel_hi:[0,1,1]
    ds_write_addtid_b32 v156 offset:47744
    ds_write_addtid_b32 v157 offset:48016
    ds_write_addtid_b32 v158 offset:48288
    ds_write_addtid_b32 v158 offset:48832
    ds_write_addtid_b32 v159 offset:49104
    ds_read_b128 v[116:119], v225 offset:192
    v_cvt_pk_bf16_f32 v156, v62, v63
    v_cvt_pk_bf16_f32 v157, v170, v171
    v_cvt_pk_bf16_f32 v158, v174, v175
    v_cvt_pk_bf16_f32 v159, v168, v169
    v_pk_mul_f32 v[58:59], v[174:175], v[42:43] op_sel:[1,1] op_sel_hi:[1,0] neg_lo:[1,0]
    v_pk_fma_f32 v[172:173], v[174:175], v[42:43], v[58:59] op_sel_hi:[0,1,1]
    v_pk_mul_f32 v[60:61], v[172:173], v[42:43] op_sel:[1,1] op_sel_hi:[1,0] neg_lo:[1,0]
    v_pk_fma_f32 v[144:145], v[172:173], v[42:43], v[60:61] op_sel_hi:[0,1,1]
    v_pk_mul_f32 v[58:59], v[144:145], v[42:43] op_sel:[1,1] op_sel_hi:[1,0] neg_lo:[1,0]
    v_pk_fma_f32 v[46:47], v[144:145], v[42:43], v[58:59] op_sel_hi:[0,1,1]
    v_pk_mul_f32 v[60:61], v[46:47], v[42:43] op_sel:[1,1] op_sel_hi:[1,0] neg_lo:[1,0]
    v_pk_fma_f32 v[50:51], v[46:47], v[42:43], v[60:61] op_sel_hi:[0,1,1]
    v_pk_mul_f32 v[58:59], v[50:51], v[42:43] op_sel:[1,1] op_sel_hi:[1,0] neg_lo:[1,0]
    v_pk_fma_f32 v[52:53], v[50:51], v[42:43], v[58:59] op_sel_hi:[0,1,1]
    ds_write_addtid_b32 v156 offset:49376
    ds_write_addtid_b32 v157 offset:49920
    ds_write_addtid_b32 v158 offset:50192
    ds_write_addtid_b32 v159 offset:51008
    ds_read_b128 v[124:127], v225 offset:224
    v_cvt_pk_bf16_f32 v156, v172, v173
    v_cvt_pk_bf16_f32 v157, v144, v145
    v_cvt_pk_bf16_f32 v158, v46, v47
    v_cvt_pk_bf16_f32 v159, v50, v51
    v_cvt_pk_bf16_f32 v160, v52, v53
    ds_write_addtid_b32 v156 offset:51280
    ds_write_addtid_b32 v157 offset:50464
    ds_write_addtid_b32 v158 offset:48560
    ds_write_addtid_b32 v159 offset:51552
    ds_write_addtid_b32 v160 offset:49648
    ds_read_b128 v[64:67], v224 offset:8704
    ds_read_b128 v[72:75], v224 offset:8736
    v_and_b32 v146, 0xffff0000, v20
    v_and_b32 v147, 0xffff0000, v21
    v_and_b32 v148, 0xffff0000, v22
    v_and_b32 v149, 0xffff0000, v23
    v_and_b32 v150, 0xffff0000, v24
    v_and_b32 v151, 0xffff0000, v25
    v_mul_f32 v146, s56, v146
    v_mul_f32 v147, s57, v147
    v_mul_f32 v148, s58, v148
    v_mul_f32 v149, s58, v149
    v_mul_f32 v152, 0x41000000, v146
    v_mul_f32 v153, 0xc1000000, v147
    v_mul_f32 v154, 0x43800000, v146
    v_mul_f32 v155, 0x43800000, v147
    v_fract_f32 v147, v147
    v_fract_f32 v153, v153
    v_fract_f32 v155, v155
    v_exp_f32 v146, v146
    v_mul_f32 v44, v150, v148
    v_cos_f32 v38, v147
    v_mul_f32 v45, v150, v149
    v_sin_f32 v39, v147
    v_fma_f32 v44, -v151, v149, v44
    v_exp_f32 v152, v152
    v_fmac_f32 v45, v151, v148
    v_cos_f32 v40, v153
    v_mul_f32 v38, v146, v38
    v_sin_f32 v41, v153
    v_mul_f32 v39, v146, v39
    v_exp_f32 v154, v154
    v_mul_f32 v40, v152, v40
    v_cos_f32 v42, v155
    v_mul_f32 v41, v152, v41
    v_sin_f32 v43, v155
    v_mul_f32 v42, v154, v42
    v_mul_f32 v43, v154, v43
    v_pk_mul_f32 v[60:61], v[40:41], v[40:41] op_sel:[1,1] op_sel_hi:[1,0] neg_lo:[1,0]
    v_pk_fma_f32 v[46:47], v[40:41], v[40:41], v[60:61] op_sel_hi:[0,1,1]
    v_pk_mul_f32 v[58:59], v[46:47], v[40:41] op_sel:[1,1] op_sel_hi:[1,0] neg_lo:[1,0]
    v_pk_fma_f32 v[48:49], v[46:47], v[40:41], v[58:59] op_sel_hi:[0,1,1]
    s_waitcnt lgkmcnt(1)
    v_mfma_f32_32x32x16_bf16 v[128:143], v[64:67], v[68:71], 0
    s_and_b32 s62, s37, 1
    s_nop 0
    ds_read_b128 v[80:83], v224 offset:8768
    v_cvt_pk_bf16_f32 v156, v40, v41
    v_cvt_pk_bf16_f32 v157, v46, v47
    v_cvt_pk_bf16_f32 v158, v48, v49
    v_pk_mul_f32 v[58:59], v[48:49], v[40:41] op_sel:[1,1] op_sel_hi:[1,0] neg_lo:[1,0]
    v_pk_fma_f32 v[50:51], v[48:49], v[40:41], v[58:59] op_sel_hi:[0,1,1]
    v_pk_mul_f32 v[60:61], v[50:51], v[40:41] op_sel:[1,1] op_sel_hi:[1,0] neg_lo:[1,0]
    v_pk_fma_f32 v[52:53], v[50:51], v[40:41], v[60:61] op_sel_hi:[0,1,1]
    v_pk_mul_f32 v[58:59], v[52:53], v[40:41] op_sel:[1,1] op_sel_hi:[1,0] neg_lo:[1,0]
    v_pk_fma_f32 v[54:55], v[52:53], v[40:41], v[58:59] op_sel_hi:[0,1,1]
    v_pk_mul_f32 v[60:61], v[54:55], v[40:41] op_sel:[1,1] op_sel_hi:[1,0] neg_lo:[1,0]
    v_pk_fma_f32 v[56:57], v[54:55], v[40:41], v[60:61] op_sel_hi:[0,1,1]
    s_waitcnt lgkmcnt(1)
    v_mfma_f32_32x32x16_bf16 v[128:143], v[72:75], v[76:79], v[128:143]
    s_lshl_b32 s62, s62, 3
    ds_write_addtid_b32 v156 offset:37136
    ds_write_addtid_b32 v157 offset:37408
    ds_write_addtid_b32 v158 offset:37680
    ds_read_b128 v[88:91], v224 offset:8800
    v_cvt_pk_bf16_f32 v156, v50, v51
    v_cvt_pk_bf16_f32 v157, v52, v53
    v_cvt_pk_bf16_f32 v158, v54, v55
    v_cvt_pk_bf16_f32 v159, v56, v57
    v_pk_mul_f32 v[58:59], v[56:57], v[40:41] op_sel:[1,1] op_sel_hi:[1,0] neg_lo:[1,0]
    v_pk_fma_f32 v[62:63], v[56:57], v[40:41], v[58:59] op_sel_hi:[0,1,1]
    v_pk_mul_f32 v[60:61], v[62:63], v[40:41] op_sel:[1,1] op_sel_hi:[1,0] neg_lo:[1,0]
    v_pk_fma_f32 v[168:169], v[62:63], v[40:41], v[60:61] op_sel_hi:[0,1,1]
    v_pk_mul_f32 v[58:59], v[168:169], v[40:41] op_sel:[1,1] op_sel_hi:[1,0] neg_lo:[1,0]
    v_pk_fma_f32 v[170:171], v[168:169], v[40:41], v[58:59] op_sel_hi:[0,1,1]
    v_pk_mul_f32 v[60:61], v[170:171], v[40:41] op_sel:[1,1] op_sel_hi:[1,0] neg_lo:[1,0]
    v_pk_fma_f32 v[172:173], v[170:171], v[40:41], v[60:61] op_sel_hi:[0,1,1]
    s_waitcnt lgkmcnt(4)
    v_mfma_f32_32x32x16_bf16 v[128:143], v[80:83], v[84:87], v[128:143]
    s_lshr_b32 s67, s38, 2
    ds_write_addtid_b32 v156 offset:37952
    ds_write_addtid_b32 v157 offset:38224
    ds_write_addtid_b32 v158 offset:38496
    ds_write_addtid_b32 v159 offset:38768
    ds_read_b128 v[96:99], v224 offset:8832
    v_cvt_pk_bf16_f32 v156, v62, v63
    v_cvt_pk_bf16_f32 v157, v168, v169
    v_cvt_pk_bf16_f32 v158, v170, v171
    v_cvt_pk_bf16_f32 v159, v172, v173
    v_pk_mul_f32 v[58:59], v[172:173], v[40:41] op_sel:[1,1] op_sel_hi:[1,0] neg_lo:[1,0]
    v_pk_fma_f32 v[174:175], v[172:173], v[40:41], v[58:59] op_sel_hi:[0,1,1]
    v_pk_mul_f32 v[60:61], v[174:175], v[40:41] op_sel:[1,1] op_sel_hi:[1,0] neg_lo:[1,0]
    v_pk_fma_f32 v[144:145], v[174:175], v[40:41], v[60:61] op_sel_hi:[0,1,1]
    v_pk_mul_f32 v[58:59], v[144:145], v[40:41] op_sel:[1,1] op_sel_hi:[1,0] neg_lo:[1,0]
    v_pk_fma_f32 v[46:47], v[144:145], v[40:41], v[58:59] op_sel_hi:[0,1,1]
    v_pk_mul_f32 v[60:61], v[46:47], v[40:41] op_sel:[1,1] op_sel_hi:[1,0] neg_lo:[1,0]
    v_pk_fma_f32 v[48:49], v[46:47], v[40:41], v[60:61] op_sel_hi:[0,1,1]
    s_waitcnt lgkmcnt(5)
    v_mfma_f32_32x32x16_bf16 v[128:143], v[88:91], v[92:95], v[128:143]
    s_add_u32 s62, s62, s67
    ds_write_addtid_b32 v156 offset:39040
    ds_write_addtid_b32 v157 offset:39312
    ds_write_addtid_b32 v158 offset:39584
    ds_write_addtid_b32 v159 offset:39856
    ds_read_b128 v[104:107], v224 offset:8864
    v_cvt_pk_bf16_f32 v156, v174, v175
    v_cvt_pk_bf16_f32 v157, v144, v145
    v_cvt_pk_bf16_f32 v158, v46, v47
    v_cvt_pk_bf16_f32 v159, v48, v49
    v_pk_mul_f32 v[58:59], v[48:49], v[40:41] op_sel:[1,1] op_sel_hi:[1,0] neg_lo:[1,0]
    v_pk_fma_f32 v[50:51], v[48:49], v[40:41], v[58:59] op_sel_hi:[0,1,1]
    v_pk_mul_f32 v[60:61], v[50:51], v[40:41] op_sel:[1,1] op_sel_hi:[1,0] neg_lo:[1,0]
    v_pk_fma_f32 v[52:53], v[50:51], v[40:41], v[60:61] op_sel_hi:[0,1,1]
    v_pk_mul_f32 v[58:59], v[52:53], v[40:41] op_sel:[1,1] op_sel_hi:[1,0] neg_lo:[1,0]
    v_pk_fma_f32 v[54:55], v[52:53], v[40:41], v[58:59] op_sel_hi:[0,1,1]
    v_pk_mul_f32 v[60:61], v[54:55], v[40:41] op_sel:[1,1] op_sel_hi:[1,0] neg_lo:[1,0]
    v_pk_fma_f32 v[56:57], v[54:55], v[40:41], v[60:61] op_sel_hi:[0,1,1]
    s_waitcnt lgkmcnt(5)
    v_mfma_f32_32x32x16_bf16 v[128:143], v[96:99], v[100:103], v[128:143]
    s_lshr_b32 s63, s37, 1
    ds_write_addtid_b32 v156 offset:40128
    ds_write_addtid_b32 v157 offset:40400
    ds_write_addtid_b32 v158 offset:40672
    ds_write_addtid_b32 v159 offset:40944
    ds_read_b128 v[112:115], v224 offset:8896
    v_cvt_pk_bf16_f32 v156, v50, v51
    v_cvt_pk_bf16_f32 v157, v52, v53
    v_cvt_pk_bf16_f32 v158, v54, v55
    v_cvt_pk_bf16_f32 v159, v56, v57
    v_pk_mul_f32 v[58:59], v[56:57], v[40:41] op_sel:[1,1] op_sel_hi:[1,0] neg_lo:[1,0]
    v_pk_fma_f32 v[62:63], v[56:57], v[40:41], v[58:59] op_sel_hi:[0,1,1]
    v_pk_mul_f32 v[60:61], v[62:63], v[40:41] op_sel:[1,1] op_sel_hi:[1,0] neg_lo:[1,0]
    v_pk_fma_f32 v[168:169], v[62:63], v[40:41], v[60:61] op_sel_hi:[0,1,1]
    v_pk_mul_f32 v[58:59], v[168:169], v[40:41] op_sel:[1,1] op_sel_hi:[1,0] neg_lo:[1,0]
    v_pk_fma_f32 v[170:171], v[168:169], v[40:41], v[58:59] op_sel_hi:[0,1,1]
    v_pk_mul_f32 v[60:61], v[170:171], v[40:41] op_sel:[1,1] op_sel_hi:[1,0] neg_lo:[1,0]
    v_pk_fma_f32 v[172:173], v[170:171], v[40:41], v[60:61] op_sel_hi:[0,1,1]
    s_waitcnt lgkmcnt(5)
    v_mfma_f32_32x32x16_bf16 v[128:143], v[104:107], v[108:111], v[128:143]
    s_and_b32 s67, s38, 3
    ds_write_addtid_b32 v156 offset:41216
    ds_write_addtid_b32 v157 offset:41488
    ds_write_addtid_b32 v158 offset:41760
    ds_write_addtid_b32 v159 offset:42032
    ds_read_b128 v[120:123], v224 offset:8928
    v_cvt_pk_bf16_f32 v156, v62, v63
    v_cvt_pk_bf16_f32 v157, v168, v169
    v_cvt_pk_bf16_f32 v158, v170, v171
    v_cvt_pk_bf16_f32 v159, v172, v173
    v_pk_mul_f32 v[58:59], v[172:173], v[40:41] op_sel:[1,1] op_sel_hi:[1,0] neg_lo:[1,0]
    v_pk_fma_f32 v[174:175], v[172:173], v[40:41], v[58:59] op_sel_hi:[0,1,1]
    v_pk_mul_f32 v[60:61], v[174:175], v[40:41] op_sel:[1,1] op_sel_hi:[1,0] neg_lo:[1,0]
    v_pk_fma_f32 v[144:145], v[174:175], v[40:41], v[60:61] op_sel_hi:[0,1,1]
    v_pk_mul_f32 v[58:59], v[144:145], v[40:41] op_sel:[1,1] op_sel_hi:[1,0] neg_lo:[1,0]
    v_pk_fma_f32 v[46:47], v[144:145], v[40:41], v[58:59] op_sel_hi:[0,1,1]
    v_pk_mul_f32 v[60:61], v[46:47], v[40:41] op_sel:[1,1] op_sel_hi:[1,0] neg_lo:[1,0]
    v_pk_fma_f32 v[48:49], v[46:47], v[40:41], v[60:61] op_sel_hi:[0,1,1]
    s_waitcnt lgkmcnt(5)
    v_mfma_f32_32x32x16_bf16 v[128:143], v[112:115], v[116:119], v[128:143]
    s_lshl2_add_u32 s63, s63, s67
    ds_write_addtid_b32 v156 offset:42304
    ds_write_addtid_b32 v157 offset:42576
    ds_write_addtid_b32 v158 offset:42848
    ds_write_addtid_b32 v159 offset:43120
    v_cvt_pk_bf16_f32 v156, v174, v175
    v_cvt_pk_bf16_f32 v157, v144, v145
    v_cvt_pk_bf16_f32 v158, v46, v47
    v_cvt_pk_bf16_f32 v159, v48, v49
    v_pk_mul_f32 v[58:59], v[48:49], v[40:41] op_sel:[1,1] op_sel_hi:[1,0] neg_lo:[1,0]
    v_pk_fma_f32 v[50:51], v[48:49], v[40:41], v[58:59] op_sel_hi:[0,1,1]
    v_pk_mul_f32 v[60:61], v[50:51], v[40:41] op_sel:[1,1] op_sel_hi:[1,0] neg_lo:[1,0]
    v_pk_fma_f32 v[52:53], v[50:51], v[40:41], v[60:61] op_sel_hi:[0,1,1]
    v_pk_mul_f32 v[58:59], v[52:53], v[40:41] op_sel:[1,1] op_sel_hi:[1,0] neg_lo:[1,0]
    v_pk_fma_f32 v[54:55], v[52:53], v[40:41], v[58:59] op_sel_hi:[0,1,1]
    v_pk_mul_f32 v[60:61], v[54:55], v[40:41] op_sel:[1,1] op_sel_hi:[1,0] neg_lo:[1,0]
    v_pk_fma_f32 v[56:57], v[54:55], v[40:41], v[60:61] op_sel_hi:[0,1,1]
    s_waitcnt lgkmcnt(4)
    v_mfma_f32_32x32x16_bf16 v[128:143], v[120:123], v[124:127], v[128:143]
    s_lshl2_add_u32 s60, s63, s36
    ds_write_addtid_b32 v156 offset:43392
    ds_write_addtid_b32 v157 offset:43664
    ds_write_addtid_b32 v158 offset:43936
    ds_write_addtid_b32 v159 offset:44208
    v_cvt_pk_bf16_f32 v156, v50, v51
    v_cvt_pk_bf16_f32 v157, v52, v53
    v_cvt_pk_bf16_f32 v158, v54, v55
    v_cvt_pk_bf16_f32 v159, v56, v57
    v_pk_mul_f32 v[60:61], v[44:45], v[38:39] op_sel:[1,1] op_sel_hi:[1,0] neg_lo:[1,0]
    v_pk_fma_f32 v[62:63], v[44:45], v[38:39], v[60:61] op_sel_hi:[0,1,1]
    v_pk_mul_f32 v[58:59], v[62:63], v[38:39] op_sel:[1,1] op_sel_hi:[1,0] neg_lo:[1,0]
    v_pk_fma_f32 v[168:169], v[62:63], v[38:39], v[58:59] op_sel_hi:[0,1,1]
    v_pk_mul_f32 v[60:61], v[168:169], v[38:39] op_sel:[1,1] op_sel_hi:[1,0] neg_lo:[1,0]
    v_pk_fma_f32 v[170:171], v[168:169], v[38:39], v[60:61] op_sel_hi:[0,1,1]
    ds_write_addtid_b32 v156 offset:44480
    ds_write_addtid_b32 v157 offset:44752
    ds_write_addtid_b32 v158 offset:45024
    ds_write_addtid_b32 v159 offset:45296
    ds_read_b128 v[68:71], v225 offset:0
    ds_read_b128 v[76:79], v225 offset:32
    v_cvt_pk_bf16_f32 v156, v44, v45
    v_cvt_pk_bf16_f32 v157, v62, v63
    v_cvt_pk_bf16_f32 v158, v168, v169
    v_cvt_pk_bf16_f32 v159, v170, v171
    v_pk_mul_f32 v[58:59], v[170:171], v[38:39] op_sel:[1,1] op_sel_hi:[1,0] neg_lo:[1,0]
    v_pk_fma_f32 v[172:173], v[170:171], v[38:39], v[58:59] op_sel_hi:[0,1,1]
    v_pk_mul_f32 v[60:61], v[172:173], v[38:39] op_sel:[1,1] op_sel_hi:[1,0] neg_lo:[1,0]
    v_pk_fma_f32 v[174:175], v[172:173], v[38:39], v[60:61] op_sel_hi:[0,1,1]
    v_pk_mul_f32 v[58:59], v[174:175], v[38:39] op_sel:[1,1] op_sel_hi:[1,0] neg_lo:[1,0]
    v_pk_fma_f32 v[144:145], v[174:175], v[38:39], v[58:59] op_sel_hi:[0,1,1]
    v_pk_mul_f32 v[60:61], v[144:145], v[38:39] op_sel:[1,1] op_sel_hi:[1,0] neg_lo:[1,0]
    v_pk_fma_f32 v[46:47], v[144:145], v[38:39], v[60:61] op_sel_hi:[0,1,1]
    ds_write_addtid_b32 v156 offset:45568
    ds_write_addtid_b32 v157 offset:45840
    ds_write_addtid_b32 v158 offset:46112
    ds_write_addtid_b32 v159 offset:46384
    ds_read_b128 v[84:87], v225 offset:64
    ds_read_b128 v[92:95], v225 offset:96
    v_cvt_pk_bf16_f32 v156, v172, v173
    v_cvt_pk_bf16_f32 v157, v174, v175
    v_cvt_pk_bf16_f32 v158, v144, v145
    v_cvt_pk_bf16_f32 v159, v46, v47
    v_pk_mul_f32 v[58:59], v[46:47], v[38:39] op_sel:[1,1] op_sel_hi:[1,0] neg_lo:[1,0]
    v_pk_fma_f32 v[48:49], v[46:47], v[38:39], v[58:59] op_sel_hi:[0,1,1]
    v_pk_mul_f32 v[60:61], v[44:45], v[42:43] op_sel:[1,1] op_sel_hi:[1,0] neg_lo:[1,0]
    v_pk_fma_f32 v[50:51], v[44:45], v[42:43], v[60:61] op_sel_hi:[0,1,1]
    v_pk_mul_f32 v[58:59], v[168:169], v[42:43] op_sel:[1,1] op_sel_hi:[1,0] neg_lo:[1,0]
    v_pk_fma_f32 v[52:53], v[168:169], v[42:43], v[58:59] op_sel_hi:[0,1,1]
    v_pk_mul_f32 v[60:61], v[172:173], v[42:43] op_sel:[1,1] op_sel_hi:[1,0] neg_lo:[1,0]
    v_pk_fma_f32 v[54:55], v[172:173], v[42:43], v[60:61] op_sel_hi:[0,1,1]
    v_pk_mul_f32 v[58:59], v[144:145], v[42:43] op_sel:[1,1] op_sel_hi:[1,0] neg_lo:[1,0]
    v_pk_fma_f32 v[56:57], v[144:145], v[42:43], v[58:59] op_sel_hi:[0,1,1]
    ds_write_addtid_b32 v156 offset:46656
    ds_write_addtid_b32 v157 offset:46928
    ds_write_addtid_b32 v158 offset:47200
    ds_write_addtid_b32 v159 offset:47472
    ds_read_b128 v[100:103], v225 offset:128
    ds_read_b128 v[108:111], v225 offset:160
    v_cvt_pk_bf16_f32 v156, v50, v51
    v_cvt_pk_bf16_f32 v157, v52, v53
    v_cvt_pk_bf16_f32 v158, v54, v55
    v_cvt_pk_bf16_f32 v159, v56, v57
    v_pk_mul_f32 v[58:59], v[48:49], v[42:43] op_sel:[1,1] op_sel_hi:[1,0] neg_lo:[1,0]
    v_pk_fma_f32 v[62:63], v[48:49], v[42:43], v[58:59] op_sel_hi:[0,1,1]
    v_pk_mul_f32 v[60:61], v[54:55], v[42:43] op_sel:[1,1] op_sel_hi:[1,0] neg_lo:[1,0]
    v_pk_fma_f32 v[170:171], v[54:55], v[42:43], v[60:61] op_sel_hi:[0,1,1]
    v_pk_mul_f32 v[58:59], v[62:63], v[42:43] op_sel:[1,1] op_sel_hi:[1,0] neg_lo:[1,0]
    v_pk_fma_f32 v[174:175], v[62:63], v[42:43], v[58:59] op_sel_hi:[0,1,1]
    v_pk_mul_f32 v[60:61], v[170:171], v[42:43] op_sel:[1,1] op_sel_hi:[1,0] neg_lo:[1,0]
    v_pk_fma_f32 v[168:169], v[170:171], v[42:43], v[60:61] op_sel_hi:[0,1,1]
    ds_write_addtid_b32 v156 offset:47744
    ds_write_addtid_b32 v157 offset:48016
    ds_write_addtid_b32 v158 offset:48288
    ds_write_addtid_b32 v158 offset:48832
    ds_write_addtid_b32 v159 offset:49104
    ds_read_b128 v[116:119], v225 offset:192
    v_cvt_pk_bf16_f32 v156, v62, v63
    v_cvt_pk_bf16_f32 v157, v170, v171
    v_cvt_pk_bf16_f32 v158, v174, v175
    v_cvt_pk_bf16_f32 v159, v168, v169
    v_pk_mul_f32 v[58:59], v[174:175], v[42:43] op_sel:[1,1] op_sel_hi:[1,0] neg_lo:[1,0]
    v_pk_fma_f32 v[172:173], v[174:175], v[42:43], v[58:59] op_sel_hi:[0,1,1]
    v_pk_mul_f32 v[60:61], v[172:173], v[42:43] op_sel:[1,1] op_sel_hi:[1,0] neg_lo:[1,0]
    v_pk_fma_f32 v[144:145], v[172:173], v[42:43], v[60:61] op_sel_hi:[0,1,1]
    v_pk_mul_f32 v[58:59], v[144:145], v[42:43] op_sel:[1,1] op_sel_hi:[1,0] neg_lo:[1,0]
    v_pk_fma_f32 v[46:47], v[144:145], v[42:43], v[58:59] op_sel_hi:[0,1,1]
    v_pk_mul_f32 v[60:61], v[46:47], v[42:43] op_sel:[1,1] op_sel_hi:[1,0] neg_lo:[1,0]
    v_pk_fma_f32 v[50:51], v[46:47], v[42:43], v[60:61] op_sel_hi:[0,1,1]
    v_pk_mul_f32 v[58:59], v[50:51], v[42:43] op_sel:[1,1] op_sel_hi:[1,0] neg_lo:[1,0]
    v_pk_fma_f32 v[52:53], v[50:51], v[42:43], v[58:59] op_sel_hi:[0,1,1]
    ds_write_addtid_b32 v156 offset:49376
    ds_write_addtid_b32 v157 offset:49920
    ds_write_addtid_b32 v158 offset:50192
    ds_write_addtid_b32 v159 offset:51008
    ds_read_b128 v[124:127], v225 offset:224
    buffer_load_dwordx2 v[18:19], v211, s[40:43], 0 offen sc1
    v_cvt_pk_bf16_f32 v156, v172, v173
    v_cvt_pk_bf16_f32 v157, v144, v145
    v_cvt_pk_bf16_f32 v158, v46, v47
    v_cvt_pk_bf16_f32 v159, v50, v51
    v_cvt_pk_bf16_f32 v160, v52, v53
    ds_write_addtid_b32 v156 offset:51280
    ds_write_addtid_b32 v157 offset:50464
    ds_write_addtid_b32 v158 offset:48560
    ds_write_addtid_b32 v159 offset:51552
    ds_write_addtid_b32 v160 offset:49648
    ds_read_b128 v[64:67], v224 offset:8704
    ds_read_b128 v[72:75], v224 offset:8736
    v_lshlrev_b32 v146, 16, v26
    v_lshlrev_b32 v147, 16, v27
    v_lshlrev_b32 v148, 16, v28
    v_lshlrev_b32 v149, 16, v29
    v_lshlrev_b32 v150, 16, v30
    v_lshlrev_b32 v151, 16, v31
    v_mul_f32 v146, s56, v146
    v_mul_f32 v147, s57, v147
    v_mul_f32 v148, s58, v148
    v_mul_f32 v149, s58, v149
    v_mul_f32 v152, 0x41000000, v146
    v_mul_f32 v153, 0xc1000000, v147
    v_mul_f32 v154, 0x43800000, v146
    v_mul_f32 v155, 0x43800000, v147
    v_fract_f32 v147, v147
    v_fract_f32 v153, v153
    v_fract_f32 v155, v155
    v_exp_f32 v146, v146
    v_mul_f32 v44, v150, v148
    v_cos_f32 v38, v147
    v_mul_f32 v45, v150, v149
    v_sin_f32 v39, v147
    v_fma_f32 v44, -v151, v149, v44
    v_exp_f32 v152, v152
    v_fmac_f32 v45, v151, v148
    v_cos_f32 v40, v153
    v_mul_f32 v38, v146, v38
    v_sin_f32 v41, v153
    v_mul_f32 v39, v146, v39
    v_exp_f32 v154, v154
    v_mul_f32 v40, v152, v40
    v_cos_f32 v42, v155
    v_mul_f32 v41, v152, v41
    v_sin_f32 v43, v155
    v_mul_f32 v42, v154, v42
    v_mul_f32 v43, v154, v43
    v_pk_mul_f32 v[60:61], v[40:41], v[40:41] op_sel:[1,1] op_sel_hi:[1,0] neg_lo:[1,0]
    v_pk_fma_f32 v[46:47], v[40:41], v[40:41], v[60:61] op_sel_hi:[0,1,1]
    v_pk_mul_f32 v[58:59], v[46:47], v[40:41] op_sel:[1,1] op_sel_hi:[1,0] neg_lo:[1,0]
    v_pk_fma_f32 v[48:49], v[46:47], v[40:41], v[58:59] op_sel_hi:[0,1,1]
    s_waitcnt lgkmcnt(1)
    v_mfma_f32_32x32x16_bf16 v[128:143], v[64:67], v[68:71], v[128:143]
    s_mul_i32 s60, s60, 61440
    ds_read_b128 v[80:83], v224 offset:8768
    v_cvt_pk_bf16_f32 v156, v40, v41
    v_cvt_pk_bf16_f32 v157, v46, v47
    v_cvt_pk_bf16_f32 v158, v48, v49
    v_pk_mul_f32 v[58:59], v[48:49], v[40:41] op_sel:[1,1] op_sel_hi:[1,0] neg_lo:[1,0]
    v_pk_fma_f32 v[50:51], v[48:49], v[40:41], v[58:59] op_sel_hi:[0,1,1]
    v_pk_mul_f32 v[60:61], v[50:51], v[40:41] op_sel:[1,1] op_sel_hi:[1,0] neg_lo:[1,0]
    v_pk_fma_f32 v[52:53], v[50:51], v[40:41], v[60:61] op_sel_hi:[0,1,1]
    v_pk_mul_f32 v[58:59], v[52:53], v[40:41] op_sel:[1,1] op_sel_hi:[1,0] neg_lo:[1,0]
    v_pk_fma_f32 v[54:55], v[52:53], v[40:41], v[58:59] op_sel_hi:[0,1,1]
    v_pk_mul_f32 v[60:61], v[54:55], v[40:41] op_sel:[1,1] op_sel_hi:[1,0] neg_lo:[1,0]
    v_pk_fma_f32 v[56:57], v[54:55], v[40:41], v[60:61] op_sel_hi:[0,1,1]
    s_waitcnt lgkmcnt(1)
    s_nop 0
    v_mfma_f32_32x32x16_bf16 v[128:143], v[72:75], v[76:79], v[128:143]
    s_add_u32 s60, s60, 10489856
    ds_write_addtid_b32 v156 offset:37136
    ds_write_addtid_b32 v157 offset:37408
    ds_write_addtid_b32 v158 offset:37680
    ds_read_b128 v[88:91], v224 offset:8800
    v_cvt_pk_bf16_f32 v156, v50, v51
    v_cvt_pk_bf16_f32 v157, v52, v53
    v_cvt_pk_bf16_f32 v158, v54, v55
    v_cvt_pk_bf16_f32 v159, v56, v57
    v_pk_mul_f32 v[58:59], v[56:57], v[40:41] op_sel:[1,1] op_sel_hi:[1,0] neg_lo:[1,0]
    v_pk_fma_f32 v[62:63], v[56:57], v[40:41], v[58:59] op_sel_hi:[0,1,1]
    v_pk_mul_f32 v[60:61], v[62:63], v[40:41] op_sel:[1,1] op_sel_hi:[1,0] neg_lo:[1,0]
    v_pk_fma_f32 v[168:169], v[62:63], v[40:41], v[60:61] op_sel_hi:[0,1,1]
    v_pk_mul_f32 v[58:59], v[168:169], v[40:41] op_sel:[1,1] op_sel_hi:[1,0] neg_lo:[1,0]
    v_pk_fma_f32 v[170:171], v[168:169], v[40:41], v[58:59] op_sel_hi:[0,1,1]
    v_pk_mul_f32 v[60:61], v[170:171], v[40:41] op_sel:[1,1] op_sel_hi:[1,0] neg_lo:[1,0]
    v_pk_fma_f32 v[172:173], v[170:171], v[40:41], v[60:61] op_sel_hi:[0,1,1]
    s_waitcnt lgkmcnt(4)
    v_mfma_f32_32x32x16_bf16 v[128:143], v[80:83], v[84:87], v[128:143]
    s_add_u32 s39, s36, 0
    ds_write_addtid_b32 v156 offset:37952
    ds_write_addtid_b32 v157 offset:38224
    ds_write_addtid_b32 v158 offset:38496
    ds_write_addtid_b32 v159 offset:38768
    ds_read_b128 v[96:99], v224 offset:8832
    v_cvt_pk_bf16_f32 v156, v62, v63
    v_cvt_pk_bf16_f32 v157, v168, v169
    v_cvt_pk_bf16_f32 v158, v170, v171
    v_cvt_pk_bf16_f32 v159, v172, v173
    v_pk_mul_f32 v[58:59], v[172:173], v[40:41] op_sel:[1,1] op_sel_hi:[1,0] neg_lo:[1,0]
    v_pk_fma_f32 v[174:175], v[172:173], v[40:41], v[58:59] op_sel_hi:[0,1,1]
    v_pk_mul_f32 v[60:61], v[174:175], v[40:41] op_sel:[1,1] op_sel_hi:[1,0] neg_lo:[1,0]
    v_pk_fma_f32 v[144:145], v[174:175], v[40:41], v[60:61] op_sel_hi:[0,1,1]
    v_pk_mul_f32 v[58:59], v[144:145], v[40:41] op_sel:[1,1] op_sel_hi:[1,0] neg_lo:[1,0]
    v_pk_fma_f32 v[46:47], v[144:145], v[40:41], v[58:59] op_sel_hi:[0,1,1]
    v_pk_mul_f32 v[60:61], v[46:47], v[40:41] op_sel:[1,1] op_sel_hi:[1,0] neg_lo:[1,0]
    v_pk_fma_f32 v[48:49], v[46:47], v[40:41], v[60:61] op_sel_hi:[0,1,1]
    s_waitcnt lgkmcnt(5)
    v_mfma_f32_32x32x16_bf16 v[128:143], v[88:91], v[92:95], v[128:143]
    s_and_b32 s39, s39, 3
    ds_write_addtid_b32 v156 offset:39040
    ds_write_addtid_b32 v157 offset:39312
    ds_write_addtid_b32 v158 offset:39584
    ds_write_addtid_b32 v159 offset:39856
    ds_read_b128 v[104:107], v224 offset:8864
    v_cvt_pk_bf16_f32 v156, v174, v175
    v_cvt_pk_bf16_f32 v157, v144, v145
    v_cvt_pk_bf16_f32 v158, v46, v47
    v_cvt_pk_bf16_f32 v159, v48, v49
    v_pk_mul_f32 v[58:59], v[48:49], v[40:41] op_sel:[1,1] op_sel_hi:[1,0] neg_lo:[1,0]
    v_pk_fma_f32 v[50:51], v[48:49], v[40:41], v[58:59] op_sel_hi:[0,1,1]
    v_pk_mul_f32 v[60:61], v[50:51], v[40:41] op_sel:[1,1] op_sel_hi:[1,0] neg_lo:[1,0]
    v_pk_fma_f32 v[52:53], v[50:51], v[40:41], v[60:61] op_sel_hi:[0,1,1]
    v_pk_mul_f32 v[58:59], v[52:53], v[40:41] op_sel:[1,1] op_sel_hi:[1,0] neg_lo:[1,0]
    v_pk_fma_f32 v[54:55], v[52:53], v[40:41], v[58:59] op_sel_hi:[0,1,1]
    v_pk_mul_f32 v[60:61], v[54:55], v[40:41] op_sel:[1,1] op_sel_hi:[1,0] neg_lo:[1,0]
    v_pk_fma_f32 v[56:57], v[54:55], v[40:41], v[60:61] op_sel_hi:[0,1,1]
    s_waitcnt lgkmcnt(5)
    v_mfma_f32_32x32x16_bf16 v[128:143], v[96:99], v[100:103], v[128:143]
    s_add_u32 s67, s39, 0
    ds_write_addtid_b32 v156 offset:40128
    ds_write_addtid_b32 v157 offset:40400
    ds_write_addtid_b32 v158 offset:40672
    ds_write_addtid_b32 v159 offset:40944
    ds_read_b128 v[112:115], v224 offset:8896
    s_waitcnt vmcnt(0)
    v_cmp_ne_u64 vcc, s[44:45], v[18:19]
    s_nop 1
    s_cbranch_vccnz L_retry_1
L_seen_2:
    v_cvt_pk_bf16_f32 v156, v50, v51
    v_cvt_pk_bf16_f32 v157, v52, v53
    v_cvt_pk_bf16_f32 v158, v54, v55
    v_cvt_pk_bf16_f32 v159, v56, v57
    v_pk_mul_f32 v[58:59], v[56:57], v[40:41] op_sel:[1,1] op_sel_hi:[1,0] neg_lo:[1,0]
    v_pk_fma_f32 v[62:63], v[56:57], v[40:41], v[58:59] op_sel_hi:[0,1,1]
    v_pk_mul_f32 v[60:61], v[62:63], v[40:41] op_sel:[1,1] op_sel_hi:[1,0] neg_lo:[1,0]
    v_pk_fma_f32 v[168:169], v[62:63], v[40:41], v[60:61] op_sel_hi:[0,1,1]
    v_pk_mul_f32 v[58:59], v[168:169], v[40:41] op_sel:[1,1] op_sel_hi:[1,0] neg_lo:[1,0]
    v_pk_fma_f32 v[170:171], v[168:169], v[40:41], v[58:59] op_sel_hi:[0,1,1]
    v_pk_mul_f32 v[60:61], v[170:171], v[40:41] op_sel:[1,1] op_sel_hi:[1,0] neg_lo:[1,0]
    v_pk_fma_f32 v[172:173], v[170:171], v[40:41], v[60:61] op_sel_hi:[0,1,1]
    s_waitcnt lgkmcnt(5)
    v_mfma_f32_32x32x16_bf16 v[128:143], v[104:107], v[108:111], v[128:143]
    s_and_b32 s67, s67, 3
    ds_write_addtid_b32 v156 offset:41216
    ds_write_addtid_b32 v157 offset:41488
    ds_write_addtid_b32 v158 offset:41760
    ds_write_addtid_b32 v159 offset:42032
    ds_read_b128 v[120:123], v224 offset:8928
    s_add_u32 m0, s59, 4096
    s_nop 0
    global_load_lds_dwordx4 v210, s[34:35] sc1
    s_mov_b32 m0, s70
    v_add_u32 v210, 164864, v210
    v_cvt_pk_bf16_f32 v156, v62, v63
    v_cvt_pk_bf16_f32 v157, v168, v169
    v_cvt_pk_bf16_f32 v158, v170, v171
    v_cvt_pk_bf16_f32 v159, v172, v173
    v_pk_mul_f32 v[58:59], v[172:173], v[40:41] op_sel:[1,1] op_sel_hi:[1,0] neg_lo:[1,0]
    v_pk_fma_f32 v[174:175], v[172:173], v[40:41], v[58:59] op_sel_hi:[0,1,1]
    v_pk_mul_f32 v[60:61], v[174:175], v[40:41] op_sel:[1,1] op_sel_hi:[1,0] neg_lo:[1,0]
    v_pk_fma_f32 v[144:145], v[174:175], v[40:41], v[60:61] op_sel_hi:[0,1,1]
    v_pk_mul_f32 v[58:59], v[144:145], v[40:41] op_sel:[1,1] op_sel_hi:[1,0] neg_lo:[1,0]
    v_pk_fma_f32 v[46:47], v[144:145], v[40:41], v[58:59] op_sel_hi:[0,1,1]
    v_pk_mul_f32 v[60:61], v[46:47], v[40:41] op_sel:[1,1] op_sel_hi:[1,0] neg_lo:[1,0]
    v_pk_fma_f32 v[48:49], v[46:47], v[40:41], v[60:61] op_sel_hi:[0,1,1]
    s_waitcnt lgkmcnt(5)
    s_nop 0
    v_mfma_f32_32x32x16_bf16 v[128:143], v[112:115], v[116:119], v[128:143]
    s_mul_i32 s67, s67, 15360
    ds_write_addtid_b32 v156 offset:42304
    ds_write_addtid_b32 v157 offset:42576
    ds_write_addtid_b32 v158 offset:42848
    ds_write_addtid_b32 v159 offset:43120
    s_add_u32 m0, s59, 5120
    s_nop 0
    global_load_lds_dwordx4 v210, s[34:35] sc1
    s_mov_b32 m0, s70
    v_add_u32 v210, 164864, v210
    v_cvt_pk_bf16_f32 v156, v174, v175
    v_cvt_pk_bf16_f32 v157, v144, v145
    v_cvt_pk_bf16_f32 v158, v46, v47
    v_cvt_pk_bf16_f32 v159, v48, v49
    v_pk_mul_f32 v[58:59], v[48:49], v[40:41] op_sel:[1,1] op_sel_hi:[1,0] neg_lo:[1,0]
    v_pk_fma_f32 v[50:51], v[48:49], v[40:41], v[58:59] op_sel_hi:[0,1,1]
    v_pk_mul_f32 v[60:61], v[50:51], v[40:41] op_sel:[1,1] op_sel_hi:[1,0] neg_lo:[1,0]
    v_pk_fma_f32 v[52:53], v[50:51], v[40:41], v[60:61] op_sel_hi:[0,1,1]
    v_pk_mul_f32 v[58:59], v[52:53], v[40:41] op_sel:[1,1] op_sel_hi:[1,0] neg_lo:[1,0]
    v_pk_fma_f32 v[54:55], v[52:53], v[40:41], v[58:59] op_sel_hi:[0,1,1]
    v_pk_mul_f32 v[60:61], v[54:55], v[40:41] op_sel:[1,1] op_sel_hi:[1,0] neg_lo:[1,0]
    v_pk_fma_f32 v[56:57], v[54:55], v[40:41], v[60:61] op_sel_hi:[0,1,1]
    s_waitcnt lgkmcnt(4)
    v_mfma_f32_32x32x16_bf16 v[128:143], v[120:123], v[124:127], v[128:143]
    s_add_u32 s67, s67, s60
    ds_write_addtid_b32 v156 offset:43392
    ds_write_addtid_b32 v157 offset:43664
    ds_write_addtid_b32 v158 offset:43936
    ds_write_addtid_b32 v159 offset:44208
    s_add_u32 m0, s59, 6144
    s_nop 0
    global_load_lds_dwordx4 v210, s[34:35] sc1
    s_mov_b32 m0, s70
    v_add_u32 v210, 164864, v210
    v_cvt_pk_bf16_f32 v156, v50, v51
    v_cvt_pk_bf16_f32 v157, v52, v53
    v_cvt_pk_bf16_f32 v158, v54, v55
    v_cvt_pk_bf16_f32 v159, v56, v57
    v_pk_mul_f32 v[60:61], v[44:45], v[38:39] op_sel:[1,1] op_sel_hi:[1,0] neg_lo:[1,0]
    v_pk_fma_f32 v[62:63], v[44:45], v[38:39], v[60:61] op_sel_hi:[0,1,1]
    v_pk_mul_f32 v[58:59], v[62:63], v[38:39] op_sel:[1,1] op_sel_hi:[1,0] neg_lo:[1,0]
    v_pk_fma_f32 v[168:169], v[62:63], v[38:39], v[58:59] op_sel_hi:[0,1,1]
    v_pk_mul_f32 v[60:61], v[168:169], v[38:39] op_sel:[1,1] op_sel_hi:[1,0] neg_lo:[1,0]
    v_pk_fma_f32 v[170:171], v[168:169], v[38:39], v[60:61] op_sel_hi:[0,1,1]
    ds_write_addtid_b32 v156 offset:44480
    ds_write_addtid_b32 v157 offset:44752
    ds_write_addtid_b32 v158 offset:45024
    ds_write_addtid_b32 v159 offset:45296
    ds_read_b128 v[68:71], v225 offset:0
    ds_read_b128 v[76:79], v225 offset:32
    s_add_u32 m0, s59, 7168
    s_nop 0
    global_load_lds_dwordx4 v210, s[34:35] sc1
    s_mov_b32 m0, s70
    v_cvt_pk_bf16_f32 v156, v44, v45
L_padB_1:
    s_cbranch_execz L_padB_5
    v_cvt_pk_bf16_f32 v157, v62, v63
    v_cvt_pk_bf16_f32 v158, v168, v169
    v_cvt_pk_bf16_f32 v159, v170, v171
    v_pk_mul_f32 v[58:59], v[170:171], v[38:39] op_sel:[1,1] op_sel_hi:[1,0] neg_lo:[1,0]
    v_pk_fma_f32 v[172:173], v[170:171], v[38:39], v[58:59] op_sel_hi:[0,1,1]
    v_pk_mul_f32 v[60:61], v[172:173], v[38:39] op_sel:[1,1] op_sel_hi:[1,0] neg_lo:[1,0]
    v_pk_fma_f32 v[174:175], v[172:173], v[38:39], v[60:61] op_sel_hi:[0,1,1]
    v_pk_mul_f32 v[58:59], v[174:175], v[38:39] op_sel:[1,1] op_sel_hi:[1,0] neg_lo:[1,0]
    v_pk_fma_f32 v[144:145], v[174:175], v[38:39], v[58:59] op_sel_hi:[0,1,1]
    v_pk_mul_f32 v[60:61], v[144:145], v[38:39] op_sel:[1,1] op_sel_hi:[1,0] neg_lo:[1,0]
    v_pk_fma_f32 v[46:47], v[144:145], v[38:39], v[60:61] op_sel_hi:[0,1,1]
    ds_write_addtid_b32 v156 offset:45568
    ds_write_addtid_b32 v157 offset:45840
    ds_write_addtid_b32 v158 offset:46112
    ds_write_addtid_b32 v159 offset:46384
    ds_read_b128 v[84:87], v225 offset:64
    ds_read_b128 v[92:95], v225 offset:96
    s_add_u32 m0, s59, 20480
    s_nop 0
    global_load_lds_dwordx4 v176, s[34:35] sc1
    s_mov_b32 m0, s70
    v_add_u32 v176, 164864, v176
    v_cvt_pk_bf16_f32 v156, v172, v173
    v_cvt_pk_bf16_f32 v157, v174, v175
    v_cvt_pk_bf16_f32 v158, v144, v145
    v_cvt_pk_bf16_f32 v159, v46, v47
    v_pk_mul_f32 v[58:59], v[46:47], v[38:39] op_sel:[1,1] op_sel_hi:[1,0] neg_lo:[1,0]
    v_pk_fma_f32 v[48:49], v[46:47], v[38:39], v[58:59] op_sel_hi:[0,1,1]
    v_pk_mul_f32 v[60:61], v[44:45], v[42:43] op_sel:[1,1] op_sel_hi:[1,0] neg_lo:[1,0]
    v_pk_fma_f32 v[50:51], v[44:45], v[42:43], v[60:61] op_sel_hi:[0,1,1]
    v_pk_mul_f32 v[58:59], v[168:169], v[42:43] op_sel:[1,1] op_sel_hi:[1,0] neg_lo:[1,0]
    v_pk_fma_f32 v[52:53], v[168:169], v[42:43], v[58:59] op_sel_hi:[0,1,1]
    v_pk_mul_f32 v[60:61], v[172:173], v[42:43] op_sel:[1,1] op_sel_hi:[1,0] neg_lo:[1,0]
    v_pk_fma_f32 v[54:55], v[172:173], v[42:43], v[60:61] op_sel_hi:[0,1,1]
    v_pk_mul_f32 v[58:59], v[144:145], v[42:43] op_sel:[1,1] op_sel_hi:[1,0] neg_lo:[1,0]
    v_pk_fma_f32 v[56:57], v[144:145], v[42:43], v[58:59] op_sel_hi:[0,1,1]
    ds_write_addtid_b32 v156 offset:46656
    ds_write_addtid_b32 v157 offset:46928
    ds_write_addtid_b32 v158 offset:47200
    ds_write_addtid_b32 v159 offset:47472
    ds_read_b128 v[100:103], v225 offset:128
    ds_read_b128 v[108:111], v225 offset:160
    s_add_u32 m0, s59, 21504
    s_nop 0
    global_load_lds_dwordx4 v176, s[34:35] sc1
    s_mov_b32 m0, s70
    v_add_u32 v176, 164864, v176
    v_cvt_pk_bf16_f32 v156, v50, v51
    v_cvt_pk_bf16_f32 v157, v52, v53
    v_cvt_pk_bf16_f32 v158, v54, v55
    v_cvt_pk_bf16_f32 v159, v56, v57
    v_pk_mul_f32 v[58:59], v[48:49], v[42:43] op_sel:[1,1] op_sel_hi:[1,0] neg_lo:[1,0]
    v_pk_fma_f32 v[62:63], v[48:49], v[42:43], v[58:59] op_sel_hi:[0,1,1]
    v_pk_mul_f32 v[60:61], v[54:55], v[42:43] op_sel:[1,1] op_sel_hi:[1,0] neg_lo:[1,0]
    v_pk_fma_f32 v[170:171], v[54:55], v[42:43], v[60:61] op_sel_hi:[0,1,1]
    v_pk_mul_f32 v[58:59], v[62:63], v[42:43] op_sel:[1,1] op_sel_hi:[1,0] neg_lo:[1,0]
    v_pk_fma_f32 v[174:175], v[62:63], v[42:43], v[58:59] op_sel_hi:[0,1,1]
    v_pk_mul_f32 v[60:61], v[170:171], v[42:43] op_sel:[1,1] op_sel_hi:[1,0] neg_lo:[1,0]
    v_pk_fma_f32 v[168:169], v[170:171], v[42:43], v[60:61] op_sel_hi:[0,1,1]
    ds_write_addtid_b32 v156 offset:47744
    ds_write_addtid_b32 v157 offset:48016
    ds_write_addtid_b32 v158 offset:48288
    ds_write_addtid_b32 v158 offset:48832
    ds_write_addtid_b32 v159 offset:49104
    ds_read_b128 v[116:119], v225 offset:192
    s_add_u32 m0, s59, 22528
    s_nop 0
    global_load_lds_dwordx4 v176, s[34:35] sc1
    s_mov_b32 m0, s70
    v_add_u32 v176, 164864, v176
    v_cvt_pk_bf16_f32 v156, v62, v63
    v_cvt_pk_bf16_f32 v157, v170, v171
    v_cvt_pk_bf16_f32 v158, v174, v175
    v_cvt_pk_bf16_f32 v159, v168, v169
    v_pk_mul_f32 v[58:59], v[174:175], v[42:43] op_sel:[1,1] op_sel_hi:[1,0] neg_lo:[1,0]
    v_pk_fma_f32 v[172:173], v[174:175], v[42:43], v[58:59] op_sel_hi:[0,1,1]
    v_pk_mul_f32 v[60:61], v[172:173], v[42:43] op_sel:[1,1] op_sel_hi:[1,0] neg_lo:[1,0]
    v_pk_fma_f32 v[144:145], v[172:173], v[42:43], v[60:61] op_sel_hi:[0,1,1]
    v_pk_mul_f32 v[58:59], v[144:145], v[42:43] op_sel:[1,1] op_sel_hi:[1,0] neg_lo:[1,0]
    v_pk_fma_f32 v[46:47], v[144:145], v[42:43], v[58:59] op_sel_hi:[0,1,1]
    v_pk_mul_f32 v[60:61], v[46:47], v[42:43] op_sel:[1,1] op_sel_hi:[1,0] neg_lo:[1,0]
    v_pk_fma_f32 v[50:51], v[46:47], v[42:43], v[60:61] op_sel_hi:[0,1,1]
    v_pk_mul_f32 v[58:59], v[50:51], v[42:43] op_sel:[1,1] op_sel_hi:[1,0] neg_lo:[1,0]
    v_pk_fma_f32 v[52:53], v[50:51], v[42:43], v[58:59] op_sel_hi:[0,1,1]
    ds_write_addtid_b32 v156 offset:49376
    ds_write_addtid_b32 v157 offset:49920
    ds_write_addtid_b32 v158 offset:50192
    ds_write_addtid_b32 v159 offset:51008
    ds_read_b128 v[124:127], v225 offset:224
    s_add_u32 m0, s59, 23552
    s_nop 0
    global_load_lds_dwordx4 v176, s[34:35] sc1
    s_mov_b32 m0, s70
    v_cvt_pk_bf16_f32 v156, v172, v173
    v_cvt_pk_bf16_f32 v157, v144, v145
    v_cvt_pk_bf16_f32 v158, v46, v47
    v_cvt_pk_bf16_f32 v159, v50, v51
    v_cvt_pk_bf16_f32 v160, v52, v53
    ds_write_addtid_b32 v156 offset:51280
    ds_write_addtid_b32 v157 offset:50464
    ds_write_addtid_b32 v158 offset:48560
    ds_write_addtid_b32 v159 offset:51552
    ds_write_addtid_b32 v160 offset:49648
    ds_read_b128 v[64:67], v224 offset:8704
    ds_read_b128 v[72:75], v224 offset:8736
    ds_read_b128 v[80:83], v224 offset:8768
    ds_read_b128 v[88:91], v224 offset:8800
    ds_read_b128 v[96:99], v224 offset:8832
    ds_read_b128 v[104:107], v224 offset:8864
    ds_read_b128 v[112:115], v224 offset:8896
    ds_read_b128 v[120:123], v224 offset:8928
    ds_write_b128 v233, v[190:193]
    s_lshl_b32 s48, s37, 15
    s_mul_i32 s49, s36, 1536
    s_add_u32 s48, s48, s49
    s_add_u32 s48, s48, 4204544
    v_min_u32 v211, 23, v1
    v_lshl_add_u32 v211, v211, 6, s48
    s_add_u32 s4, s34, s67
    s_addc_u32 s5, s35, 0
    s_add_u32 s6, s4, 8192
    s_addc_u32 s7, s5, 0
    s_add_u32 s67, s39, 1
    s_and_b32 s67, s67, 3
    s_mul_i32 s67, s67, 15360
    s_add_u32 s67, s67, s60
    s_add_u32 s8, s34, s67
    s_addc_u32 s9, s35, 0
    s_add_u32 s10, s8, 8192
    s_addc_u32 s11, s9, 0
    s_add_u32 s67, s39, 2
    s_and_b32 s67, s67, 3
    s_mul_i32 s67, s67, 15360
    s_add_u32 s67, s67, s60
    s_add_u32 s12, s34, s67
    s_addc_u32 s13, s35, 0
    s_add_u32 s14, s12, 8192
    s_addc_u32 s15, s13, 0
    s_add_u32 s67, s39, 3
    s_and_b32 s67, s67, 3
    s_mul_i32 s67, s67, 15360
    s_add_u32 s67, s67, s60
    s_add_u32 s16, s34, s67
    s_addc_u32 s17, s35, 0
    s_add_u32 s18, s16, 8192
    s_addc_u32 s19, s17, 0
    s_lshl_b32 s68, s36, 4
    v_xor_b32 v200, s68, v200
    v_xor_b32 v201, s68, v201
    v_xor_b32 v202, s68, v202
    v_xor_b32 v203, s68, v203
    v_xor_b32 v204, s68, v204
    v_xor_b32 v205, s68, v205
    v_xor_b32 v206, s68, v206
    v_xor_b32 v207, s68, v207
    v_xor_b32 v208, s68, v208
    s_waitcnt vmcnt(0)
    s_barrier
    s_waitcnt lgkmcnt(8)
    v_mfma_f32_32x32x16_bf16 v[128:143], v[64:67], v[68:71], v[128:143]
    v_add_u32 v226, s55, v226
    v_add_u32 v227, s55, v227
    v_add_u32 v228, s55, v228
    v_add_u32 v229, s55, v229
    v_add_u32 v230, s55, v230
    s_waitcnt lgkmcnt(7)
    v_mfma_f32_32x32x16_bf16 v[128:143], v[72:75], v[76:79], v[128:143]
    v_add_u32 v231, s55, v231
    v_add_u32 v232, s55, v232
    v_add_u32 v216, s55, v216
    v_add_u32 v217, s55, v217
    v_add_u32 v218, s55, v218
    s_waitcnt lgkmcnt(6)
    v_mfma_f32_32x32x16_bf16 v[128:143], v[80:83], v[84:87], v[128:143]
    v_add_u32 v219, s55, v219
    v_add_u32 v220, s55, v220
    v_add_u32 v221, s55, v221
    v_add_u32 v222, s55, v222
    v_add_u32 v223, s55, v223
    s_waitcnt lgkmcnt(5)
    v_mfma_f32_32x32x16_bf16 v[128:143], v[88:91], v[92:95], v[128:143]
    ds_read_b128 v[2:5], v204 offset:2048
    ds_read_b128 v[86:89], v200 offset:2048
    s_lshl_b32 s68, s50, 2
    s_and_b32 s68, s68, 32
    v_xor_b32 v209, s68, v209
    s_lshl_b32 s68, s50, 6
    v_add_u32 v209, s68, v209
    s_waitcnt lgkmcnt(6)
    v_mfma_f32_32x32x16_bf16 v[128:143], v[96:99], v[100:103], v[128:143]
    ds_read_b128 v[144:147], v214 offset:18432
    ds_read_b128 v[148:151], v215 offset:18432
    s_mul_i32 s69, s38, -448
    s_mul_i32 s48, s37, 1216
    s_add_u32 s69, s69, s48
    s_lshl_b32 s48, s2, 7
    s_add_u32 s48, s48, 262144
    s_waitcnt lgkmcnt(7)
    v_mfma_f32_32x32x16_bf16 v[128:143], v[104:107], v[108:111], v[128:143]
    ds_read_b128 v[6:9], v204 offset:6144
    ds_read_b128 v[152:155], v214 offset:22528
    s_sub_u32 s48, s48, s69
    v_lshrrev_b32 v199, 4, v0
    v_cmp_eq_u32 vcc, 4, v199
    v_lshl_add_u32 v199, v1, 3, s48
    s_nop 0
    v_cndmask_b32 v199, v177, v199, vcc
    s_waitcnt lgkmcnt(8)
    v_mfma_f32_32x32x16_bf16 v[128:143], v[112:115], v[116:119], v[128:143]
    ds_read_b128 v[156:159], v215 offset:22528
    ds_read_b128 v[10:13], v204 offset:10240
    s_add_u32 s48, s69, 5177344
    v_add_u32 v177, s48, v177
    s_min_u32 s48, s2, 1
    s_lshl_b32 s48, s48, 30
    v_lshrrev_b32 v198, 4, v0
    s_waitcnt lgkmcnt(9)
    v_mfma_f32_32x32x16_bf16 v[128:143], v[120:123], v[124:127], v[128:143]
    ds_read_b128 v[160:163], v214 offset:26624
    ds_read_b128 v[164:167], v215 offset:26624
    v_cmp_eq_u32 vcc, 4, v198
    v_lshl_add_u32 v198, v1, 3, s48
    s_nop 0
    v_cndmask_b32 v198, v177, v198, vcc
    ds_read_b128 v[14:17], v204 offset:14336
    ds_read_b128 v[168:171], v214 offset:30720
    ds_read_b128 v[172:175], v215 offset:30720
    ds_read_b128 v[100:103], v208 offset:0
    ds_read_b128 v[18:21], v205 offset:2048
    s_nop 0
    ds_read_b128 v[140:143], v201 offset:2048
    ds_read_b128 v[22:25], v205 offset:6144
    ds_read_b128 v[26:29], v205 offset:10240
    v_cmp_eq_u32 vcc, 0, v1
    s_mov_b32 s71, 0xffff
    s_nop 0
    v_cndmask_b32 v196, 0, v196, vcc
    v_add_f32 v128, v128, v196
    v_cvt_pk_bf16_f32 v180, v128, v129
    v_cvt_pk_bf16_f32 v181, v130, v131
    ds_write_b64 v226, v[180:181] offset:13392
    ds_read_b64 v[92:93], v229 offset:13384
    ds_read_b64 v[94:95], v229 offset:13392
    ds_read_b128 v[30:33], v205 offset:14336
    v_cvt_pk_bf16_f32 v182, v132, v132
    v_cvt_pk_bf16_f32 v183, v133, v134
    v_cvt_pk_bf16_f32 v184, v134, v134
    v_cvt_pk_bf16_f32 v185, v134, 0
    v_cvt_pk_bf16_f32 v186, 0, v137
    v_cvt_pk_bf16_f32 v187, v137, 0
    v_cvt_pk_bf16_f32 v188, v137, v136
    v_cvt_pk_bf16_f32 v189, v138, v135
    ds_write_b64 v226, v[182:183] offset:13904
    ds_write_b32 v227, v188 offset:21132
    ds_write_b16 v228, v189 offset:21630
    ds_write_b16_d16_hi v228, v189 offset:21566
    s_mov_b32 exec_lo, 0
    s_mov_b32 exec_hi, 0x80000000
    ds_write_b64 v226, v[184:185] offset:13912
    ds_write_b32 v226, v186 offset:13932
    ds_write_b32 v226, v187 offset:13936
    s_mov_b64 exec, -1
    s_waitcnt lgkmcnt(8)
    v_bfi_b32 v128, s71, v94, v93
    v_bfi_b32 v129, s71, v93, v92
    v_alignbit_b32 v130, v94, v94, 16
    v_alignbit_b32 v131, v93, v93, 16
    v_bfi_b32 v132, s71, v95, v94
    v_mov_b32 v133, v128
    v_alignbit_b32 v134, v95, v95, 16
    v_mov_b32 v135, v130
    ds_write_b128 v230, v[128:131] offset:15088
    ds_write_b128 v230, v[132:135] offset:15104
    s_mov_b32 s70, 327680
    buffer_load_dwordx2 v[234:235], v211, s[40:43], s70 offen sc1
    ds_read_b64 v[50:51], v216 offset:18432
    ds_read_b64 v[52:53], v216 offset:15600
    ds_read_b64 v[54:55], v216 offset:18400
    ds_read_b64 v[68:69], v216 offset:17920
    ds_read_b64 v[70:71], v216 offset:15088
    ds_read_b64 v[72:73], v216 offset:17888
    ds_read_b64 v[96:97], v229 offset:13896
    ds_read_b64 v[98:99], v229 offset:13904
    ds_read_b64 v[56:57], v216 offset:18560
    ds_read_b64 v[58:59], v216 offset:15728
    ds_read_b64 v[60:61], v216 offset:18528
    ds_read_b64 v[74:75], v216 offset:18048
    ds_read_b64 v[76:77], v216 offset:15216
    ds_read_b64 v[78:79], v216 offset:18016
    ds_read_b64 v[92:93], v231 offset:13376
    ds_read_b64 v[94:95], v231 offset:13384
    s_waitcnt lgkmcnt(10)
    v_mfma_f32_16x16x32_bf16 v[144:147], v[52:55], v[2:5], v[144:147]
    ds_read_b64 v[62:63], v216 offset:18688
    v_mfma_f32_16x16x32_bf16 v[148:151], v[50:53], v[2:5], v[148:151]
    ds_read_b64 v[64:65], v216 offset:15856
    v_mfma_f32_16x16x32_bf16 v[144:147], v[70:73], v[86:89], v[144:147]
    ds_read_b64 v[66:67], v216 offset:18656
    s_waitcnt lgkmcnt(11)
    v_bfi_b32 v128, s71, v98, v97
    v_mfma_f32_16x16x32_bf16 v[148:151], v[68:71], v[86:89], v[148:151]
    ds_read_b128 v[34:37], v206 offset:2048
    v_bfi_b32 v129, s71, v97, v96
    v_mfma_f32_16x16x32_bf16 v[152:155], v[52:55], v[6:9], v[152:155]
    ds_read_b128 v[180:183], v200 offset:2048
    v_alignbit_b32 v130, v98, v98, 16
    v_mfma_f32_16x16x32_bf16 v[156:159], v[50:53], v[6:9], v[156:159]
    ds_read_b64 v[80:81], v216 offset:18176
    v_alignbit_b32 v131, v97, v97, 16
    v_mfma_f32_16x16x32_bf16 v[160:163], v[52:55], v[10:13], v[160:163]
    ds_read_b64 v[82:83], v216 offset:15344
    v_bfi_b32 v132, s71, v99, v98
    v_mfma_f32_16x16x32_bf16 v[164:167], v[50:53], v[10:13], v[164:167]
    ds_read_b64 v[84:85], v216 offset:18144
    v_mov_b32 v133, v128
    v_alignbit_b32 v134, v99, v99, 16
    v_mfma_f32_16x16x32_bf16 v[168:171], v[52:55], v[14:17], v[168:171]
    ds_read_b128 v[136:139], v202 offset:2048
    v_mov_b32 v135, v130
    s_waitcnt vmcnt(0)
    v_cmp_ne_u64 vcc, s[44:45], v[234:235]
    v_mfma_f32_16x16x32_bf16 v[172:175], v[50:53], v[14:17], v[172:175]
    s_nop 0
    s_cbranch_vccnz L_retry_3
L_seen_4:
    ds_write_b128 v230, v[128:131] offset:16112
    v_mfma_f32_16x16x32_bf16 v[108:111], v[236:239], v[100:103], 0
    s_barrier
    v_mfma_f32_16x16x32_bf16 v[112:115], v[240:243], v[100:103], 0
    s_waitcnt lgkmcnt(12)
    ds_read_b128 v[38:41], v206 offset:6144
    v_mfma_f32_16x16x32_bf16 v[144:147], v[58:61], v[18:21], v[144:147]
    ds_read_b128 v[42:45], v206 offset:10240
    v_mfma_f32_16x16x32_bf16 v[148:151], v[56:59], v[18:21], v[148:151]
    ds_read_b128 v[46:49], v206 offset:14336
    global_load_dwordx4 a[0:3], v252, s[4:5] offset:-4096 sc1
    v_mfma_f32_16x16x32_bf16 v[144:147], v[76:79], v[140:143], v[144:147]
    ds_read_b128 v[104:107], v208 offset:2048
    v_mfma_f32_16x16x32_bf16 v[148:151], v[74:77], v[140:143], v[148:151]
    ds_read_b64 v[50:51], v216 offset:18816
    v_mfma_f32_16x16x32_bf16 v[152:155], v[58:61], v[22:25], v[152:155]
    ds_read_b64 v[52:53], v216 offset:15984
    global_load_dwordx4 a[4:7], v252, s[4:5] offset:-3072 sc1
    v_mfma_f32_16x16x32_bf16 v[156:159], v[56:59], v[22:25], v[156:159]
    ds_read_b64 v[54:55], v216 offset:18784
    v_cvt_pk_bf16_f32 v124, v108, v109
    v_mfma_f32_16x16x32_bf16 v[160:163], v[58:61], v[26:29], v[160:163]
    ds_read_b128 v[2:5], v207 offset:2048
    v_cvt_pk_bf16_f32 v125, v110, v111
    v_mfma_f32_16x16x32_bf16 v[164:167], v[56:59], v[26:29], v[164:167]
    ds_read_b64 v[68:69], v216 offset:18304
    ds_read_b128 v[184:187], v212 offset:18432
    v_mfma_f32_16x16x32_bf16 v[168:171], v[58:61], v[30:33], v[168:171]
    ds_read_b64 v[70:71], v216 offset:15472
    ds_read_b128 v[188:191], v213 offset:18432
    global_load_dwordx4 a[8:11], v252, s[4:5] offset:-2048 sc1
    v_mfma_f32_16x16x32_bf16 v[172:175], v[56:59], v[30:33], v[172:175]
    ds_read_b64 v[72:73], v216 offset:18272
    v_cvt_pk_bf16_f32 v126, v112, v113
    v_mfma_f32_16x16x32_bf16 v[116:119], v[244:247], v[100:103], 0
    ds_read_b128 v[86:89], v203 offset:2048
    v_cvt_pk_bf16_f32 v127, v114, v115
    v_mfma_f32_16x16x32_bf16 v[120:123], v[248:251], v[100:103], 0
    s_waitcnt lgkmcnt(10)
    ds_read_b128 v[6:9], v207 offset:6144
    ds_write_b128 v230, v[132:135] offset:16128
    v_mfma_f32_16x16x32_bf16 v[144:147], v[64:67], v[34:37], v[144:147]
    ds_write_b64 v217, v[124:125] offset:0
    v_mfma_f32_16x16x32_bf16 v[148:151], v[62:65], v[34:37], v[148:151]
    s_waitcnt lgkmcnt(5)
    ds_read_b128 v[10:13], v207 offset:10240
    ds_write_b64 v217, v[126:127] offset:3328
    v_mfma_f32_16x16x32_bf16 v[144:147], v[82:85], v[136:139], v[144:147]
    ds_read_b128 v[14:17], v207 offset:14336
    global_load_dwordx4 a[12:15], v252, s[4:5] offset:-1024 sc1
    v_cvt_pk_bf16_f32 v124, v116, v117
    v_cvt_pk_bf16_f32 v125, v118, v119
    v_mfma_f32_16x16x32_bf16 v[148:151], v[80:83], v[136:139], v[148:151]
    ds_read_b64 v[56:57], v216 offset:18944
    global_load_dwordx4 a[16:19], v252, s[4:5] offset:0 sc1
    v_cvt_pk_bf16_f32 v126, v120, v121
    v_cvt_pk_bf16_f32 v127, v122, v123
    v_mfma_f32_16x16x32_bf16 v[152:155], v[64:67], v[38:41], v[152:155]
    ds_read_b64 v[58:59], v216 offset:16112
    v_lshlrev_b32 v192, 16, v180
    v_and_b32 v193, 0xffff0000, v180
    v_lshlrev_b32 v194, 16, v181
    v_and_b32 v195, 0xffff0000, v181
    v_mfma_f32_16x16x32_bf16 v[156:159], v[62:65], v[38:41], v[156:159]
    ds_read_b64 v[60:61], v216 offset:18912
    v_fmac_f32 v144, v184, v192
    v_mfma_f32_16x16x32_bf16 v[160:163], v[64:67], v[42:45], v[160:163]
    ds_read_b128 v[18:21], v200 offset:0
    v_fmac_f32 v145, v185, v193
    v_mfma_f32_16x16x32_bf16 v[164:167], v[62:65], v[42:45], v[164:167]
    ds_read_b64 v[74:75], v216 offset:19456
    global_load_dwordx4 a[20:23], v252, s[4:5] offset:1024 sc1
    v_mfma_f32_16x16x32_bf16 v[168:171], v[64:67], v[46:49], v[168:171]
    ds_read_b64 v[76:77], v216 offset:16624
    v_fmac_f32 v146, v186, v194
    v_mfma_f32_16x16x32_bf16 v[172:175], v[62:65], v[46:49], v[172:175]
    ds_read_b64 v[78:79], v216 offset:19424
    v_fmac_f32 v147, v187, v195
    v_mfma_f32_16x16x32_bf16 v[108:111], v[236:239], v[104:107], 0
    ds_read_b128 v[140:143], v204 offset:0
    global_load_dwordx4 a[24:27], v252, s[4:5] offset:2048 sc1
    v_mfma_f32_16x16x32_bf16 v[112:115], v[240:243], v[104:107], 0
    s_waitcnt lgkmcnt(8)
    ds_read_b128 v[22:25], v200 offset:4096
    v_lshlrev_b32 v192, 16, v182
    v_mfma_f32_16x16x32_bf16 v[144:147], v[52:55], v[2:5], v[144:147]
    ds_read_b128 v[26:29], v200 offset:8192
    ds_write_b64 v217, v[124:125] offset:6656
    v_mfma_f32_16x16x32_bf16 v[148:151], v[50:53], v[2:5], v[148:151]
    ds_read_b128 v[30:33], v200 offset:12288
    ds_write_b64 v217, v[126:127] offset:10048
    v_mfma_f32_16x16x32_bf16 v[144:147], v[70:73], v[86:89], v[144:147]
    ds_read_b128 v[100:103], v208 offset:4096
    global_load_dwordx4 a[28:31], v252, s[4:5] offset:3072 sc1
    v_mfma_f32_16x16x32_bf16 v[148:151], v[68:71], v[86:89], v[148:151]
    ds_read_b64 v[62:63], v216 offset:19072
    v_and_b32 v193, 0xffff0000, v182
    v_mfma_f32_16x16x32_bf16 v[152:155], v[52:55], v[6:9], v[152:155]
    ds_read_b64 v[64:65], v216 offset:16240
    v_lshlrev_b32 v194, 16, v183
    v_mfma_f32_16x16x32_bf16 v[156:159], v[50:53], v[6:9], v[156:159]
    ds_read_b64 v[66:67], v216 offset:19040
    v_and_b32 v195, 0xffff0000, v183
    v_bfi_b32 v128, s71, v94, v93
    v_mfma_f32_16x16x32_bf16 v[160:163], v[52:55], v[10:13], v[160:163]
    ds_read_b128 v[34:37], v201 offset:0
    global_load_dwordx4 a[32:35], v252, s[6:7] offset:-4096 sc1
    v_bfi_b32 v129, s71, v93, v92
    v_mfma_f32_16x16x32_bf16 v[164:167], v[50:53], v[10:13], v[164:167]
    ds_read_b64 v[80:81], v216 offset:19584
    v_cvt_pk_bf16_f32 v124, v108, v109
    v_cvt_pk_bf16_f32 v125, v110, v111
    v_mfma_f32_16x16x32_bf16 v[168:171], v[52:55], v[14:17], v[168:171]
    ds_read_b64 v[82:83], v216 offset:16752
    v_cvt_pk_bf16_f32 v126, v112, v113
    v_cvt_pk_bf16_f32 v127, v114, v115
    v_mfma_f32_16x16x32_bf16 v[172:175], v[50:53], v[14:17], v[172:175]
    ds_read_b64 v[84:85], v216 offset:19552
    global_load_dwordx4 a[36:39], v252, s[6:7] offset:-3072 sc1
    v_alignbit_b32 v130, v94, v94, 16
    v_mfma_f32_16x16x32_bf16 v[116:119], v[244:247], v[104:107], 0
    ds_read_b128 v[136:139], v205 offset:0
    v_fmac_f32 v148, v188, v192
    v_fmac_f32 v149, v189, v193
    v_mfma_f32_16x16x32_bf16 v[120:123], v[248:251], v[104:107], 0
    s_waitcnt lgkmcnt(8)
    ds_read_b128 v[38:41], v201 offset:4096
    v_fmac_f32 v150, v190, v194
    v_fmac_f32 v151, v191, v195
    v_mfma_f32_16x16x32_bf16 v[144:147], v[58:61], v[18:21], v[144:147]
    ds_read_b128 v[42:45], v201 offset:8192
    ds_write_b64 v217, v[124:125] offset:128
    v_mfma_f32_16x16x32_bf16 v[148:151], v[56:59], v[18:21], v[148:151]
    ds_write_b64 v217, v[126:127] offset:3456
    v_mfma_f32_16x16x32_bf16 v[144:147], v[76:79], v[140:143], v[144:147]
    ds_read_b128 v[46:49], v201 offset:12288
    global_load_dwordx4 a[40:43], v252, s[6:7] offset:-2048 sc1
    v_mfma_f32_16x16x32_bf16 v[148:151], v[74:77], v[140:143], v[148:151]
    ds_read_b64 v[50:51], v216 offset:19200
    v_alignbit_b32 v131, v93, v93, 16
    v_mfma_f32_16x16x32_bf16 v[152:155], v[58:61], v[22:25], v[152:155]
    ds_read_b64 v[52:53], v216 offset:16368
    v_bfi_b32 v132, s71, v95, v94
    v_mfma_f32_16x16x32_bf16 v[156:159], v[56:59], v[22:25], v[156:159]
    ds_read_b64 v[54:55], v216 offset:19168
    global_load_dwordx4 a[44:47], v252, s[6:7] offset:-1024 sc1
    v_mfma_f32_16x16x32_bf16 v[160:163], v[58:61], v[26:29], v[160:163]
    ds_read_b128 v[2:5], v202 offset:0
    v_mov_b32 v133, v128
    v_mfma_f32_16x16x32_bf16 v[164:167], v[56:59], v[26:29], v[164:167]
    ds_read_b64 v[68:69], v216 offset:19712
    v_alignbit_b32 v134, v95, v95, 16
    v_mfma_f32_16x16x32_bf16 v[168:171], v[58:61], v[30:33], v[168:171]
    ds_read_b64 v[70:71], v216 offset:16880
    global_load_dwordx4 a[60:63], v252, s[8:9] offset:-4096 sc1
    v_mfma_f32_16x16x32_bf16 v[172:175], v[56:59], v[30:33], v[172:175]
    ds_read_b64 v[72:73], v216 offset:19680
    v_mov_b32 v135, v130
    v_mfma_f32_16x16x32_bf16 v[108:111], v[236:239], v[100:103], 0
    ds_read_b128 v[86:89], v206 offset:0
    v_cvt_pk_bf16_f32 v124, v116, v117
    v_cvt_pk_bf16_f32 v125, v118, v119
    v_mfma_f32_16x16x32_bf16 v[112:115], v[240:243], v[100:103], 0
    s_waitcnt lgkmcnt(8)
    ds_read_b128 v[6:9], v202 offset:4096
    v_cvt_pk_bf16_f32 v126, v120, v121
    v_cvt_pk_bf16_f32 v127, v122, v123
    v_mfma_f32_16x16x32_bf16 v[144:147], v[64:67], v[34:37], v[144:147]
    ds_read_b128 v[10:13], v202 offset:8192
    ds_write_b64 v217, v[124:125] offset:6784
    v_mfma_f32_16x16x32_bf16 v[148:151], v[62:65], v[34:37], v[148:151]
    ds_read_b128 v[14:17], v202 offset:12288
    ds_write_b64 v217, v[126:127] offset:10176
    v_mfma_f32_16x16x32_bf16 v[144:147], v[82:85], v[136:139], v[144:147]
    ds_read_b128 v[104:107], v208 offset:6144
    global_load_dwordx4 a[64:67], v252, s[8:9] offset:-3072 sc1
    v_mfma_f32_16x16x32_bf16 v[148:151], v[80:83], v[136:139], v[148:151]
    ds_read_b64 v[56:57], v216 offset:19328
    v_mfma_f32_16x16x32_bf16 v[152:155], v[64:67], v[38:41], v[152:155]
    ds_read_b64 v[58:59], v216 offset:16496
    global_load_dwordx4 a[68:71], v252, s[8:9] offset:-2048 sc1
    v_mfma_f32_16x16x32_bf16 v[156:159], v[62:65], v[38:41], v[156:159]
    ds_read_b64 v[60:61], v216 offset:19296
    v_mfma_f32_16x16x32_bf16 v[160:163], v[64:67], v[42:45], v[160:163]
    ds_read_b128 v[18:21], v203 offset:0
    v_cvt_pk_bf16_f32 v124, v108, v109
    v_mfma_f32_16x16x32_bf16 v[164:167], v[62:65], v[42:45], v[164:167]
    ds_read_b64 v[74:75], v216 offset:19840
    global_load_dwordx4 a[72:75], v252, s[8:9] offset:-1024 sc1
    v_mfma_f32_16x16x32_bf16 v[168:171], v[64:67], v[46:49], v[168:171]
    ds_read_b64 v[76:77], v216 offset:17008
    v_cvt_pk_bf16_f32 v125, v110, v111
    v_mfma_f32_16x16x32_bf16 v[172:175], v[62:65], v[46:49], v[172:175]
    ds_read_b64 v[78:79], v216 offset:19808
    v_cvt_pk_bf16_f32 v126, v112, v113
    v_mfma_f32_16x16x32_bf16 v[116:119], v[244:247], v[100:103], 0
    ds_read_b128 v[140:143], v207 offset:0
    v_cvt_pk_bf16_f32 v127, v114, v115
    v_mfma_f32_16x16x32_bf16 v[120:123], v[248:251], v[100:103], 0
    s_waitcnt lgkmcnt(8)
    ds_read_b128 v[22:25], v203 offset:4096
    global_load_dwordx4 a[76:79], v252, s[8:9] offset:0 sc1
    v_mfma_f32_16x16x32_bf16 v[144:147], v[52:55], v[2:5], v[144:147]
    ds_read_b128 v[26:29], v203 offset:8192
    ds_write_b64 v217, v[124:125] offset:256
    v_mfma_f32_16x16x32_bf16 v[148:151], v[50:53], v[2:5], v[148:151]
    ds_write_b64 v217, v[126:127] offset:3584
    v_mfma_f32_16x16x32_bf16 v[144:147], v[70:73], v[86:89], v[144:147]
    ds_read_b128 v[30:33], v203 offset:12288
    global_load_dwordx4 a[80:83], v252, s[8:9] offset:1024 sc1
    v_mfma_f32_16x16x32_bf16 v[148:151], v[68:71], v[86:89], v[148:151]
    ds_read_b64 v[62:63], v216 offset:19456
    v_mfma_f32_16x16x32_bf16 v[152:155], v[52:55], v[6:9], v[152:155]
    ds_read_b64 v[64:65], v216 offset:16624
    v_cvt_pk_bf16_f32 v124, v116, v117
    v_mfma_f32_16x16x32_bf16 v[156:159], v[50:53], v[6:9], v[156:159]
    ds_read_b64 v[66:67], v216 offset:19424
    v_cvt_pk_bf16_f32 v125, v118, v119
    v_mfma_f32_16x16x32_bf16 v[160:163], v[52:55], v[10:13], v[160:163]
    ds_read_b128 v[38:41], v204 offset:4096
    global_load_dwordx4 a[84:87], v252, s[8:9] offset:2048 sc1
    v_mfma_f32_16x16x32_bf16 v[164:167], v[50:53], v[10:13], v[164:167]
    ds_write_b64 v217, v[124:125] offset:6912
    v_mfma_f32_16x16x32_bf16 v[168:171], v[52:55], v[14:17], v[168:171]
    v_cvt_pk_bf16_f32 v126, v120, v121
    v_mfma_f32_16x16x32_bf16 v[172:175], v[50:53], v[14:17], v[172:175]
    ds_read_b128 v[42:45], v204 offset:8192
    v_cvt_pk_bf16_f32 v127, v122, v123
    v_mfma_f32_16x16x32_bf16 v[108:111], v[236:239], v[104:107], 0
    ds_read_b128 v[46:49], v204 offset:12288
    global_load_dwordx4 a[88:91], v252, s[8:9] offset:3072 sc1
    v_mfma_f32_16x16x32_bf16 v[112:115], v[240:243], v[104:107], 0
    s_waitcnt lgkmcnt(7)
    ds_write_b64 v217, v[126:127] offset:10304
    v_mfma_f32_16x16x32_bf16 v[144:147], v[58:61], v[18:21], v[144:147]
    v_mfma_f32_16x16x32_bf16 v[148:151], v[56:59], v[18:21], v[148:151]
    ds_read_b128 v[100:103], v208 offset:8192
    global_load_dwordx4 a[92:95], v252, s[10:11] offset:-4096 sc1
    v_mfma_f32_16x16x32_bf16 v[144:147], v[76:79], v[140:143], v[144:147]
    ds_read_b64 v[50:51], v216 offset:19584
    v_cvt_pk_bf16_f32 v124, v108, v109
    v_mfma_f32_16x16x32_bf16 v[148:151], v[74:77], v[140:143], v[148:151]
    ds_read_b64 v[52:53], v216 offset:16752
    v_cvt_pk_bf16_f32 v125, v110, v111
    v_mfma_f32_16x16x32_bf16 v[152:155], v[58:61], v[22:25], v[152:155]
    ds_read_b128 v[180:183], v200 offset:6144
    v_cvt_pk_bf16_f32 v126, v112, v113
    v_cvt_pk_bf16_f32 v127, v114, v115
    v_mfma_f32_16x16x32_bf16 v[156:159], v[56:59], v[22:25], v[156:159]
    ds_read_b64 v[54:55], v216 offset:19552
    ds_read_b128 v[184:187], v212 offset:22528
    global_load_dwordx4 a[96:99], v252, s[10:11] offset:-3072 sc1
    v_mfma_f32_16x16x32_bf16 v[160:163], v[58:61], v[26:29], v[160:163]
L_padB_2:
    s_cbranch_execz L_padB_6
    s_mov_b32 s68, 7340032
    ds_read_b128 v[188:191], v213 offset:22528
    v_cvt_pk_bf16_f32 v86, v144, v145
    v_cvt_pk_bf16_f32 v87, v146, v147
    v_mfma_f32_16x16x32_bf16 v[164:167], v[56:59], v[26:29], v[164:167]
    ds_read_b128 v[6:9], v205 offset:4096
    v_cvt_pk_bf16_f32 v88, v148, v149
    v_cvt_pk_bf16_f32 v89, v150, v151
    v_mfma_f32_16x16x32_bf16 v[168:171], v[58:61], v[30:33], v[168:171]
    buffer_store_dwordx4 v[86:89], v209, s[40:43], s68 offen sc1
    v_mfma_f32_16x16x32_bf16 v[172:175], v[56:59], v[30:33], v[172:175]
    ds_write_b64 v217, v[124:125] offset:384
    v_mfma_f32_16x16x32_bf16 v[116:119], v[244:247], v[104:107], 0
    global_load_dwordx4 a[100:103], v252, s[10:11] offset:-2048 sc1
    v_mfma_f32_16x16x32_bf16 v[120:123], v[248:251], v[104:107], 0
    s_waitcnt lgkmcnt(8)
    s_waitcnt lgkmcnt(2)
    ds_read_b128 v[10:13], v205 offset:8192
    v_mfma_f32_16x16x32_bf16 v[152:155], v[64:67], v[38:41], v[152:155]
    ds_read_b128 v[14:17], v205 offset:12288
    global_load_dwordx4 a[104:107], v252, s[10:11] offset:-1024 sc1
    v_lshlrev_b32 v192, 16, v180
    v_mfma_f32_16x16x32_bf16 v[156:159], v[62:65], v[38:41], v[156:159]
    ds_read_b128 v[104:107], v208 offset:10240
    ds_write_b64 v217, v[126:127] offset:3712
    v_mfma_f32_16x16x32_bf16 v[160:163], v[64:67], v[42:45], v[160:163]
    v_and_b32 v193, 0xffff0000, v180
    v_lshlrev_b32 v194, 16, v181
    v_and_b32 v195, 0xffff0000, v181
    v_mfma_f32_16x16x32_bf16 v[164:167], v[62:65], v[42:45], v[164:167]
    ds_read_b64 v[56:57], v216 offset:19712
    v_cvt_pk_bf16_f32 v124, v116, v117
    v_mfma_f32_16x16x32_bf16 v[168:171], v[64:67], v[46:49], v[168:171]
    ds_read_b64 v[58:59], v216 offset:16880
    global_load_dwordx4 a[120:123], v252, s[12:13] offset:-4096 sc1
    v_cvt_pk_bf16_f32 v125, v118, v119
    v_mfma_f32_16x16x32_bf16 v[172:175], v[62:65], v[46:49], v[172:175]
    ds_read_b64 v[60:61], v216 offset:19680
    v_fmac_f32 v152, v184, v192
    v_fmac_f32 v153, v185, v193
    v_mfma_f32_16x16x32_bf16 v[108:111], v[236:239], v[100:103], 0
    ds_read_b128 v[22:25], v206 offset:4096
    v_fmac_f32 v154, v186, v194
    v_fmac_f32 v155, v187, v195
    v_mfma_f32_16x16x32_bf16 v[112:115], v[240:243], v[100:103], 0
    s_waitcnt lgkmcnt(6)
    ds_read_b128 v[26:29], v206 offset:8192
    v_cvt_pk_bf16_f32 v126, v120, v121
    v_mfma_f32_16x16x32_bf16 v[152:155], v[52:55], v[6:9], v[152:155]
    ds_read_b64 v[62:63], v216 offset:19840
    ds_write_b128 v232, v[128:131] offset:14960
    ds_write_b128 v232, v[132:135] offset:14976
    v_mfma_f32_16x16x32_bf16 v[156:159], v[50:53], v[6:9], v[156:159]
    global_load_dwordx4 a[124:127], v252, s[12:13] offset:-3072 sc1
    v_cvt_pk_bf16_f32 v127, v122, v123
    v_lshlrev_b32 v192, 16, v182
    v_mfma_f32_16x16x32_bf16 v[160:163], v[52:55], v[10:13], v[160:163]
    ds_read_b128 v[30:33], v206 offset:12288
    v_and_b32 v193, 0xffff0000, v182
    v_lshlrev_b32 v194, 16, v183
    v_mfma_f32_16x16x32_bf16 v[164:167], v[50:53], v[10:13], v[164:167]
    ds_read_b64 v[64:65], v216 offset:17008
    global_load_dwordx4 a[128:131], v252, s[12:13] offset:-2048 sc1
    v_and_b32 v195, 0xffff0000, v183
    v_mfma_f32_16x16x32_bf16 v[168:171], v[52:55], v[14:17], v[168:171]
    ds_read_b64 v[66:67], v216 offset:19808
    ds_write_b64 v217, v[124:125] offset:7040
    v_fmac_f32 v156, v188, v192
    v_fmac_f32 v157, v189, v193
    v_mfma_f32_16x16x32_bf16 v[172:175], v[50:53], v[14:17], v[172:175]
    ds_write_b64 v217, v[126:127] offset:10432
    ds_read_b128 v[180:183], v200 offset:10240
    ds_read_b128 v[184:187], v212 offset:26624
    v_fmac_f32 v158, v190, v194
    v_fmac_f32 v159, v191, v195
    ds_read_b128 v[188:191], v213 offset:26624
    s_waitcnt lgkmcnt(15)
    v_mfma_f32_16x16x32_bf16 v[116:119], v[236:239], v[104:107], 0
    v_cvt_pk_bf16_f32 v124, v108, v109
    v_cvt_pk_bf16_f32 v125, v110, v111
    v_mfma_f32_16x16x32_bf16 v[120:123], v[240:243], v[104:107], 0
    s_waitcnt lgkmcnt(7)
    ds_read_b128 v[38:41], v207 offset:4096
    global_load_dwordx4 a[132:135], v252, s[12:13] offset:-1024 sc1
    v_mfma_f32_16x16x32_bf16 v[152:155], v[58:61], v[22:25], v[152:155]
    ds_read_b128 v[42:45], v207 offset:8192
    v_cvt_pk_bf16_f32 v126, v112, v113
    v_mfma_f32_16x16x32_bf16 v[156:159], v[56:59], v[22:25], v[156:159]
    ds_read_b128 v[46:49], v207 offset:12288
    v_cvt_pk_bf16_f32 v127, v114, v115
    v_mfma_f32_16x16x32_bf16 v[160:163], v[58:61], v[26:29], v[160:163]
    s_waitcnt lgkmcnt(3)
    ds_read_b64 v[50:51], v216 offset:18176
    v_lshlrev_b32 v192, 16, v180
    v_and_b32 v193, 0xffff0000, v180
    v_mfma_f32_16x16x32_bf16 v[164:167], v[56:59], v[26:29], v[164:167]
    ds_read_b64 v[52:53], v216 offset:15344
    global_load_dwordx4 a[136:139], v252, s[12:13] offset:0 sc1
    v_lshlrev_b32 v194, 16, v181
    v_and_b32 v195, 0xffff0000, v181
    v_mfma_f32_16x16x32_bf16 v[168:171], v[58:61], v[30:33], v[168:171]
    ds_read_b64 v[54:55], v216 offset:18144
    ds_write_b64 v217, v[124:125] offset:512
    v_mfma_f32_16x16x32_bf16 v[172:175], v[56:59], v[30:33], v[172:175]
    s_waitcnt lgkmcnt(4)
    ds_write_b64 v217, v[126:127] offset:3840
    v_fmac_f32 v160, v184, v192
    v_mfma_f32_16x16x32_bf16 v[152:155], v[64:67], v[38:41], v[152:155]
    ds_read_b128 v[6:9], v202 offset:6144
    global_load_dwordx4 a[140:143], v252, s[12:13] offset:1024 sc1
    v_fmac_f32 v161, v185, v193
    v_fmac_f32 v162, v186, v194
    v_fmac_f32 v163, v187, v195
    v_mfma_f32_16x16x32_bf16 v[156:159], v[62:65], v[38:41], v[156:159]
    ds_read_b128 v[10:13], v202 offset:10240
    v_cvt_pk_bf16_f32 v124, v116, v117
    v_mfma_f32_16x16x32_bf16 v[160:163], v[64:67], v[42:45], v[160:163]
    ds_read_b128 v[14:17], v202 offset:14336
    v_cvt_pk_bf16_f32 v125, v118, v119
    v_cvt_pk_bf16_f32 v126, v120, v121
    v_mfma_f32_16x16x32_bf16 v[164:167], v[62:65], v[42:45], v[164:167]
    ds_read_b64 v[56:57], v216 offset:18304
    v_cvt_pk_bf16_f32 v127, v122, v123
    v_lshlrev_b32 v192, 16, v182
    v_mfma_f32_16x16x32_bf16 v[168:171], v[64:67], v[46:49], v[168:171]
    ds_read_b64 v[58:59], v216 offset:15472
    global_load_dwordx4 a[144:147], v252, s[12:13] offset:2048 sc1
    v_and_b32 v193, 0xffff0000, v182
    v_mfma_f32_16x16x32_bf16 v[172:175], v[62:65], v[46:49], v[172:175]
    s_waitcnt lgkmcnt(2)
    ds_read_b64 v[60:61], v216 offset:18272
    v_lshlrev_b32 v194, 16, v183
    v_and_b32 v195, 0xffff0000, v183
    v_mfma_f32_16x16x32_bf16 v[152:155], v[52:55], v[6:9], v[152:155]
    ds_read_b128 v[22:25], v203 offset:6144
    ds_read_b64 v[62:63], v216 offset:17920
    ds_read_b64 v[64:65], v216 offset:15088
    ds_write_b64 v217, v[124:125] offset:640
    v_mfma_f32_16x16x32_bf16 v[156:159], v[50:53], v[6:9], v[156:159]
    ds_read_b128 v[26:29], v203 offset:10240
    ds_read_b64 v[66:67], v216 offset:17888
    ds_write_b64 v217, v[126:127] offset:3968
    ds_read_b128 v[180:183], v200 offset:14336
    ds_read_b128 v[184:187], v212 offset:30720
    v_fmac_f32 v164, v188, v192
    v_fmac_f32 v165, v189, v193
    v_fmac_f32 v166, v190, v194
    v_fmac_f32 v167, v191, v195
    ds_read_b128 v[188:191], v213 offset:30720
    v_mfma_f32_16x16x32_bf16 v[160:163], v[52:55], v[10:13], v[160:163]
    ds_read_b128 v[30:33], v203 offset:14336
    global_load_dwordx4 a[148:151], v252, s[12:13] offset:3072 sc1
    v_mfma_f32_16x16x32_bf16 v[164:167], v[50:53], v[10:13], v[164:167]
    ds_read_b128 v[34:37], v200 offset:2048
    ds_read_b128 v[38:41], v200 offset:6144
    v_mfma_f32_16x16x32_bf16 v[168:171], v[52:55], v[14:17], v[168:171]
    ds_read_b128 v[42:45], v200 offset:10240
    ds_read_b128 v[46:49], v200 offset:14336
    v_mfma_f32_16x16x32_bf16 v[172:175], v[50:53], v[14:17], v[172:175]
    s_waitcnt lgkmcnt(4)
    ds_read_b64 v[100:101], v216 offset:19968
    ds_read_b64 v[102:103], v216 offset:17136
    global_load_dwordx4 a[152:155], v252, s[14:15] offset:-4096 sc1
    v_mfma_f32_16x16x32_bf16 v[152:155], v[58:61], v[22:25], v[152:155]
    ds_read_b64 v[104:105], v216 offset:19936
    ds_read_b64 v[106:107], v216 offset:20352
    v_lshlrev_b32 v192, 16, v180
    v_and_b32 v193, 0xffff0000, v180
    v_lshlrev_b32 v194, 16, v181
    v_and_b32 v195, 0xffff0000, v181
    v_mfma_f32_16x16x32_bf16 v[156:159], v[56:59], v[22:25], v[156:159]
    ds_read_b64 v[108:109], v216 offset:17520
    v_fmac_f32 v168, v184, v192
    v_fmac_f32 v169, v185, v193
    v_fmac_f32 v170, v186, v194
    v_mfma_f32_16x16x32_bf16 v[160:163], v[58:61], v[26:29], v[160:163]
    ds_read_b64 v[110:111], v216 offset:20320
    ds_read_b64 v[50:51], v216 offset:18048
    v_fmac_f32 v171, v187, v195
    v_mfma_f32_16x16x32_bf16 v[164:167], v[56:59], v[26:29], v[164:167]
    ds_read_b64 v[52:53], v216 offset:15216
    global_load_dwordx4 a[156:159], v252, s[14:15] offset:-3072 sc1
    v_lshlrev_b32 v192, 16, v182
    v_and_b32 v193, 0xffff0000, v182
    v_mfma_f32_16x16x32_bf16 v[168:171], v[58:61], v[30:33], v[168:171]
    ds_read_b64 v[54:55], v216 offset:18016
    ds_read_b128 v[2:5], v201 offset:2048
    v_lshlrev_b32 v194, 16, v183
    v_mfma_f32_16x16x32_bf16 v[172:175], v[56:59], v[30:33], v[172:175]
    s_waitcnt lgkmcnt(4)
    ds_read_b128 v[6:9], v201 offset:6144
    ds_read_b128 v[10:13], v201 offset:10240
    ds_read_b128 v[80:83], v222 offset:21120
    v_mfma_f32_16x16x32_bf16 v[152:155], v[64:67], v[38:41], v[152:155]
    s_add_u32 s48, s69, 4849664
    ds_read_b128 v[14:17], v201 offset:14336
    ds_read_b64 v[114:115], v216 offset:17264
    v_and_b32 v195, 0xffff0000, v183
    v_mfma_f32_16x16x32_bf16 v[156:159], v[62:65], v[38:41], v[156:159]
    s_waitcnt vmcnt(12)
    ds_read_b64 v[116:117], v216 offset:20064
    ds_read_b64 v[120:121], v216 offset:17648
    global_load_dwordx4 a[160:163], v252, s[14:15] offset:-2048 sc1
    v_mfma_f32_16x16x32_bf16 v[160:163], v[64:67], v[42:45], v[160:163]
    s_barrier
    ds_read_b64 v[122:123], v216 offset:20448
    ds_read_b128 v[76:79], v222 offset:21184
    v_fmac_f32 v172, v188, v192
    v_mfma_f32_16x16x32_bf16 v[164:167], v[62:65], v[42:45], v[164:167]
    ds_read_b64_tr_b16 v[18:19], v218 offset:0
    v_fmac_f32 v173, v189, v193
    v_fmac_f32 v174, v190, v194
    v_fmac_f32 v175, v191, v195
    v_mfma_f32_16x16x32_bf16 v[168:171], v[64:67], v[46:49], v[168:171]
    ds_read_b64_tr_b16 v[20:21], v218 offset:8
    global_load_dwordx4 a[164:167], v252, s[14:15] offset:-1024 sc1
    v_mfma_f32_16x16x32_bf16 v[172:175], v[62:65], v[46:49], v[172:175]
    ds_read_b64_tr_b16 v[22:23], v219 offset:0
    v_mfma_f32_16x16x32_bf16 v[152:155], v[102:105], v[34:37], v[152:155]
    buffer_store_dwordx2 v[178:179], v199, s[40:43], s48 offen sc1
    ds_read_b128 v[72:75], v222 offset:21248
    v_mfma_f32_16x16x32_bf16 v[156:159], v[100:103], v[34:37], v[156:159]
    ds_read_b64_tr_b16 v[24:25], v219 offset:8
    v_mfma_f32_16x16x32_bf16 v[160:163], v[102:105], v[38:41], v[160:163]
    ds_read_b128 v[68:71], v222 offset:21312
    global_load_dwordx4 a[180:183], v252, s[16:17] offset:-4096 sc1
    v_mfma_f32_16x16x32_bf16 v[164:167], v[100:103], v[38:41], v[164:167]
    ds_read_b64_tr_b16 v[26:27], v218 offset:64
    v_mfma_f32_16x16x32_bf16 v[168:171], v[102:105], v[42:45], v[168:171]
    ds_read_b128 v[96:99], v222 offset:20864
    v_mfma_f32_16x16x32_bf16 v[172:175], v[100:103], v[42:45], v[172:175]
    ds_read_b64_tr_b16 v[28:29], v218 offset:72
    global_load_dwordx4 a[184:187], v252, s[16:17] offset:-3072 sc1
    v_mfma_f32_16x16x32_bf16 v[160:163], v[108:111], v[34:37], v[160:163]
    ds_read_b128 v[92:95], v222 offset:20928
    v_mfma_f32_16x16x32_bf16 v[164:167], v[106:109], v[34:37], v[164:167]
    v_mfma_f32_16x16x32_bf16 v[168:171], v[108:111], v[38:41], v[168:171]
    ds_read_b64_tr_b16 v[30:31], v219 offset:64
    v_mfma_f32_16x16x32_bf16 v[172:175], v[106:109], v[38:41], v[172:175]
    s_waitcnt lgkmcnt(12)
    v_mfma_f32_16x16x32_bf16 v[152:155], v[52:55], v[6:9], v[152:155]
    ds_read_b64_tr_b16 v[32:33], v219 offset:72
    global_load_dwordx4 a[188:191], v252, s[16:17] offset:-2048 sc1
    v_mfma_f32_16x16x32_bf16 v[156:159], v[50:53], v[6:9], v[156:159]
    ds_read_b64_tr_b16 v[34:35], v218 offset:128
    v_mfma_f32_16x16x32_bf16 v[160:163], v[52:55], v[10:13], v[160:163]
    ds_read_b64_tr_b16 v[36:37], v218 offset:136
    v_mfma_f32_16x16x32_bf16 v[164:167], v[50:53], v[10:13], v[164:167]
    ds_read_b64_tr_b16 v[38:39], v219 offset:128
    global_load_dwordx4 a[192:195], v252, s[16:17] offset:-1024 sc1
    v_mfma_f32_16x16x32_bf16 v[168:171], v[52:55], v[14:17], v[168:171]
    ds_read_b128 v[88:91], v222 offset:20992
    v_mfma_f32_16x16x32_bf16 v[172:175], v[50:53], v[14:17], v[172:175]
    ds_read_b64_tr_b16 v[40:41], v219 offset:136
    ds_read_b64 v[128:129], v223 offset:21688
    v_mfma_f32_16x16x32_bf16 v[152:155], v[114:117], v[2:5], v[152:155]
    ds_read_b128 v[84:87], v222 offset:21056
    global_load_dwordx4 a[196:199], v252, s[16:17] offset:0 sc1
    v_mfma_f32_16x16x32_bf16 v[160:163], v[114:117], v[6:9], v[160:163]
    ds_read_b64_tr_b16 v[42:43], v218 offset:192
    v_mfma_f32_16x16x32_bf16 v[168:171], v[114:117], v[10:13], v[168:171]
    ds_read_b64_tr_b16 v[44:45], v218 offset:200
    ds_read_b64 v[130:131], v223 offset:21696
    v_mfma_f32_16x16x32_bf16 v[160:163], v[120:123], v[2:5], v[160:163]
    ds_read_b64 v[132:133], v223 offset:21624
    v_mfma_f32_16x16x32_bf16 v[168:171], v[120:123], v[6:9], v[168:171]
    s_waitcnt lgkmcnt(11)
    ds_read_b64_tr_b16 v[46:47], v219 offset:192
    global_load_dwordx4 a[200:203], v252, s[16:17] offset:1024 sc1
    v_mfma_f32_16x16x32_bf16 v[152:155], v[18:21], v[80:83], v[152:155]
    s_mul_i32 s57, s62, 40960
    s_mul_i32 s58, s39, 10240
    ds_read_b64_tr_b16 v[2:3], v220 offset:0
    v_mfma_f32_16x16x32_bf16 v[160:163], v[18:21], v[96:99], v[160:163]
    s_add_u32 s57, s57, s58
    s_add_u32 s57, s57, 7340032
    ds_read_b64_tr_b16 v[48:49], v219 offset:200
    v_mfma_f32_16x16x32_bf16 v[156:159], v[22:25], v[80:83], v[156:159]
    s_mul_i32 s58, s58, 3
    ds_read_b64_tr_b16 v[4:5], v220 offset:16
    v_add_u32 v117, s57, v252
    v_mfma_f32_16x16x32_bf16 v[164:167], v[22:25], v[96:99], v[164:167]
    s_lshl_b32 s46, s37, 15
    ds_read_b64_tr_b16 v[6:7], v221 offset:0
    ds_read_b64 v[134:135], v223 offset:21632
    v_mfma_f32_16x16x32_bf16 v[152:155], v[26:29], v[76:79], v[152:155]
    s_mul_i32 s47, s39, 2560
    ds_read_b64_tr_b16 v[8:9], v221 offset:16
    global_load_dwordx4 a[204:207], v252, s[16:17] offset:2048 sc1
    v_mfma_f32_16x16x32_bf16 v[160:163], v[26:29], v[92:95], v[160:163]
    s_add_u32 s47, s47, s46
    s_add_u32 s47, s47, 4849664
    ds_read_b64_tr_b16 v[10:11], v220 offset:128
    v_mfma_f32_16x16x32_bf16 v[156:159], v[30:33], v[76:79], v[156:159]
    ds_read_b64_tr_b16 v[12:13], v220 offset:144
    ds_read_b64 v[136:137], v223 offset:21560
    v_mfma_f32_16x16x32_bf16 v[164:167], v[30:33], v[92:95], v[164:167]
    s_waitcnt lgkmcnt(7)
    ds_read_b64 v[138:139], v223 offset:21568
    global_load_dwordx4 a[208:211], v252, s[16:17] offset:3072 sc1
    v_mfma_f32_16x16x32_bf16 v[152:155], v[34:37], v[72:75], v[152:155]
    ds_read_b64_tr_b16 v[14:15], v221 offset:128
    v_min_u32 v127, 39, v1
    v_mfma_f32_16x16x32_bf16 v[160:163], v[34:37], v[88:91], v[160:163]
    ds_read_b64_tr_b16 v[16:17], v221 offset:144
    v_lshl_add_u32 v127, v127, 6, s47
    v_mfma_f32_16x16x32_bf16 v[156:159], v[38:41], v[72:75], v[156:159]
    s_mul_i32 s47, s36, 1536
    ds_read_b64_tr_b16 v[18:19], v218 offset:256
    global_load_dwordx4 a[212:215], v252, s[18:19] offset:-4096 sc1
    v_mfma_f32_16x16x32_bf16 v[164:167], v[38:41], v[88:91], v[164:167]
    s_add_u32 s47, s47, s46
    s_add_u32 s47, s47, 4857344
    ds_read_b64_tr_b16 v[20:21], v218 offset:264
    v_mfma_f32_16x16x32_bf16 v[152:155], v[42:45], v[68:71], v[152:155]
    ds_read_b64_tr_b16 v[22:23], v219 offset:256
    ds_read_b64 v[140:141], v223 offset:21496
    ds_read_b64 v[142:143], v223 offset:21504
    v_mfma_f32_16x16x32_bf16 v[160:163], v[42:45], v[84:87], v[160:163]
    ds_read_b64_tr_b16 v[24:25], v219 offset:264
    v_cmp_lt_u32 s[28:29], 39, v1
    v_mfma_f32_16x16x32_bf16 v[156:159], v[46:49], v[68:71], v[156:159]
    ds_read_b64_tr_b16 v[26:27], v218 offset:320
    global_load_dwordx4 a[216:219], v252, s[18:19] offset:-3072 sc1
    v_mfma_f32_16x16x32_bf16 v[164:167], v[46:49], v[84:87], v[164:167]
    s_waitcnt lgkmcnt(7)
    ds_read_b64_tr_b16 v[28:29], v218 offset:328
    v_lshl_add_u32 v0, v1, 6, s47
    v_mfma_f32_16x16x32_bf16 v[160:163], v[2:5], v[132:135], v[160:163]
    ds_read_b64_tr_b16 v[30:31], v219 offset:320
    v_cndmask_b32 v0, v127, v0, s[28:29]
    s_waitcnt lgkmcnt(4)
    v_mfma_f32_16x16x32_bf16 v[168:171], v[2:5], v[140:143], v[168:171]
    s_mov_b32 s68, 7995392
    ds_read_b64_tr_b16 v[32:33], v219 offset:328
    global_load_dwordx4 a[220:223], v252, s[18:19] offset:-2048 sc1
    v_mfma_f32_16x16x32_bf16 v[164:167], v[6:9], v[132:135], v[164:167]
    ds_read_b64_tr_b16 v[34:35], v218 offset:384
    v_cvt_pk_bf16_f32 v184, v152, v153
    v_mfma_f32_16x16x32_bf16 v[172:175], v[6:9], v[140:143], v[172:175]
    ds_read_b64_tr_b16 v[36:37], v218 offset:392
    v_cvt_pk_bf16_f32 v185, v154, v155
    v_mfma_f32_16x16x32_bf16 v[160:163], v[10:13], v[128:131], v[160:163]
    ds_read_b64_tr_b16 v[38:39], v219 offset:384
    v_cvt_pk_bf16_f32 v186, v156, v157
    v_cvt_pk_bf16_f32 v187, v158, v159
    v_mfma_f32_16x16x32_bf16 v[168:171], v[10:13], v[136:139], v[168:171]
    buffer_store_dwordx4 v[184:187], v209, s[40:43], s68 offen sc1
    v_mfma_f32_16x16x32_bf16 v[164:167], v[14:17], v[128:131], v[164:167]
    ds_read_b64_tr_b16 v[40:41], v219 offset:392
    global_load_dwordx4 a[224:227], v252, s[18:19] offset:-1024 sc1
    v_mfma_f32_16x16x32_bf16 v[172:175], v[14:17], v[136:139], v[172:175]
    s_waitcnt lgkmcnt(4)
    ds_read_b64_tr_b16 v[42:43], v218 offset:448
    v_mfma_f32_16x16x32_bf16 v[160:163], v[18:21], v[80:83], v[160:163]
    ds_read_b64_tr_b16 v[44:45], v218 offset:456
    v_mfma_f32_16x16x32_bf16 v[168:171], v[18:21], v[96:99], v[168:171]
    ds_read_b64_tr_b16 v[46:47], v219 offset:448
    v_mfma_f32_16x16x32_bf16 v[164:167], v[22:25], v[80:83], v[164:167]
    ds_read_b64_tr_b16 v[48:49], v219 offset:456
    v_mfma_f32_16x16x32_bf16 v[172:175], v[22:25], v[96:99], v[172:175]
    ds_read_b64_tr_b16 v[2:3], v218 offset:512
    v_mfma_f32_16x16x32_bf16 v[160:163], v[26:29], v[76:79], v[160:163]
    ds_read_b64_tr_b16 v[4:5], v218 offset:520
    v_mfma_f32_16x16x32_bf16 v[168:171], v[26:29], v[92:95], v[168:171]
    ds_read_b64_tr_b16 v[6:7], v219 offset:512
    v_mfma_f32_16x16x32_bf16 v[164:167], v[30:33], v[76:79], v[164:167]
    ds_read_b64_tr_b16 v[8:9], v219 offset:520
    v_mfma_f32_16x16x32_bf16 v[172:175], v[30:33], v[92:95], v[172:175]
    s_waitcnt lgkmcnt(4)
    ds_read_b64_tr_b16 v[10:11], v218 offset:576
    v_mfma_f32_16x16x32_bf16 v[160:163], v[34:37], v[72:75], v[160:163]
    ds_read_b64_tr_b16 v[12:13], v218 offset:584
    ds_read_b64_tr_b16 v[14:15], v219 offset:576
    ds_read_b64_tr_b16 v[16:17], v219 offset:584
    v_mfma_f32_16x16x32_bf16 v[168:171], v[34:37], v[88:91], v[168:171]
    ds_read_b64_tr_b16 v[18:19], v218 offset:640
    v_mfma_f32_16x16x32_bf16 v[164:167], v[38:41], v[72:75], v[164:167]
    ds_read_b64_tr_b16 v[20:21], v218 offset:648
    v_mfma_f32_16x16x32_bf16 v[172:175], v[38:41], v[88:91], v[172:175]
    ds_read_b64_tr_b16 v[22:23], v219 offset:640
    v_mfma_f32_16x16x32_bf16 v[160:163], v[42:45], v[68:71], v[160:163]
    ds_read_b64_tr_b16 v[24:25], v219 offset:648
    v_mfma_f32_16x16x32_bf16 v[168:171], v[42:45], v[84:87], v[168:171]
    ds_read_b64_tr_b16 v[26:27], v218 offset:704
    v_mfma_f32_16x16x32_bf16 v[164:167], v[46:49], v[68:71], v[164:167]
    buffer_load_dwordx2 v[254:255], v0, s[40:43], 0 offen sc1
    ds_read_b64_tr_b16 v[28:29], v218 offset:712
    v_mfma_f32_16x16x32_bf16 v[172:175], v[46:49], v[84:87], v[172:175]
    s_waitcnt lgkmcnt(6)
    ds_read_b64_tr_b16 v[30:31], v219 offset:704
    v_mfma_f32_16x16x32_bf16 v[168:171], v[2:5], v[80:83], v[168:171]
    ds_read_b64_tr_b16 v[32:33], v219 offset:712
    ds_read_b64_tr_b16 v[34:35], v220 offset:256
    v_mfma_f32_16x16x32_bf16 v[172:175], v[6:9], v[80:83], v[172:175]
    s_mov_b32 s68, 8650752
    ds_read_b64_tr_b16 v[36:37], v220 offset:272
    ds_read_b64_tr_b16 v[38:39], v221 offset:256
    v_mfma_f32_16x16x32_bf16 v[168:171], v[10:13], v[76:79], v[168:171]
    ds_read_b64_tr_b16 v[40:41], v221 offset:272
    ds_read_b64_tr_b16 v[42:43], v220 offset:384
    v_mfma_f32_16x16x32_bf16 v[172:175], v[14:17], v[76:79], v[172:175]
    s_waitcnt lgkmcnt(5)
    ds_read_b64_tr_b16 v[44:45], v220 offset:400
    ds_read_b64_tr_b16 v[46:47], v221 offset:384
    v_mfma_f32_16x16x32_bf16 v[168:171], v[18:21], v[72:75], v[168:171]
    ds_read_b64_tr_b16 v[48:49], v221 offset:400
    v_cvt_pk_bf16_f32 v188, v160, v161
    v_mfma_f32_16x16x32_bf16 v[172:175], v[22:25], v[72:75], v[172:175]
    v_cvt_pk_bf16_f32 v189, v162, v163
    v_cvt_pk_bf16_f32 v190, v164, v165
    v_cvt_pk_bf16_f32 v191, v166, v167
    v_mfma_f32_16x16x32_bf16 v[168:171], v[26:29], v[68:71], v[168:171]
    buffer_store_dwordx4 v[188:191], v209, s[40:43], s68 offen sc1
    v_mfma_f32_16x16x32_bf16 v[172:175], v[30:33], v[68:71], v[172:175]
    s_waitcnt lgkmcnt(0)
    v_mfma_f32_16x16x32_bf16 v[168:171], v[34:37], v[132:135], v[168:171]
    v_mfma_f32_16x16x32_bf16 v[172:175], v[38:41], v[132:135], v[172:175]
    v_mfma_f32_16x16x32_bf16 v[168:171], v[42:45], v[128:131], v[168:171]
    v_mfma_f32_16x16x32_bf16 v[172:175], v[46:49], v[128:131], v[172:175]
    v_mov_b32 v94, 0x3f803f80
    v_mov_b32 v95, 0x3f803f80
    v_mov_b32 v96, 0x3f803f80
    v_mov_b32 v97, 0x3f803f80
    s_mov_b32 s68, 9306112
    s_nop 1
    v_cvt_pk_bf16_f32 v192, v168, v169
    v_cvt_pk_bf16_f32 v193, v170, v171
    v_cvt_pk_bf16_f32 v194, v172, v173
    v_cvt_pk_bf16_f32 v195, v174, v175
    buffer_store_dwordx4 v[192:195], v209, s[40:43], s68 offen sc1
    v_mfma_f32_16x16x32_bf16 v[82:85], a[0:3], v[94:97], 0
    s_add_u32 s22, s34, 4096
    s_addc_u32 s23, s35, 0
    s_add_u32 s24, s34, 8192
    s_addc_u32 s25, s35, 0
    v_mfma_f32_16x16x32_bf16 v[82:85], a[12:15], v[94:97], v[82:85]
    s_add_u32 s26, s34, 12288
    s_addc_u32 s27, s35, 0
    s_mov_b64 s[20:21], s[34:35]
    v_mfma_f32_16x16x32_bf16 v[82:85], a[24:27], v[94:97], v[82:85]
    s_and_b32 s68, s63, 7
    s_lshr_b32 s72, s63, 3
    v_mov_b32 v118, s44
    v_mfma_f32_16x16x32_bf16 v[82:85], a[36:39], v[94:97], v[82:85]
    v_mov_b32 v119, s45
    v_and_b32 v106, 15, v1
    v_mfma_f32_16x16x32_bf16 v[86:89], a[4:7], v[94:97], 0
    v_lshrrev_b32 v107, 4, v1
    v_bfe_u32 v108, v1, 2, 2
    v_mfma_f32_16x16x32_bf16 v[86:89], a[16:19], v[94:97], v[86:89]
    v_and_b32 v109, 3, v1
    v_lshlrev_b32 v110, 9, v107
    v_mfma_f32_16x16x32_bf16 v[86:89], a[28:31], v[94:97], v[86:89]
    v_lshl_add_u32 v110, v108, 6, v110
    v_lshl_add_u32 v110, v109, 3, v110
    v_mfma_f32_16x16x32_bf16 v[86:89], a[40:43], v[94:97], v[86:89]
    s_add_u32 s47, s39, 0
    v_and_b32 v111, 1, v107
    v_lshl_add_u32 v110, v111, 5, v110
    v_mfma_f32_16x16x32_bf16 v[90:93], a[8:11], v[94:97], 0
    s_and_b32 s47, s47, 3
    s_mul_i32 s47, s47, 30720
    v_add_u32 v2, s47, v110
    v_mfma_f32_16x16x32_bf16 v[90:93], a[20:23], v[94:97], v[90:93]
    s_add_u32 s47, s39, 1
    s_and_b32 s47, s47, 3
    v_xor_b32 v6, 32, v2
    v_mfma_f32_16x16x32_bf16 v[90:93], a[32:35], v[94:97], v[90:93]
    s_mul_i32 s47, s47, 30720
    v_add_u32 v3, s47, v110
    v_xor_b32 v7, 32, v3
    v_mfma_f32_16x16x32_bf16 v[90:93], a[44:47], v[94:97], v[90:93]
    s_add_u32 s47, s39, 2
    s_and_b32 s47, s47, 3
    s_mul_i32 s47, s47, 30720
    s_waitcnt vmcnt(2)
    v_cmp_ne_u64 vcc, s[44:45], v[254:255]
    s_nop 1
    s_cbranch_vccnz L_retry_5
L_seen_6:
    s_barrier
    s_mov_b32 s48, 327680
    buffer_store_dwordx2 v[178:179], v177, s[40:43], s48 offen sc1
    s_add_u32 m0, s58, 0
    s_nop 0
    global_load_lds_dwordx4 v117, s[20:21] offset:0 sc1
    v_mfma_f32_16x16x32_bf16 v[82:85], a[60:63], v[94:97], v[82:85]
    v_add_u32 v4, s47, v110
    v_xor_b32 v8, 32, v4
    v_mfma_f32_16x16x32_bf16 v[82:85], a[72:75], v[94:97], v[82:85]
    global_load_lds_dwordx4 v117, s[20:21] offset:1024 sc1
    s_add_u32 s47, s39, 3
    s_and_b32 s47, s47, 3
    s_mul_i32 s47, s47, 30720
    v_mfma_f32_16x16x32_bf16 v[82:85], a[84:87], v[94:97], v[82:85]
    global_load_lds_dwordx4 v117, s[20:21] offset:2048 sc1
    v_add_u32 v5, s47, v110
    v_xor_b32 v9, 32, v5
    v_mfma_f32_16x16x32_bf16 v[82:85], a[96:99], v[94:97], v[82:85]
    global_load_lds_dwordx4 v117, s[20:21] offset:3072 sc1
    v_mov_b32 v123, 0
    v_cmp_eq_u32 s[50:51], v107, v108
    v_mfma_f32_16x16x32_bf16 v[86:89], a[64:67], v[94:97], v[86:89]
    s_add_u32 m0, s58, 4096
    s_nop 0
    global_load_lds_dwordx4 v117, s[22:23] offset:0 sc1
    s_lshl_b32 s47, s36, 3
    s_add_u32 s47, s47, 122880
    v_cmp_gt_u32 s[52:53], 48, v1
    v_mfma_f32_16x16x32_bf16 v[86:89], a[76:79], v[94:97], v[86:89]
    global_load_lds_dwordx4 v117, s[22:23] offset:1024 sc1
    v_lshl_add_u32 v125, v106, 5, s47
    v_mov_b32 v111, 123904
    v_mfma_f32_16x16x32_bf16 v[86:89], a[88:91], v[94:97], v[86:89]
    global_load_lds_dwordx4 v117, s[22:23] offset:2048 sc1
    v_lshl_add_u32 v111, v1, 3, v111
    v_cndmask_b32 v125, v111, v125, s[50:51]
    v_mfma_f32_16x16x32_bf16 v[86:89], a[100:103], v[94:97], v[86:89]
    global_load_lds_dwordx4 v117, s[22:23] offset:3072 sc1
    v_lshlrev_b32 v126, 5, v106
    v_add_u32 v126, 122880, v126
    v_mfma_f32_16x16x32_bf16 v[90:93], a[68:71], v[94:97], v[90:93]
    s_add_u32 m0, s58, 8192
    s_nop 0
    global_load_lds_dwordx4 v117, s[24:25] offset:0 sc1
    s_mul_i32 s56, s62, 479232
    v_mov_b32 v111, 0x40000000
    v_cmp_gt_u32 s[50:51], 16, v1
    v_mfma_f32_16x16x32_bf16 v[90:93], a[80:83], v[94:97], v[90:93]
    global_load_lds_dwordx4 v117, s[24:25] offset:1024 sc1
    s_add_u32 s60, s56, 16777216
    s_lshl2_add_u32 s47, s63, s36
    s_mul_i32 s56, s47, 768
    v_mfma_f32_16x16x32_bf16 v[90:93], a[92:95], v[94:97], v[90:93]
    v_add_u32 v117, 655360, v117
    s_add_u32 s56, s56, s60
    s_mul_i32 s61, s47, -704
    s_add_u32 s61, s61, 48384
    v_mfma_f32_16x16x32_bf16 v[90:93], a[104:107], v[94:97], v[90:93]
    v_add_u32 v116, s61, v252
    v_cndmask_b32 v124, v116, v252, s[52:53]
    v_mfma_f32_16x16x32_bf16 v[82:85], a[120:123], v[94:97], v[82:85]
    s_add_u32 s61, s61, 768
    v_cmp_gt_u32 s[52:53], 52, v1
    v_lshrrev_b32 v116, 3, v1
    v_mfma_f32_16x16x32_bf16 v[82:85], a[132:135], v[94:97], v[82:85]
    v_mul_u32_u24 v116, 53184, v116
    v_lshl_add_u32 v116, v1, 3, v116
    v_mfma_f32_16x16x32_bf16 v[82:85], a[144:147], v[94:97], v[82:85]
    v_add_u32 v116, s61, v116
    v_cndmask_b32 v124, v111, v124, s[52:53]
    v_mfma_f32_16x16x32_bf16 v[82:85], a[156:159], v[94:97], v[82:85]
    v_cndmask_b32 v116, v111, v116, s[50:51]
    v_cmp_eq_u32 s[50:51], 1, v109
    v_mfma_f32_16x16x32_bf16 v[86:89], a[124:127], v[94:97], v[86:89]
    s_lshl2_add_u32 s59, s68, s36
    v_cmp_eq_u32 s[52:53], 2, v109
    v_cmp_eq_u32 s[54:55], 3, v109
    v_mfma_f32_16x16x32_bf16 v[86:89], a[136:139], v[94:97], v[86:89]
    s_mul_i32 s59, s59, 61440
    s_add_u32 s59, s59, 14680064
    s_mul_i32 s47, s72, 53248
    v_mfma_f32_16x16x32_bf16 v[86:89], a[148:151], v[94:97], v[86:89]
    s_add_u32 s60, s60, s47
    s_mul_i32 s47, s36, 12288
    s_add_u32 s60, s60, s47
    v_mfma_f32_16x16x32_bf16 v[86:89], a[160:163], v[94:97], v[86:89]
L_padB_3:
    s_cbranch_execz L_padB_7
    s_lshr_b32 s47, s68, 1
    s_mul_i32 s47, s47, 30720
    s_and_b32 s46, s68, 1
    v_mfma_f32_16x16x32_bf16 v[90:93], a[128:131], v[94:97], v[90:93]
    s_mul_i32 s46, s46, 5120
    s_add_u32 s47, s47, s46
    v_lshl_add_u32 v112, v107, 2, v108
    v_mfma_f32_16x16x32_bf16 v[90:93], a[140:143], v[94:97], v[90:93]
    v_lshlrev_b32 v112, 6, v112
    v_lshl_add_u32 v112, v109, 3, v112
    v_mfma_f32_16x16x32_bf16 v[90:93], a[152:155], v[94:97], v[90:93]
    v_lshrrev_b32 v113, 1, v107
    v_xor_b32 v113, s72, v113
    v_mfma_f32_16x16x32_bf16 v[90:93], a[164:167], v[94:97], v[90:93]
    v_lshl_add_u32 v112, v113, 5, v112
    v_add_u32 v112, s47, v112
    v_mfma_f32_16x16x32_bf16 v[82:85], a[180:183], v[94:97], v[82:85]
    v_mul_u32_u24 v113, 176, v106
    v_lshl_add_u32 v113, v107, 3, v113
    v_mfma_f32_16x16x32_bf16 v[82:85], a[192:195], v[94:97], v[82:85]
    s_mul_i32 s33, s36, 6144
    s_add_u32 s33, s33, 139264
    v_add_u32 v113, 124928, v113
    v_mfma_f32_16x16x32_bf16 v[82:85], a[204:207], v[94:97], v[82:85]
    s_mov_b32 s32, 0x3acccccd
    v_mfma_f32_16x16x32_bf16 v[82:85], a[216:219], v[94:97], v[82:85]
    v_mfma_f32_16x16x32_bf16 v[86:89], a[184:187], v[94:97], v[86:89]
    v_mfma_f32_16x16x32_bf16 v[86:89], a[196:199], v[94:97], v[86:89]
    v_mfma_f32_16x16x32_bf16 v[86:89], a[208:211], v[94:97], v[86:89]
    v_mfma_f32_16x16x32_bf16 v[86:89], a[220:223], v[94:97], v[86:89]
    v_mfma_f32_16x16x32_bf16 v[90:93], a[188:191], v[94:97], v[90:93]
    v_mfma_f32_16x16x32_bf16 v[90:93], a[200:203], v[94:97], v[90:93]
    v_mfma_f32_16x16x32_bf16 v[90:93], a[212:215], v[94:97], v[90:93]
    v_mfma_f32_16x16x32_bf16 v[90:93], a[224:227], v[94:97], v[90:93]
    v_mov_b32 v114, 0x3727c5ac
L_join:
    global_load_dwordx4 a[48:51], v252, s[6:7] offset:0 sc1
    global_load_dwordx4 a[52:55], v252, s[6:7] offset:1024 sc1
    global_load_dwordx4 a[56:59], v252, s[6:7] offset:2048 sc1
    global_load_dwordx4 a[108:111], v252, s[10:11] offset:0 sc1
    global_load_dwordx4 a[112:115], v252, s[10:11] offset:1024 sc1
    global_load_dwordx4 a[116:119], v252, s[10:11] offset:2048 sc1
    global_load_dwordx4 a[168:171], v252, s[14:15] offset:0 sc1
    v_lshl_add_u32 v108, s36, 10, v112
    v_lshl_add_u32 v109, s36, 5, v113
    s_waitcnt vmcnt(15)
    ds_read_b64_tr_b16 v[10:11], v2 offset:0
    ds_read_b64_tr_b16 v[12:13], v2 offset:256
    s_waitcnt vmcnt(13)
    ds_read_b64_tr_b16 v[14:15], v2 offset:2048
    ds_read_b64_tr_b16 v[16:17], v2 offset:2304
    s_waitcnt lgkmcnt(2)
    v_mfma_f32_16x16x32_bf16 v[78:81], v[10:13], v[10:13], 0
    s_waitcnt vmcnt(11)
    ds_read_b64_tr_b16 v[18:19], v2 offset:4096
    v_mfma_f32_16x16x32_bf16 v[74:77], v[94:97], v[10:13], 0
    ds_read_b64_tr_b16 v[20:21], v2 offset:4352
    v_mfma_f32_16x16x32_bf16 v[58:61], a[8:11], v[10:13], 0
    v_mfma_f32_16x16x32_bf16 v[54:57], a[4:7], v[10:13], 0
    v_mfma_f32_16x16x32_bf16 v[50:53], a[0:3], v[10:13], 0
    s_waitcnt lgkmcnt(2)
    v_mfma_f32_16x16x32_bf16 v[78:81], v[14:17], v[14:17], v[78:81]
    s_waitcnt vmcnt(9)
    ds_read_b64_tr_b16 v[22:23], v2 offset:6144
    v_mfma_f32_16x16x32_bf16 v[74:77], v[94:97], v[14:17], v[74:77]
    ds_read_b64_tr_b16 v[24:25], v2 offset:6400
    v_mfma_f32_16x16x32_bf16 v[58:61], a[20:23], v[14:17], v[58:61]
    v_mfma_f32_16x16x32_bf16 v[54:57], a[16:19], v[14:17], v[54:57]
    v_mfma_f32_16x16x32_bf16 v[50:53], a[12:15], v[14:17], v[50:53]
    s_waitcnt lgkmcnt(2)
    v_mfma_f32_16x16x32_bf16 v[78:81], v[18:21], v[18:21], v[78:81]
    s_waitcnt vmcnt(7)
    ds_read_b64_tr_b16 v[26:27], v2 offset:8192
    v_mfma_f32_16x16x32_bf16 v[74:77], v[94:97], v[18:21], v[74:77]
    s_barrier
    ds_read_b64_tr_b16 v[28:29], v2 offset:8448
    v_mfma_f32_16x16x32_bf16 v[58:61], a[32:35], v[18:21], v[58:61]
    buffer_store_dwordx2 v[118:119], v198, s[40:43], 0 offen sc1
    v_mfma_f32_16x16x32_bf16 v[54:57], a[28:31], v[18:21], v[54:57]
    ds_read_b64_tr_b16 v[30:31], v3 offset:0
    v_mfma_f32_16x16x32_bf16 v[50:53], a[24:27], v[18:21], v[50:53]
    ds_read_b64_tr_b16 v[32:33], v3 offset:256
    global_load_dwordx4 a[172:175], v252, s[14:15] offset:1024 sc1
    s_waitcnt lgkmcnt(4)
    v_mfma_f32_16x16x32_bf16 v[78:81], v[22:25], v[22:25], v[78:81]
    ds_read_b64_tr_b16 v[34:35], v3 offset:2048
    v_mfma_f32_16x16x32_bf16 v[74:77], v[94:97], v[22:25], v[74:77]
    s_mov_b32 s73, 655360
    ds_read_b64_tr_b16 v[36:37], v3 offset:2304
    buffer_load_dwordx2 v[254:255], v127, s[40:43], s73 offen sc1
    v_mfma_f32_16x16x32_bf16 v[58:61], a[44:47], v[22:25], v[58:61]
    ds_read_b64_tr_b16 v[38:39], v3 offset:4096
    global_load_dwordx4 a[176:179], v252, s[14:15] offset:2048 sc1
    v_mfma_f32_16x16x32_bf16 v[54:57], a[40:43], v[22:25], v[54:57]
    ds_read_b64_tr_b16 v[40:41], v3 offset:4352
    v_mfma_f32_16x16x32_bf16 v[50:53], a[36:39], v[22:25], v[50:53]
    ds_read_b64_tr_b16 v[42:43], v3 offset:6144
    s_waitcnt lgkmcnt(7)
    v_mfma_f32_16x16x32_bf16 v[78:81], v[26:29], v[26:29], v[78:81]
    ds_read_b64_tr_b16 v[44:45], v3 offset:6400
    global_load_dwordx4 a[228:231], v252, s[18:19] offset:0 sc1
    v_mfma_f32_16x16x32_bf16 v[74:77], v[94:97], v[26:29], v[74:77]
    ds_read_b64_tr_b16 v[46:47], v3 offset:8192
    s_waitcnt vmcnt(9)
    v_mfma_f32_16x16x32_bf16 v[58:61], a[56:59], v[26:29], v[58:61]
    ds_read_b64_tr_b16 v[48:49], v3 offset:8448
    v_mfma_f32_16x16x32_bf16 v[54:57], a[52:55], v[26:29], v[54:57]
    ds_read_b64_tr_b16 v[110:111], v108 offset:0
    v_mfma_f32_16x16x32_bf16 v[50:53], a[48:51], v[26:29], v[50:53]
    global_load_dwordx4 a[232:235], v252, s[18:19] offset:1024 sc1
    v_cndmask_b32 v75, v78, v79, s[50:51]
    v_mfma_f32_16x16x32_bf16 v[82:85], a[48:51], v[94:97], v[82:85]
    v_cndmask_b32 v75, v75, v80, s[52:53]
    v_cndmask_b32 v75, abs(v75), abs(v81), s[54:55]
    v_mfma_f32_16x16x32_bf16 v[86:89], a[52:55], v[94:97], v[86:89]
    ds_write_b64 v125, v[74:75] offset:0
    v_mfma_f32_16x16x32_bf16 v[90:93], a[56:59], v[94:97], v[90:93]
    s_waitcnt lgkmcnt(8)
    v_mfma_f32_16x16x32_bf16 v[50:53], a[60:63], v[30:33], v[50:53]
    s_mul_i32 s48, s36, -11264
    ds_read_b64_tr_b16 v[10:11], v4 offset:0
    global_load_dwordx4 a[236:239], v252, s[18:19] offset:2048 sc1
    v_mfma_f32_16x16x32_bf16 v[50:53], a[72:75], v[34:37], v[50:53]
    s_waitcnt lgkmcnt(5)
    s_add_u32 s70, s60, s48
    ds_read_b64_tr_b16 v[12:13], v4 offset:256
    v_mfma_f32_16x16x32_bf16 v[50:53], a[84:87], v[38:41], v[50:53]
    s_add_u32 s70, s70, 102400
    s_mov_b32 s46, 0
    s_add_u32 s48, s46, 0
    s_and_b32 s48, s48, 3
    v_mfma_f32_16x16x32_bf16 v[50:53], a[96:99], v[42:45], v[50:53]
    s_waitcnt lgkmcnt(4)
    s_mul_i32 s71, s48, 15360
    ds_read_b64_tr_b16 v[14:15], v4 offset:2048
    s_waitcnt vmcnt(10)
    v_mfma_f32_16x16x32_bf16 v[50:53], a[108:111], v[46:49], v[50:53]
    s_add_u32 s4, s59, s71
    s_mul_i32 s71, s48, 3072
    ds_read_b64_tr_b16 v[16:17], v4 offset:2304
    v_mfma_f32_16x16x32_bf16 v[54:57], a[64:67], v[30:33], v[54:57]
    s_add_u32 s71, s71, s60
    s_add_u32 s8, s34, s71
    s_addc_u32 s9, s35, 0
    s_add_u32 s48, s46, 1
    v_mfma_f32_16x16x32_bf16 v[54:57], a[76:79], v[34:37], v[54:57]
    s_and_b32 s48, s48, 3
    s_mul_i32 s71, s48, 15360
    ds_read_b64_tr_b16 v[18:19], v4 offset:4096
    v_mfma_f32_16x16x32_bf16 v[54:57], a[88:91], v[38:41], v[54:57]
    s_waitcnt lgkmcnt(5)
    s_barrier
    s_add_u32 s5, s59, s71
    ds_read_b64_tr_b16 v[20:21], v4 offset:4352
    v_mfma_f32_16x16x32_bf16 v[54:57], a[100:103], v[42:45], v[54:57]
    s_mul_i32 s71, s48, 3072
    s_add_u32 s71, s71, s60
    ds_read_b128 v[74:77], v126 offset:0
    s_waitcnt vmcnt(9)
    v_mfma_f32_16x16x32_bf16 v[54:57], a[112:115], v[46:49], v[54:57]
    s_add_u32 s10, s34, s71
    s_addc_u32 s11, s35, 0
    ds_read_b128 v[78:81], v126 offset:16
    v_mfma_f32_16x16x32_bf16 v[58:61], a[68:71], v[30:33], v[58:61]
    s_add_u32 s48, s46, 2
    s_and_b32 s48, s48, 3
    s_mul_i32 s71, s48, 15360
    ds_read_b64_tr_b16 v[22:23], v4 offset:6144
    v_mfma_f32_16x16x32_bf16 v[58:61], a[80:83], v[34:37], v[58:61]
    s_add_u32 s6, s59, s71
    s_mul_i32 s71, s48, 3072
    ds_read_b64_tr_b16 v[24:25], v4 offset:6400
    v_mfma_f32_16x16x32_bf16 v[58:61], a[92:95], v[38:41], v[58:61]
    s_add_u32 s71, s71, s60
    s_add_u32 s12, s34, s71
    s_addc_u32 s13, s35, 0
    ds_read_b64_tr_b16 v[26:27], v4 offset:8192
    v_mfma_f32_16x16x32_bf16 v[58:61], a[104:107], v[42:45], v[58:61]
    s_add_u32 s48, s46, 3
    s_and_b32 s48, s48, 3
    ds_read_b64_tr_b16 v[28:29], v4 offset:8448
    s_waitcnt vmcnt(8)
    v_mfma_f32_16x16x32_bf16 v[58:61], a[116:119], v[46:49], v[58:61]
    s_mul_i32 s71, s48, 15360
    ds_write_b64 v109, v[110:111] offset:0
    v_mfma_f32_16x16x32_bf16 v[82:85], a[108:111], v[94:97], v[82:85]
    s_waitcnt lgkmcnt(5)
    v_add_f32 v74, v74, v76
    v_add_f32 v75, v75, v77
    v_mfma_f32_16x16x32_bf16 v[86:89], a[112:115], v[94:97], v[86:89]
    s_add_u32 s7, s59, s71
    ds_read_b64_tr_b16 v[110:111], v112 offset:4096
    v_add_f32 v78, v78, v80
    v_mfma_f32_16x16x32_bf16 v[90:93], a[116:119], v[94:97], v[90:93]
    v_add_f32 v79, v79, v81
    v_add_f32 v74, v74, v78
    v_mfma_f32_16x16x32_bf16 v[58:61], a[128:131], v[10:13], v[58:61]
    s_mul_i32 s71, s48, 3072
    s_add_u32 s71, s71, s60
    ds_read_b64_tr_b16 v[30:31], v5 offset:0
    v_mfma_f32_16x16x32_bf16 v[58:61], a[140:143], v[14:17], v[58:61]
    s_waitcnt lgkmcnt(5)
    s_add_u32 s14, s34, s71
    s_addc_u32 s15, s35, 0
    ds_read_b64_tr_b16 v[32:33], v5 offset:256
    v_mfma_f32_16x16x32_bf16 v[58:61], a[152:155], v[18:21], v[58:61]
    v_add_f32 v75, v75, v79
    s_waitcnt vmcnt(4)
    v_cmp_ne_u64 vcc, s[44:45], v[254:255]
    v_mfma_f32_16x16x32_bf16 v[58:61], a[164:167], v[22:25], v[58:61]
    s_waitcnt lgkmcnt(4)
    s_cbranch_vccnz L_retry_11
L_seen_12:
    ds_read_b64_tr_b16 v[34:35], v5 offset:2048
    s_waitcnt vmcnt(3)
    v_mfma_f32_16x16x32_bf16 v[58:61], a[176:179], v[26:29], v[58:61]
    s_add_u32 m0, s58, 10240
    ds_read_b64_tr_b16 v[36:37], v5 offset:2304
    global_load_lds_dwordx4 v117, s[20:21] offset:0 sc1
    v_mfma_f32_16x16x32_bf16 v[54:57], a[124:127], v[10:13], v[54:57]
    v_mul_f32 v98, 0x3acccccd, v74
    v_and_b32 v0, 16, v1
    v_mfma_f32_16x16x32_bf16 v[54:57], a[136:139], v[14:17], v[54:57]
    ds_read_b64_tr_b16 v[38:39], v5 offset:4096
    v_cmp_eq_u32 s[28:29], 0, v0
    v_mfma_f32_16x16x32_bf16 v[54:57], a[148:151], v[18:21], v[54:57]
    ds_read_b64_tr_b16 v[40:41], v5 offset:4352
    v_cndmask_b32 v0, v119, v118, s[28:29]
    v_mfma_f32_16x16x32_bf16 v[54:57], a[160:163], v[22:25], v[54:57]
    v_fma_f32 v75, abs(v75), s32, v114
    v_lshrrev_b32 v106, 3, v1
    v_fma_f32 v75, -v98, v98, v75
    v_mfma_f32_16x16x32_bf16 v[54:57], a[172:175], v[26:29], v[54:57]
    ds_read_b64_tr_b16 v[42:43], v5 offset:6144
    global_load_lds_dwordx4 v117, s[20:21] offset:1024 sc1
    v_and_b32 v107, 7, v1
    v_mfma_f32_16x16x32_bf16 v[50:53], a[120:123], v[10:13], v[50:53]
    ds_read_b64_tr_b16 v[44:45], v5 offset:6400
    v_max_f32 v101, 0x3727c5ac, v75
    v_mul_u32_u24 v106, 53248, v106
    v_mfma_f32_16x16x32_bf16 v[50:53], a[132:135], v[14:17], v[50:53]
    s_waitcnt lgkmcnt(8)
    ds_write_b64 v113, v[110:111] offset:128
    v_mfma_f32_16x16x32_bf16 v[50:53], a[144:147], v[18:21], v[50:53]
    s_add_u32 s48, s56, s61
    v_rsq_f32 v76, v101
    v_lshl_add_u32 v106, v107, 3, v106
    v_mfma_f32_16x16x32_bf16 v[50:53], a[156:159], v[22:25], v[50:53]
    s_add_u32 s48, s48, 53248
    ds_read_b64_tr_b16 v[46:47], v5 offset:8192
    v_mfma_f32_16x16x32_bf16 v[50:53], a[168:171], v[26:29], v[50:53]
    ds_read_b64_tr_b16 v[48:49], v5 offset:8448
    global_load_lds_dwordx4 v117, s[20:21] offset:2048 sc1
    v_mfma_f32_16x16x32_bf16 v[82:85], a[168:171], v[94:97], v[82:85]
    buffer_store_dwordx2 v[94:95], v106, s[40:43], s48 offen sc1
    v_mfma_f32_16x16x32_bf16 v[86:89], a[172:175], v[94:97], v[86:89]
    v_mfma_f32_16x16x32_bf16 v[90:93], a[176:179], v[94:97], v[90:93]
    s_waitcnt lgkmcnt(7)
    v_mfma_f32_16x16x32_bf16 v[50:53], a[180:183], v[30:33], v[50:53]
    ds_read_b64_tr_b16 v[10:11], v6 offset:0
    v_mfma_f32_16x16x32_bf16 v[50:53], a[192:195], v[34:37], v[50:53]
    s_waitcnt lgkmcnt(4)
    ds_read_b64_tr_b16 v[12:13], v6 offset:256
    global_load_lds_dwordx4 v117, s[20:21] offset:3072 sc1
    v_mfma_f32_16x16x32_bf16 v[50:53], a[204:207], v[38:41], v[50:53]
    v_mfma_f32_16x16x32_bf16 v[50:53], a[216:219], v[42:45], v[50:53]
    s_waitcnt lgkmcnt(2)
    s_add_u32 m0, s58, 14336
    ds_read_b64_tr_b16 v[14:15], v6 offset:2048
    s_waitcnt vmcnt(7)
    v_mfma_f32_16x16x32_bf16 v[50:53], a[228:231], v[46:49], v[50:53]
    ds_read_b64_tr_b16 v[16:17], v6 offset:2304
    v_mfma_f32_16x16x32_bf16 v[54:57], a[184:187], v[30:33], v[54:57]
    v_mfma_f32_16x16x32_bf16 v[54:57], a[196:199], v[34:37], v[54:57]
    ds_read_b64_tr_b16 v[18:19], v6 offset:4096
    global_load_lds_dwordx4 v117, s[22:23] offset:0 sc1
    v_mfma_f32_16x16x32_bf16 v[54:57], a[208:211], v[38:41], v[54:57]
    ds_read_b64_tr_b16 v[20:21], v6 offset:4352
    v_mfma_f32_16x16x32_bf16 v[54:57], a[220:223], v[42:45], v[54:57]
    s_waitcnt vmcnt(7)
    v_mfma_f32_16x16x32_bf16 v[54:57], a[232:235], v[46:49], v[54:57]
    ds_read_b64_tr_b16 v[22:23], v6 offset:6144
    v_mfma_f32_16x16x32_bf16 v[58:61], a[188:191], v[30:33], v[58:61]
    ds_read_b64_tr_b16 v[24:25], v6 offset:6400
    v_mfma_f32_16x16x32_bf16 v[58:61], a[200:203], v[34:37], v[58:61]
    v_mfma_f32_16x16x32_bf16 v[58:61], a[212:215], v[38:41], v[58:61]
    ds_read_b64_tr_b16 v[26:27], v6 offset:8192
    global_load_lds_dwordx4 v117, s[22:23] offset:1024 sc1
    v_mfma_f32_16x16x32_bf16 v[58:61], a[224:227], v[42:45], v[58:61]
    ds_read_b64_tr_b16 v[28:29], v6 offset:8448
    s_waitcnt vmcnt(7)
    v_mfma_f32_16x16x32_bf16 v[58:61], a[236:239], v[46:49], v[58:61]
    v_mfma_f32_16x16x32_bf16 v[82:85], a[228:231], v[94:97], v[82:85]
    v_mfma_f32_16x16x32_bf16 v[86:89], a[232:235], v[94:97], v[86:89]
    v_mul_f32 v99, 0xc0135761, v76
    v_mul_f32 v76, v76, v76
    v_mfma_f32_16x16x32_bf16 v[90:93], a[236:239], v[94:97], v[90:93]
    s_waitcnt lgkmcnt(6)
    v_mul_f32 v76, 0x3d372713, v76
    v_mul_f32 v100, v99, v76
    v_mfma_f32_16x16x32_bf16 v[78:81], v[10:13], v[10:13], 0
    ds_read_b64_tr_b16 v[30:31], v7 offset:0
    global_load_lds_dwordx4 v117, s[22:23] offset:2048 sc1
    v_mfma_f32_16x16x32_bf16 v[78:81], v[14:17], v[14:17], v[78:81]
    s_waitcnt lgkmcnt(3)
    v_mov_b32 v123, v0
    v_fma_f32 v50, -v98, v82, v50
    v_mfma_f32_16x16x32_bf16 v[78:81], v[18:21], v[18:21], v[78:81]
    ds_read_b64_tr_b16 v[32:33], v7 offset:256
    v_fma_f32 v51, -v98, v83, v51
    v_mfma_f32_16x16x32_bf16 v[78:81], v[22:25], v[22:25], v[78:81]
    s_waitcnt lgkmcnt(2)
    v_mul_f32 v106, v50, v50
    v_mul_f32 v107, v51, v51
    v_mfma_f32_16x16x32_bf16 v[78:81], v[26:29], v[26:29], v[78:81]
    ds_read_b64_tr_b16 v[34:35], v7 offset:2048
    global_load_lds_dwordx4 v117, s[22:23] offset:3072 sc1
    v_mfma_f32_16x16x32_bf16 v[74:77], v[94:97], v[10:13], 0
    v_fma_f32 v106, v106, v100, v99
    v_fma_f32 v107, v107, v100, v99
    v_mfma_f32_16x16x32_bf16 v[74:77], v[94:97], v[14:17], v[74:77]
    s_add_u32 m0, s58, 18432
    ds_read_b64_tr_b16 v[36:37], v7 offset:2304
    v_mul_f32 v106, v106, v50
    v_mfma_f32_16x16x32_bf16 v[74:77], v[94:97], v[18:21], v[74:77]
    v_mul_f32 v107, v107, v51
    v_exp_f32 v106, v106
    v_mfma_f32_16x16x32_bf16 v[74:77], v[94:97], v[22:25], v[74:77]
    ds_read_b64_tr_b16 v[38:39], v7 offset:4096
    v_exp_f32 v107, v107
    v_mfma_f32_16x16x32_bf16 v[74:77], v[94:97], v[26:29], v[74:77]
    global_load_lds_dwordx4 v117, s[24:25] offset:0 sc1
    v_fma_f32 v52, -v98, v84, v52
    v_mfma_f32_16x16x32_bf16 v[70:73], a[8:11], v[10:13], 0
    v_fma_f32 v53, -v98, v85, v53
    v_fma_f32 v106, v106, v101, v101
    v_fma_f32 v107, v107, v101, v101
    v_mfma_f32_16x16x32_bf16 v[70:73], a[20:23], v[14:17], v[70:73]
    ds_read_b64_tr_b16 v[40:41], v7 offset:4352
    v_rcp_f32 v106, v106
    v_mfma_f32_16x16x32_bf16 v[70:73], a[32:35], v[18:21], v[70:73]
    v_rcp_f32 v107, v107
    v_cndmask_b32 v75, v78, v79, s[50:51]
    v_mfma_f32_16x16x32_bf16 v[70:73], a[44:47], v[22:25], v[70:73]
    ds_read_b64_tr_b16 v[42:43], v7 offset:6144
    v_cndmask_b32 v75, v75, v80, s[52:53]
    v_cndmask_b32 v75, abs(v75), abs(v81), s[54:55]
    v_mfma_f32_16x16x32_bf16 v[70:73], a[56:59], v[26:29], v[70:73]
    ds_write_b64 v125, v[74:75] offset:512
    v_mfma_f32_16x16x32_bf16 v[66:69], a[4:7], v[10:13], 0
    global_load_lds_dwordx4 v117, s[24:25] offset:1024 sc1
    v_mul_f32 v50, v50, v52
    v_mfma_f32_16x16x32_bf16 v[66:69], a[16:19], v[14:17], v[66:69]
    ds_read_b64_tr_b16 v[44:45], v7 offset:6400
    v_mul_f32 v51, v51, v53
    v_mul_f32 v50, v50, v106
    v_mfma_f32_16x16x32_bf16 v[66:69], a[28:31], v[18:21], v[66:69]
    s_add_u32 m0, s33, 0
    ds_read_b64_tr_b16 v[46:47], v7 offset:8192
    v_add_u32 v117, 655360, v117
    v_add_u32 v253, s7, v252
    v_mfma_f32_16x16x32_bf16 v[66:69], a[40:43], v[22:25], v[66:69]
    v_mul_f32 v51, v51, v107
    v_cvt_pk_bf16_f32 v120, v50, v51
    v_mfma_f32_16x16x32_bf16 v[66:69], a[52:55], v[26:29], v[66:69]
    ds_read_b64_tr_b16 v[48:49], v7 offset:8448
    v_fma_f32 v54, -v98, v86, v54
    v_mfma_f32_16x16x32_bf16 v[62:65], a[0:3], v[10:13], 0
    global_load_lds_dwordx4 v253, s[20:21] offset:0 sc1
    v_fma_f32 v55, -v98, v87, v55
    v_mfma_f32_16x16x32_bf16 v[62:65], a[12:15], v[14:17], v[62:65]
    v_mul_f32 v106, v54, v54
    v_mul_f32 v107, v55, v55
    v_mfma_f32_16x16x32_bf16 v[62:65], a[24:27], v[18:21], v[62:65]
    v_fma_f32 v106, v106, v100, v99
    v_fma_f32 v107, v107, v100, v99
    v_mfma_f32_16x16x32_bf16 v[62:65], a[36:39], v[22:25], v[62:65]
    v_mul_f32 v106, v106, v54
    v_mul_f32 v107, v107, v55
    v_mfma_f32_16x16x32_bf16 v[62:65], a[48:51], v[26:29], v[62:65]
    s_waitcnt lgkmcnt(7)
    v_exp_f32 v106, v106
    v_mfma_f32_16x16x32_bf16 v[62:65], a[60:63], v[30:33], v[62:65]
    ds_read_b64_tr_b16 v[10:11], v8 offset:0
    global_load_lds_dwordx4 v253, s[20:21] offset:1024 sc1
    v_mfma_f32_16x16x32_bf16 v[62:65], a[72:75], v[34:37], v[62:65]
    s_waitcnt lgkmcnt(3)
    ds_read_b64_tr_b16 v[12:13], v8 offset:256
    v_exp_f32 v107, v107
    v_mfma_f32_16x16x32_bf16 v[62:65], a[84:87], v[38:41], v[62:65]
    ds_read_b64_tr_b16 v[14:15], v8 offset:2048
    v_fma_f32 v56, -v98, v88, v56
    v_mfma_f32_16x16x32_bf16 v[62:65], a[96:99], v[42:45], v[62:65]
    s_waitcnt lgkmcnt(3)
    ds_read_b64_tr_b16 v[16:17], v8 offset:2304
    v_fma_f32 v57, -v98, v89, v57
    v_mfma_f32_16x16x32_bf16 v[62:65], a[108:111], v[46:49], v[62:65]
    ds_read_b64_tr_b16 v[18:19], v8 offset:4096
    v_fma_f32 v106, v106, v101, v101
    v_mfma_f32_16x16x32_bf16 v[66:69], a[64:67], v[30:33], v[66:69]
    s_mov_b32 s73, 327680
    v_fma_f32 v107, v107, v101, v101
    v_rcp_f32 v106, v106
    v_mfma_f32_16x16x32_bf16 v[66:69], a[76:79], v[34:37], v[66:69]
    ds_read_b64_tr_b16 v[20:21], v8 offset:4352
    buffer_load_dwordx2 v[254:255], v127, s[40:43], s73 offen sc1
    v_mfma_f32_16x16x32_bf16 v[66:69], a[88:91], v[38:41], v[66:69]
    ds_read_b64_tr_b16 v[22:23], v8 offset:6144
    global_load_lds_dwordx4 v253, s[20:21] offset:2048 sc1
    v_mfma_f32_16x16x32_bf16 v[66:69], a[100:103], v[42:45], v[66:69]
    ds_read_b64_tr_b16 v[24:25], v8 offset:6400
    v_rcp_f32 v107, v107
    v_mfma_f32_16x16x32_bf16 v[66:69], a[112:115], v[46:49], v[66:69]
    ds_read_b64_tr_b16 v[26:27], v8 offset:8192
    v_mul_f32 v54, v54, v56
    v_mfma_f32_16x16x32_bf16 v[70:73], a[68:71], v[30:33], v[70:73]
    ds_read_b64_tr_b16 v[28:29], v8 offset:8448
    v_mul_f32 v55, v55, v57
    v_mfma_f32_16x16x32_bf16 v[70:73], a[80:83], v[34:37], v[70:73]
    global_load_lds_dwordx4 v253, s[20:21] offset:3072 sc1
    v_mul_f32 v54, v54, v106
    v_mfma_f32_16x16x32_bf16 v[70:73], a[92:95], v[38:41], v[70:73]
    v_mul_f32 v55, v55, v107
    v_cvt_pk_bf16_f32 v121, v54, v55
    v_mfma_f32_16x16x32_bf16 v[70:73], a[104:107], v[42:45], v[70:73]
    s_add_u32 m0, s33, 4096
    v_fma_f32 v58, -v98, v90, v58
    v_fma_f32 v59, -v98, v91, v59
    v_mfma_f32_16x16x32_bf16 v[70:73], a[116:119], v[46:49], v[70:73]
    s_waitcnt lgkmcnt(6)
    v_mul_f32 v106, v58, v58
    v_mul_f32 v107, v59, v59
    v_fma_f32 v106, v106, v100, v99
    v_mfma_f32_16x16x32_bf16 v[70:73], a[128:131], v[10:13], v[70:73]
    ds_read_b64_tr_b16 v[30:31], v9 offset:0
    v_fma_f32 v107, v107, v100, v99
    v_mul_f32 v106, v106, v58
    v_mfma_f32_16x16x32_bf16 v[70:73], a[140:143], v[14:17], v[70:73]
    s_waitcnt lgkmcnt(3)
    ds_read_b64_tr_b16 v[32:33], v9 offset:256
    global_load_lds_dwordx4 v253, s[22:23] offset:0 sc1
    v_mul_f32 v107, v107, v59
    v_mfma_f32_16x16x32_bf16 v[70:73], a[152:155], v[18:21], v[70:73]
    ds_read_b64_tr_b16 v[34:35], v9 offset:2048
    v_exp_f32 v106, v106
    v_mfma_f32_16x16x32_bf16 v[70:73], a[164:167], v[22:25], v[70:73]
    s_waitcnt lgkmcnt(3)
    ds_read_b64_tr_b16 v[36:37], v9 offset:2304
    v_exp_f32 v107, v107
    v_mfma_f32_16x16x32_bf16 v[70:73], a[176:179], v[26:29], v[70:73]
    ds_read_b64_tr_b16 v[38:39], v9 offset:4096
    v_fma_f32 v60, -v98, v92, v60
    v_mfma_f32_16x16x32_bf16 v[66:69], a[124:127], v[10:13], v[66:69]
    v_fma_f32 v61, -v98, v93, v61
    v_permlane32_swap_b32 v121, v123
    v_mfma_f32_16x16x32_bf16 v[66:69], a[136:139], v[14:17], v[66:69]
    s_waitcnt vmcnt(6)
    ds_read_b64_tr_b16 v[40:41], v9 offset:4352
    global_load_lds_dwordx4 v253, s[22:23] offset:1024 sc1
    v_mfma_f32_16x16x32_bf16 v[66:69], a[148:151], v[18:21], v[66:69]
    s_barrier
    ds_read_b128 v[74:77], v126 offset:512
    v_fma_f32 v106, v106, v101, v101
    v_fma_f32 v107, v107, v101, v101
    v_mfma_f32_16x16x32_bf16 v[66:69], a[160:163], v[22:25], v[66:69]
    ds_read_b128 v[78:81], v126 offset:528
    v_rcp_f32 v106, v106
    v_mfma_f32_16x16x32_bf16 v[66:69], a[172:175], v[26:29], v[66:69]
    ds_read_b64_tr_b16 v[42:43], v9 offset:6144
    ds_read_b64_tr_b16 v[44:45], v9 offset:6400
    v_mfma_f32_16x16x32_bf16 v[62:65], a[120:123], v[10:13], v[62:65]
    ds_read_b64_tr_b16 v[46:47], v9 offset:8192
    v_add_u32 v253, s4, v252
    v_mfma_f32_16x16x32_bf16 v[62:65], a[132:135], v[14:17], v[62:65]
    ds_read_b64_tr_b16 v[48:49], v9 offset:8448
    global_load_dwordx4 v[128:131], v253, s[20:21] offset:0 sc1
    v_mfma_f32_16x16x32_bf16 v[62:65], a[144:147], v[18:21], v[62:65]
    v_rcp_f32 v107, v107
    v_mfma_f32_16x16x32_bf16 v[62:65], a[156:159], v[22:25], v[62:65]
    v_mul_f32 v58, v58, v60
    v_mul_f32 v59, v59, v61
    v_mfma_f32_16x16x32_bf16 v[62:65], a[168:171], v[26:29], v[62:65]
    s_waitcnt lgkmcnt(8)
    s_waitcnt lgkmcnt(4)
    v_mul_f32 v58, v58, v106
    v_mfma_f32_16x16x32_bf16 v[62:65], a[180:183], v[30:33], v[62:65]
    ds_read_b64_tr_b16 v[10:11], v2 offset:10240
    v_mul_f32 v59, v59, v107
    v_add_f32 v74, v74, v76
    v_mfma_f32_16x16x32_bf16 v[62:65], a[192:195], v[34:37], v[62:65]
    s_waitcnt lgkmcnt(3)
    ds_read_b64_tr_b16 v[12:13], v2 offset:10496
    global_load_dwordx4 v[132:135], v253, s[20:21] offset:1024 sc1
    v_add_f32 v75, v75, v77
    v_mfma_f32_16x16x32_bf16 v[62:65], a[204:207], v[38:41], v[62:65]
    ds_read_b64_tr_b16 v[14:15], v2 offset:12288
    v_add_f32 v78, v78, v80
    v_add_f32 v79, v79, v81
    v_mfma_f32_16x16x32_bf16 v[62:65], a[216:219], v[42:45], v[62:65]
    s_waitcnt lgkmcnt(3)
    ds_read_b64_tr_b16 v[16:17], v2 offset:12544
    v_add_f32 v74, v74, v78
    v_cvt_pk_bf16_f32 v122, v58, v59
    v_mfma_f32_16x16x32_bf16 v[62:65], a[228:231], v[46:49], v[62:65]
    s_add_u32 s3, s56, 0
    ds_read_b64_tr_b16 v[18:19], v2 offset:14336
    v_add_f32 v75, v75, v79
    v_mfma_f32_16x16x32_bf16 v[66:69], a[184:187], v[30:33], v[66:69]
    v_mul_f32 v102, 0x3acccccd, v74
    v_permlane32_swap_b32 v120, v122
    v_mfma_f32_16x16x32_bf16 v[66:69], a[196:199], v[34:37], v[66:69]
    ds_read_b64_tr_b16 v[20:21], v2 offset:14592
    v_fma_f32 v75, abs(v75), s32, v114
    v_mfma_f32_16x16x32_bf16 v[66:69], a[208:211], v[38:41], v[66:69]
    ds_read_b64_tr_b16 v[22:23], v2 offset:16384
    v_fma_f32 v75, -v102, v102, v75
    v_mfma_f32_16x16x32_bf16 v[66:69], a[220:223], v[42:45], v[66:69]
    ds_read_b64_tr_b16 v[24:25], v2 offset:16640
    v_max_f32 v105, 0x3727c5ac, v75
    s_waitcnt vmcnt(6)
    v_cmp_ne_u64 vcc, s[44:45], v[254:255]
    v_mfma_f32_16x16x32_bf16 v[66:69], a[232:235], v[46:49], v[66:69]
    s_nop 0
    s_cbranch_vccnz L_retry_13
L_seen_14:
    s_add_u32 m0, s58, 20480
    ds_read_b64_tr_b16 v[26:27], v2 offset:18432
    v_and_b32 v127, 15, v1
    v_mfma_f32_16x16x32_bf16 v[70:73], a[188:191], v[30:33], v[70:73]
    ds_read_b64_tr_b16 v[28:29], v2 offset:18688
    global_load_lds_dwordx4 v117, s[20:21] offset:0 sc1
    v_lshl_add_u32 v127, v127, 6, s70
    v_mfma_f32_16x16x32_bf16 v[70:73], a[200:203], v[34:37], v[70:73]
    v_permlane16_swap_b32 v120, v121
    v_rsq_f32 v76, v105
    v_mfma_f32_16x16x32_bf16 v[70:73], a[212:215], v[38:41], v[70:73]
    global_load_dwordx4 v[136:139], v253, s[20:21] offset:2048 sc1
    v_permlane16_swap_b32 v122, v123
    v_mfma_f32_16x16x32_bf16 v[70:73], a[224:227], v[42:45], v[70:73]
    buffer_store_dwordx4 v[120:123], v124, s[40:43], s3 offen sc1
    v_mfma_f32_16x16x32_bf16 v[70:73], a[236:239], v[46:49], v[70:73]
    s_waitcnt lgkmcnt(6)
    v_mul_f32 v103, 0xc0135761, v76
    v_mul_f32 v76, v76, v76
    v_mul_f32 v76, 0x3d372713, v76
    v_mul_f32 v104, v103, v76
    v_mfma_f32_16x16x32_bf16 v[78:81], v[10:13], v[10:13], 0
    ds_read_b64_tr_b16 v[30:31], v3 offset:10240
    v_mov_b32 v123, v0
    v_mfma_f32_16x16x32_bf16 v[78:81], v[14:17], v[14:17], v[78:81]
    s_waitcnt lgkmcnt(3)
    ds_read_b64_tr_b16 v[110:111], v108 offset:10240
    v_fma_f32 v62, -v102, v82, v62
    v_mfma_f32_16x16x32_bf16 v[78:81], v[18:21], v[18:21], v[78:81]
    ds_read_b64_tr_b16 v[32:33], v3 offset:10496
    global_load_lds_dwordx4 v117, s[20:21] offset:1024 sc1
    v_mfma_f32_16x16x32_bf16 v[78:81], v[22:25], v[22:25], v[78:81]
    s_waitcnt lgkmcnt(3)
    v_fma_f32 v63, -v102, v83, v63
    v_mul_f32 v106, v62, v62
    v_mfma_f32_16x16x32_bf16 v[78:81], v[26:29], v[26:29], v[78:81]
    ds_read_b64_tr_b16 v[34:35], v3 offset:12288
    v_mul_f32 v107, v63, v63
    v_mfma_f32_16x16x32_bf16 v[74:77], v[94:97], v[10:13], 0
    v_fma_f32 v106, v106, v104, v103
    v_fma_f32 v107, v107, v104, v103
    v_mfma_f32_16x16x32_bf16 v[74:77], v[94:97], v[14:17], v[74:77]
    ds_read_b64_tr_b16 v[36:37], v3 offset:12544
    v_mul_f32 v106, v106, v62
    v_mfma_f32_16x16x32_bf16 v[74:77], v[94:97], v[18:21], v[74:77]
    global_load_dwordx4 v[140:143], v253, s[20:21] offset:3072 sc1
    v_mul_f32 v107, v107, v63
    v_mfma_f32_16x16x32_bf16 v[74:77], v[94:97], v[22:25], v[74:77]
    ds_read_b64_tr_b16 v[38:39], v3 offset:14336
    v_exp_f32 v106, v106
    v_mfma_f32_16x16x32_bf16 v[74:77], v[94:97], v[26:29], v[74:77]
    v_exp_f32 v107, v107
    v_fma_f32 v64, -v102, v84, v64
    v_mfma_f32_16x16x32_bf16 v[58:61], a[8:11], v[10:13], 0
    v_fma_f32 v65, -v102, v85, v65
    v_fma_f32 v106, v106, v105, v105
    v_fma_f32 v107, v107, v105, v105
    v_mfma_f32_16x16x32_bf16 v[58:61], a[20:23], v[14:17], v[58:61]
    ds_read_b64_tr_b16 v[40:41], v3 offset:14592
    v_rcp_f32 v106, v106
    v_mfma_f32_16x16x32_bf16 v[58:61], a[32:35], v[18:21], v[58:61]
    v_cndmask_b32 v75, v78, v79, s[50:51]
    v_cndmask_b32 v75, v75, v80, s[52:53]
    v_cndmask_b32 v75, abs(v75), abs(v81), s[54:55]
    v_mfma_f32_16x16x32_bf16 v[58:61], a[44:47], v[22:25], v[58:61]
    ds_write_b64 v125, v[74:75] offset:0
    v_mfma_f32_16x16x32_bf16 v[58:61], a[56:59], v[26:29], v[58:61]
    global_load_lds_dwordx4 v117, s[20:21] offset:2048 sc1
    v_rcp_f32 v107, v107
    v_mfma_f32_16x16x32_bf16 v[54:57], a[4:7], v[10:13], 0
    ds_read_b64_tr_b16 v[42:43], v3 offset:16384
    v_mul_f32 v62, v62, v64
    v_mfma_f32_16x16x32_bf16 v[54:57], a[16:19], v[14:17], v[54:57]
L_padB_4:
    s_cbranch_execz L_backB
    ds_read_b64_tr_b16 v[44:45], v3 offset:16640
    v_mul_f32 v63, v63, v65
    v_mfma_f32_16x16x32_bf16 v[54:57], a[28:31], v[18:21], v[54:57]
    ds_read_b64_tr_b16 v[46:47], v3 offset:18432
    v_mul_f32 v62, v62, v106
    v_mfma_f32_16x16x32_bf16 v[54:57], a[40:43], v[22:25], v[54:57]
    s_waitcnt lgkmcnt(9)
    ds_write_b64 v109, v[110:111] offset:2816
    v_mfma_f32_16x16x32_bf16 v[54:57], a[52:55], v[26:29], v[54:57]
    global_load_dwordx4 v[144:147], v253, s[22:23] offset:0 sc1
    v_mul_f32 v63, v63, v107
    v_mfma_f32_16x16x32_bf16 v[50:53], a[0:3], v[10:13], 0
    ds_read_b64_tr_b16 v[48:49], v3 offset:18688
    v_cvt_pk_bf16_f32 v120, v62, v63
    v_mfma_f32_16x16x32_bf16 v[50:53], a[12:15], v[14:17], v[50:53]
    ds_read_b64_tr_b16 v[110:111], v112 offset:14336
    v_fma_f32 v66, -v102, v86, v66
    v_mfma_f32_16x16x32_bf16 v[50:53], a[24:27], v[18:21], v[50:53]
    v_fma_f32 v67, -v102, v87, v67
    v_mul_f32 v106, v66, v66
    v_mfma_f32_16x16x32_bf16 v[50:53], a[36:39], v[22:25], v[50:53]
    global_load_lds_dwordx4 v117, s[20:21] offset:3072 sc1
    v_mul_f32 v107, v67, v67
    v_mfma_f32_16x16x32_bf16 v[50:53], a[48:51], v[26:29], v[50:53]
    s_waitcnt lgkmcnt(9)
    v_fma_f32 v106, v106, v104, v103
    v_fma_f32 v107, v107, v104, v103
    v_mfma_f32_16x16x32_bf16 v[50:53], a[60:63], v[30:33], v[50:53]
    ds_read_b64_tr_b16 v[10:11], v4 offset:10240
    v_mul_f32 v106, v106, v66
    v_mfma_f32_16x16x32_bf16 v[50:53], a[72:75], v[34:37], v[50:53]
    s_waitcnt lgkmcnt(5)
    ds_read_b64_tr_b16 v[12:13], v4 offset:10496
    v_mul_f32 v107, v107, v67
    v_mfma_f32_16x16x32_bf16 v[50:53], a[84:87], v[38:41], v[50:53]
    ds_read_b64_tr_b16 v[14:15], v4 offset:12288
    v_exp_f32 v106, v106
    v_mfma_f32_16x16x32_bf16 v[50:53], a[96:99], v[42:45], v[50:53]
    s_waitcnt lgkmcnt(4)
    ds_read_b64_tr_b16 v[16:17], v4 offset:12544
    global_load_dwordx4 v[148:151], v253, s[22:23] offset:1024 sc1
    v_mfma_f32_16x16x32_bf16 v[50:53], a[108:111], v[46:49], v[50:53]
    ds_read_b64_tr_b16 v[18:19], v4 offset:14336
    v_exp_f32 v107, v107
    v_mfma_f32_16x16x32_bf16 v[54:57], a[64:67], v[30:33], v[54:57]
    v_fma_f32 v68, -v102, v88, v68
    v_fma_f32 v69, -v102, v89, v69
    v_mfma_f32_16x16x32_bf16 v[54:57], a[76:79], v[34:37], v[54:57]
    s_add_u32 m0, s58, 24576
    ds_read_b64_tr_b16 v[20:21], v4 offset:14592
    v_fma_f32 v106, v106, v105, v105
    v_mfma_f32_16x16x32_bf16 v[54:57], a[88:91], v[38:41], v[54:57]
    ds_read_b64_tr_b16 v[22:23], v4 offset:16384
    v_fma_f32 v107, v107, v105, v105
    v_mfma_f32_16x16x32_bf16 v[54:57], a[100:103], v[42:45], v[54:57]
    ds_read_b64_tr_b16 v[24:25], v4 offset:16640
    v_rcp_f32 v106, v106
    v_mfma_f32_16x16x32_bf16 v[54:57], a[112:115], v[46:49], v[54:57]
    ds_read_b64_tr_b16 v[26:27], v4 offset:18432
    global_load_lds_dwordx4 v117, s[22:23] offset:0 sc1
    v_mfma_f32_16x16x32_bf16 v[58:61], a[68:71], v[30:33], v[58:61]
    s_barrier
    ds_read_b64_tr_b16 v[28:29], v4 offset:18688
    v_mfma_f32_16x16x32_bf16 v[58:61], a[80:83], v[34:37], v[58:61]
    ds_read_b128 v[74:77], v126 offset:0
    v_rcp_f32 v107, v107
    v_mfma_f32_16x16x32_bf16 v[58:61], a[92:95], v[38:41], v[58:61]
    ds_read_b128 v[78:81], v126 offset:16
    v_mul_f32 v66, v66, v68
    v_mfma_f32_16x16x32_bf16 v[58:61], a[104:107], v[42:45], v[58:61]
    s_waitcnt lgkmcnt(12)
    ds_write_b64 v113, v[110:111] offset:2944
    v_mfma_f32_16x16x32_bf16 v[58:61], a[116:119], v[46:49], v[58:61]
    s_waitcnt lgkmcnt(9)
    v_mul_f32 v67, v67, v69
    v_mul_f32 v66, v66, v106
    v_mfma_f32_16x16x32_bf16 v[58:61], a[128:131], v[10:13], v[58:61]
    ds_read_b64_tr_b16 v[30:31], v5 offset:10240
    global_load_dwordx4 v[152:155], v253, s[22:23] offset:2048 sc1
    v_mul_f32 v67, v67, v107
    v_mfma_f32_16x16x32_bf16 v[58:61], a[140:143], v[14:17], v[58:61]
    s_waitcnt lgkmcnt(6)
    ds_read_b64_tr_b16 v[32:33], v5 offset:10496
    v_cvt_pk_bf16_f32 v121, v66, v67
    v_fma_f32 v70, -v102, v90, v70
    v_mfma_f32_16x16x32_bf16 v[58:61], a[152:155], v[18:21], v[58:61]
    ds_read_b64_tr_b16 v[34:35], v5 offset:12288
    v_fma_f32 v71, -v102, v91, v71
    v_mul_f32 v106, v70, v70
    v_mfma_f32_16x16x32_bf16 v[58:61], a[164:167], v[22:25], v[58:61]
    s_waitcnt lgkmcnt(6)
    ds_read_b64_tr_b16 v[36:37], v5 offset:12544
    v_mul_f32 v107, v71, v71
    v_fma_f32 v106, v106, v104, v103
    v_mfma_f32_16x16x32_bf16 v[58:61], a[176:179], v[26:29], v[58:61]
    s_waitcnt lgkmcnt(5)
    ds_read_b64_tr_b16 v[38:39], v5 offset:14336
    global_load_lds_dwordx4 v117, s[22:23] offset:1024 sc1
    v_fma_f32 v107, v107, v104, v103
    v_mfma_f32_16x16x32_bf16 v[54:57], a[124:127], v[10:13], v[54:57]
    v_mul_f32 v106, v106, v70
    v_mul_f32 v107, v107, v71
    v_add_f32 v74, v74, v76
    v_mfma_f32_16x16x32_bf16 v[54:57], a[136:139], v[14:17], v[54:57]
    ds_read_b64_tr_b16 v[40:41], v5 offset:14592
    v_exp_f32 v106, v106
    v_mfma_f32_16x16x32_bf16 v[54:57], a[148:151], v[18:21], v[54:57]
    ds_read_b64_tr_b16 v[42:43], v5 offset:16384
    v_exp_f32 v107, v107
    v_mfma_f32_16x16x32_bf16 v[54:57], a[160:163], v[22:25], v[54:57]
    ds_read_b64_tr_b16 v[44:45], v5 offset:16640
    v_fma_f32 v72, -v102, v92, v72
    v_mfma_f32_16x16x32_bf16 v[54:57], a[172:175], v[26:29], v[54:57]
    ds_read_b64_tr_b16 v[46:47], v5 offset:18432
    global_load_dwordx4 v[156:159], v253, s[22:23] offset:3072 sc1
    v_fma_f32 v73, -v102, v93, v73
    v_mfma_f32_16x16x32_bf16 v[50:53], a[120:123], v[10:13], v[50:53]
    ds_read_b64_tr_b16 v[48:49], v5 offset:18688
    v_add_f32 v75, v75, v77
    v_add_f32 v78, v78, v80
    v_mfma_f32_16x16x32_bf16 v[50:53], a[132:135], v[14:17], v[50:53]
    v_permlane32_swap_b32 v121, v123
    v_fma_f32 v106, v106, v105, v105
    v_mfma_f32_16x16x32_bf16 v[50:53], a[144:147], v[18:21], v[50:53]
    v_fma_f32 v107, v107, v105, v105
    v_rcp_f32 v106, v106
    v_mfma_f32_16x16x32_bf16 v[50:53], a[156:159], v[22:25], v[50:53]
    v_add_f32 v79, v79, v81
    v_rcp_f32 v107, v107
    v_mfma_f32_16x16x32_bf16 v[50:53], a[168:171], v[26:29], v[50:53]
    s_waitcnt lgkmcnt(6)
    v_mul_f32 v70, v70, v72
    v_mul_f32 v71, v71, v73
    v_mfma_f32_16x16x32_bf16 v[50:53], a[180:183], v[30:33], v[50:53]
    ds_read_b64_tr_b16 v[10:11], v6 offset:10240
    global_load_lds_dwordx4 v117, s[22:23] offset:2048 sc1
    v_mul_f32 v70, v70, v106
    v_mfma_f32_16x16x32_bf16 v[50:53], a[192:195], v[34:37], v[50:53]
    s_waitcnt lgkmcnt(3)
    ds_read_b64_tr_b16 v[12:13], v6 offset:10496
    v_mul_f32 v71, v71, v107
    v_cvt_pk_bf16_f32 v122, v70, v71
    v_mfma_f32_16x16x32_bf16 v[50:53], a[204:207], v[38:41], v[50:53]
    s_add_u32 s3, s56, 53248
    ds_read_b64_tr_b16 v[14:15], v6 offset:12288
    v_permlane32_swap_b32 v120, v122
    v_mfma_f32_16x16x32_bf16 v[50:53], a[216:219], v[42:45], v[50:53]
    s_waitcnt lgkmcnt(3)
    ds_read_b64_tr_b16 v[16:17], v6 offset:12544
    v_permlane16_swap_b32 v120, v121
    v_mfma_f32_16x16x32_bf16 v[50:53], a[228:231], v[46:49], v[50:53]
    s_waitcnt vmcnt(11)
    ds_read_b64_tr_b16 v[18:19], v6 offset:14336
    v_add_f32 v74, v74, v78
    v_mfma_f32_16x16x32_bf16 v[54:57], a[184:187], v[30:33], v[54:57]
    global_load_lds_dwordx4 v117, s[22:23] offset:3072 sc1
    v_permlane16_swap_b32 v122, v123
    v_mfma_f32_16x16x32_bf16 v[54:57], a[196:199], v[34:37], v[54:57]
    ds_read_b64_tr_b16 v[20:21], v6 offset:14592
    v_add_f32 v75, v75, v79
    v_mfma_f32_16x16x32_bf16 v[54:57], a[208:211], v[38:41], v[54:57]
    s_add_u32 m0, s58, 28672
    ds_read_b64_tr_b16 v[22:23], v6 offset:16384
    v_mul_f32 v98, 0x3acccccd, v74
    v_mfma_f32_16x16x32_bf16 v[54:57], a[220:223], v[42:45], v[54:57]
    ds_read_b64_tr_b16 v[24:25], v6 offset:16640
    v_fma_f32 v75, abs(v75), s32, v114
    v_mfma_f32_16x16x32_bf16 v[54:57], a[232:235], v[46:49], v[54:57]
    ds_read_b64_tr_b16 v[26:27], v6 offset:18432
    buffer_store_dwordx4 v[120:123], v124, s[40:43], s3 offen sc1
    v_mfma_f32_16x16x32_bf16 v[58:61], a[188:191], v[30:33], v[58:61]
    ds_read_b64_tr_b16 v[28:29], v6 offset:18688
    v_fma_f32 v75, -v98, v98, v75
    v_mfma_f32_16x16x32_bf16 v[58:61], a[200:203], v[34:37], v[58:61]
    global_load_lds_dwordx4 v117, s[24:25] offset:0 sc1
    v_max_f32 v101, 0x3727c5ac, v75
    v_mfma_f32_16x16x32_bf16 v[58:61], a[212:215], v[38:41], v[58:61]
    v_rsq_f32 v76, v101
    v_mfma_f32_16x16x32_bf16 v[58:61], a[224:227], v[42:45], v[58:61]
    v_mul_f32 v99, 0xc0135761, v76
    v_mul_f32 v76, v76, v76
    v_mfma_f32_16x16x32_bf16 v[58:61], a[236:239], v[46:49], v[58:61]
    s_waitcnt lgkmcnt(6)
    v_mul_f32 v76, 0x3d372713, v76
    v_mul_f32 v100, v99, v76
    v_mov_b32 v123, v0
    v_mfma_f32_16x16x32_bf16 v[78:81], v[10:13], v[10:13], 0
    ds_read_b64_tr_b16 v[30:31], v7 offset:10240
    global_load_lds_dwordx4 v117, s[24:25] offset:1024 sc1
    v_fma_f32 v50, -v98, v82, v50
    v_mfma_f32_16x16x32_bf16 v[78:81], v[14:17], v[14:17], v[78:81]
    s_waitcnt lgkmcnt(3)
    v_fma_f32 v51, -v98, v83, v51
    v_mul_f32 v106, v50, v50
    v_mul_f32 v107, v51, v51
    v_mfma_f32_16x16x32_bf16 v[78:81], v[18:21], v[18:21], v[78:81]
    s_add_u32 m0, s58, 0
    ds_read_b64_tr_b16 v[32:33], v7 offset:10496
    v_fma_f32 v106, v106, v100, v99
    v_add_u32 v117, 655360, v117
    v_mfma_f32_16x16x32_bf16 v[78:81], v[22:25], v[22:25], v[78:81]
    s_waitcnt lgkmcnt(2)
    v_fma_f32 v107, v107, v100, v99
    v_mul_f32 v106, v106, v50
    v_mfma_f32_16x16x32_bf16 v[78:81], v[26:29], v[26:29], v[78:81]
    ds_read_b64_tr_b16 v[34:35], v7 offset:12288
    v_mul_f32 v107, v107, v51
    v_mfma_f32_16x16x32_bf16 v[74:77], v[94:97], v[10:13], 0
    global_load_lds_dwordx4 v117, s[20:21] offset:0 sc1
    v_exp_f32 v106, v106
    v_mfma_f32_16x16x32_bf16 v[74:77], v[94:97], v[14:17], v[74:77]
    ds_read_b64_tr_b16 v[36:37], v7 offset:12544
    v_exp_f32 v107, v107
    v_mfma_f32_16x16x32_bf16 v[74:77], v[94:97], v[18:21], v[74:77]
    v_fma_f32 v52, -v98, v84, v52
    v_fma_f32 v53, -v98, v85, v53
    v_mfma_f32_16x16x32_bf16 v[74:77], v[94:97], v[22:25], v[74:77]
    ds_read_b64_tr_b16 v[38:39], v7 offset:14336
    v_fma_f32 v106, v106, v101, v101
    v_mfma_f32_16x16x32_bf16 v[74:77], v[94:97], v[26:29], v[74:77]
    v_fma_f32 v107, v107, v101, v101
    v_rcp_f32 v106, v106
    v_mfma_f32_16x16x32_bf16 v[70:73], a[8:11], v[10:13], 0
    v_rcp_f32 v107, v107
    v_mfma_f32_16x16x32_bf16 v[70:73], a[20:23], v[14:17], v[70:73]
    ds_read_b64_tr_b16 v[40:41], v7 offset:14592
    global_load_dwordx4 v[160:163], v253, s[24:25] offset:0 sc1
    v_mul_f32 v50, v50, v52
    v_mfma_f32_16x16x32_bf16 v[70:73], a[32:35], v[18:21], v[70:73]
    v_cndmask_b32 v75, v78, v79, s[50:51]
    v_cndmask_b32 v75, v75, v80, s[52:53]
    v_cndmask_b32 v75, abs(v75), abs(v81), s[54:55]
    v_mfma_f32_16x16x32_bf16 v[70:73], a[44:47], v[22:25], v[70:73]
    ds_write_b64 v125, v[74:75] offset:512
    v_mfma_f32_16x16x32_bf16 v[70:73], a[56:59], v[26:29], v[70:73]
    v_mul_f32 v51, v51, v53
    v_mul_f32 v50, v50, v106
    v_mfma_f32_16x16x32_bf16 v[66:69], a[4:7], v[10:13], 0
    ds_read_b64_tr_b16 v[42:43], v7 offset:16384
    v_mul_f32 v51, v51, v107
    v_mfma_f32_16x16x32_bf16 v[66:69], a[16:19], v[14:17], v[66:69]
    ds_read_b64_tr_b16 v[44:45], v7 offset:16640
    global_load_lds_dwordx4 v117, s[20:21] offset:1024 sc1
    v_mfma_f32_16x16x32_bf16 v[66:69], a[28:31], v[18:21], v[66:69]
    ds_read_b64_tr_b16 v[46:47], v7 offset:18432
    v_cvt_pk_bf16_f32 v120, v50, v51
    v_mfma_f32_16x16x32_bf16 v[66:69], a[40:43], v[22:25], v[66:69]
    v_fma_f32 v54, -v98, v86, v54
    v_fma_f32 v55, -v98, v87, v55
    v_mfma_f32_16x16x32_bf16 v[66:69], a[52:55], v[26:29], v[66:69]
    ds_read_b64_tr_b16 v[48:49], v7 offset:18688
    v_mul_f32 v106, v54, v54
    v_mfma_f32_16x16x32_bf16 v[62:65], a[0:3], v[10:13], 0
    v_mul_f32 v107, v55, v55
    v_fma_f32 v106, v106, v100, v99
    v_mfma_f32_16x16x32_bf16 v[62:65], a[12:15], v[14:17], v[62:65]
    global_load_dwordx4 v[164:167], v253, s[24:25] offset:1024 sc1
    v_fma_f32 v107, v107, v100, v99
    v_mfma_f32_16x16x32_bf16 v[62:65], a[24:27], v[18:21], v[62:65]
    v_mul_f32 v106, v106, v54
    v_mul_f32 v107, v107, v55
    v_mfma_f32_16x16x32_bf16 v[62:65], a[36:39], v[22:25], v[62:65]
    v_exp_f32 v106, v106
    v_mfma_f32_16x16x32_bf16 v[62:65], a[48:51], v[26:29], v[62:65]
    s_waitcnt lgkmcnt(7)
    v_exp_f32 v107, v107
    v_mfma_f32_16x16x32_bf16 v[62:65], a[60:63], v[30:33], v[62:65]
    ds_read_b64_tr_b16 v[10:11], v8 offset:10240
    v_fma_f32 v56, -v98, v88, v56
    v_mfma_f32_16x16x32_bf16 v[62:65], a[72:75], v[34:37], v[62:65]
    s_waitcnt lgkmcnt(3)
    ds_read_b64_tr_b16 v[12:13], v8 offset:10496
    global_load_lds_dwordx4 v117, s[20:21] offset:2048 sc1
    v_mfma_f32_16x16x32_bf16 v[62:65], a[84:87], v[38:41], v[62:65]
    ds_read_b64_tr_b16 v[14:15], v8 offset:12288
    v_fma_f32 v57, -v98, v89, v57
    v_mfma_f32_16x16x32_bf16 v[62:65], a[96:99], v[42:45], v[62:65]
    s_waitcnt lgkmcnt(3)
    ds_read_b64_tr_b16 v[16:17], v8 offset:12544
    v_fma_f32 v106, v106, v101, v101
    v_mfma_f32_16x16x32_bf16 v[62:65], a[108:111], v[46:49], v[62:65]
    ds_read_b64_tr_b16 v[18:19], v8 offset:14336
    v_fma_f32 v107, v107, v101, v101
    v_mfma_f32_16x16x32_bf16 v[66:69], a[64:67], v[30:33], v[66:69]
    v_rcp_f32 v106, v106
    v_mfma_f32_16x16x32_bf16 v[66:69], a[76:79], v[34:37], v[66:69]
    ds_read_b64_tr_b16 v[20:21], v8 offset:14592
    v_rcp_f32 v107, v107
    v_mfma_f32_16x16x32_bf16 v[66:69], a[88:91], v[38:41], v[66:69]
    ds_read_b64_tr_b16 v[22:23], v8 offset:16384
    global_load_dwordx4 v[168:171], v253, s[24:25] offset:2048 sc1
    v_mul_f32 v54, v54, v56
    v_mfma_f32_16x16x32_bf16 v[66:69], a[100:103], v[42:45], v[66:69]
    ds_read_b64_tr_b16 v[24:25], v8 offset:16640
    v_mul_f32 v55, v55, v57
    v_mul_f32 v54, v54, v106
    v_mfma_f32_16x16x32_bf16 v[66:69], a[112:115], v[46:49], v[66:69]
    ds_read_b64_tr_b16 v[26:27], v8 offset:18432
    v_mul_f32 v55, v55, v107
    v_cvt_pk_bf16_f32 v121, v54, v55
    v_mfma_f32_16x16x32_bf16 v[70:73], a[68:71], v[30:33], v[70:73]
    ds_read_b64_tr_b16 v[28:29], v8 offset:18688
    v_fma_f32 v58, -v98, v90, v58
    v_fma_f32 v59, -v98, v91, v59
    v_mfma_f32_16x16x32_bf16 v[70:73], a[80:83], v[34:37], v[70:73]
    v_mul_f32 v106, v58, v58
    v_mul_f32 v107, v59, v59
    v_fma_f32 v106, v106, v100, v99
    v_mfma_f32_16x16x32_bf16 v[70:73], a[92:95], v[38:41], v[70:73]
    global_load_lds_dwordx4 v117, s[20:21] offset:3072 sc1
    v_fma_f32 v107, v107, v100, v99
    v_mul_f32 v106, v106, v58
    v_mfma_f32_16x16x32_bf16 v[70:73], a[104:107], v[42:45], v[70:73]
    v_mul_f32 v107, v107, v59
    v_exp_f32 v106, v106
    v_mfma_f32_16x16x32_bf16 v[70:73], a[116:119], v[46:49], v[70:73]
    s_waitcnt lgkmcnt(6)
    v_exp_f32 v107, v107
    v_mfma_f32_16x16x32_bf16 v[70:73], a[128:131], v[10:13], v[70:73]
    ds_read_b64_tr_b16 v[30:31], v9 offset:10240
    v_fma_f32 v60, -v98, v92, v60
    v_fma_f32 v61, -v98, v93, v61
    v_mfma_f32_16x16x32_bf16 v[70:73], a[140:143], v[14:17], v[70:73]
    s_waitcnt lgkmcnt(3)
    ds_read_b64_tr_b16 v[32:33], v9 offset:10496
    v_permlane32_swap_b32 v121, v123
    v_mfma_f32_16x16x32_bf16 v[70:73], a[152:155], v[18:21], v[70:73]
    ds_read_b64_tr_b16 v[34:35], v9 offset:12288
    global_load_dwordx4 v[172:175], v253, s[24:25] offset:3072 sc1
    v_mfma_f32_16x16x32_bf16 v[70:73], a[164:167], v[22:25], v[70:73]
    s_waitcnt lgkmcnt(3)
    ds_read_b64_tr_b16 v[36:37], v9 offset:12544
    v_fma_f32 v106, v106, v101, v101
    v_fma_f32 v107, v107, v101, v101
    v_mfma_f32_16x16x32_bf16 v[70:73], a[176:179], v[26:29], v[70:73]
    s_add_u32 m0, s58, 4096
    ds_read_b64_tr_b16 v[38:39], v9 offset:14336
    v_rcp_f32 v106, v106
    v_mfma_f32_16x16x32_bf16 v[66:69], a[124:127], v[10:13], v[66:69]
    v_rcp_f32 v107, v107
    v_mfma_f32_16x16x32_bf16 v[66:69], a[136:139], v[14:17], v[66:69]
    s_waitcnt vmcnt(8)
    ds_read_b64_tr_b16 v[40:41], v9 offset:14592
    v_mfma_f32_16x16x32_bf16 v[66:69], a[148:151], v[18:21], v[66:69]
    s_barrier
    ds_read_b128 v[74:77], v126 offset:512
    global_load_lds_dwordx4 v117, s[22:23] offset:0 sc1
    v_mfma_f32_16x16x32_bf16 v[66:69], a[160:163], v[22:25], v[66:69]
    ds_read_b128 v[78:81], v126 offset:528
    v_mul_f32 v58, v58, v60
    v_mfma_f32_16x16x32_bf16 v[66:69], a[172:175], v[26:29], v[66:69]
    ds_read_b64_tr_b16 v[42:43], v9 offset:16384
    ds_read_b64_tr_b16 v[44:45], v9 offset:16640
    v_mfma_f32_16x16x32_bf16 v[62:65], a[120:123], v[10:13], v[62:65]
    ds_read_b64_tr_b16 v[46:47], v9 offset:18432
    v_mul_f32 v59, v59, v61
    v_mul_f32 v58, v58, v106
    v_mfma_f32_16x16x32_bf16 v[62:65], a[132:135], v[14:17], v[62:65]
    s_add_u32 s3, s56, 106496
    ds_read_b64_tr_b16 v[48:49], v9 offset:18688
    v_mul_f32 v59, v59, v107
    v_cvt_pk_bf16_f32 v122, v58, v59
    v_mfma_f32_16x16x32_bf16 v[62:65], a[144:147], v[18:21], v[62:65]
    s_nop 0
    v_permlane32_swap_b32 v120, v122
    v_mfma_f32_16x16x32_bf16 v[62:65], a[156:159], v[22:25], v[62:65]
    global_load_dwordx4 v[176:179], v253, s[26:27] offset:0 sc1
    v_permlane16_swap_b32 v120, v121
    v_mfma_f32_16x16x32_bf16 v[62:65], a[168:171], v[26:29], v[62:65]
    s_waitcnt lgkmcnt(8)
    s_waitcnt lgkmcnt(4)
    v_mfma_f32_16x16x32_bf16 v[62:65], a[180:183], v[30:33], v[62:65]
    ds_read_b64_tr_b16 v[10:11], v2 offset:20480
    v_permlane16_swap_b32 v122, v123
    v_mfma_f32_16x16x32_bf16 v[62:65], a[192:195], v[34:37], v[62:65]
    s_waitcnt lgkmcnt(3)
    ds_read_b64_tr_b16 v[12:13], v2 offset:20736
    v_add_f32 v74, v74, v76
    v_mfma_f32_16x16x32_bf16 v[62:65], a[204:207], v[38:41], v[62:65]
    ds_read_b64_tr_b16 v[14:15], v2 offset:22528
    v_add_f32 v75, v75, v77
    v_mfma_f32_16x16x32_bf16 v[62:65], a[216:219], v[42:45], v[62:65]
    s_waitcnt lgkmcnt(3)
    ds_read_b64_tr_b16 v[16:17], v2 offset:22784
    global_load_lds_dwordx4 v117, s[22:23] offset:1024 sc1
    v_mfma_f32_16x16x32_bf16 v[62:65], a[228:231], v[46:49], v[62:65]
    ds_read_b64_tr_b16 v[18:19], v2 offset:24576
    v_add_f32 v78, v78, v80
    v_mfma_f32_16x16x32_bf16 v[66:69], a[184:187], v[30:33], v[66:69]
    buffer_store_dwordx4 v[120:123], v124, s[40:43], s3 offen sc1
    v_mfma_f32_16x16x32_bf16 v[66:69], a[196:199], v[34:37], v[66:69]
    ds_read_b64_tr_b16 v[20:21], v2 offset:24832
    v_add_f32 v79, v79, v81
    v_mfma_f32_16x16x32_bf16 v[66:69], a[208:211], v[38:41], v[66:69]
    ds_read_b64_tr_b16 v[22:23], v2 offset:26624
    v_add_f32 v74, v74, v78
    v_mfma_f32_16x16x32_bf16 v[66:69], a[220:223], v[42:45], v[66:69]
    ds_read_b64_tr_b16 v[24:25], v2 offset:26880
    global_load_dwordx4 v[180:183], v253, s[26:27] offset:1024 sc1
    v_mfma_f32_16x16x32_bf16 v[66:69], a[232:235], v[46:49], v[66:69]
    ds_read_b64_tr_b16 v[26:27], v2 offset:28672
    v_add_f32 v75, v75, v79
    v_mfma_f32_16x16x32_bf16 v[70:73], a[188:191], v[30:33], v[70:73]
    ds_read_b64_tr_b16 v[28:29], v2 offset:28928
    v_mul_f32 v102, 0x3acccccd, v74
    v_mfma_f32_16x16x32_bf16 v[70:73], a[200:203], v[34:37], v[70:73]
    v_fma_f32 v75, abs(v75), s32, v114
    v_fma_f32 v75, -v102, v102, v75
    v_mfma_f32_16x16x32_bf16 v[70:73], a[212:215], v[38:41], v[70:73]
    v_max_f32 v105, 0x3727c5ac, v75
    v_rsq_f32 v76, v105
    v_mfma_f32_16x16x32_bf16 v[70:73], a[224:227], v[42:45], v[70:73]
    global_load_lds_dwordx4 v117, s[22:23] offset:2048 sc1
    v_mul_f32 v103, 0xc0135761, v76
    v_mfma_f32_16x16x32_bf16 v[70:73], a[236:239], v[46:49], v[70:73]
    s_waitcnt lgkmcnt(6)
    v_mul_f32 v76, v76, v76
    v_mul_f32 v76, 0x3d372713, v76
    v_mul_f32 v104, v103, v76
    v_mfma_f32_16x16x32_bf16 v[78:81], v[10:13], v[10:13], 0
    ds_read_b64_tr_b16 v[30:31], v3 offset:20480
    v_mov_b32 v123, v0
    v_mfma_f32_16x16x32_bf16 v[78:81], v[14:17], v[14:17], v[78:81]
    s_waitcnt lgkmcnt(3)
    ds_read_b64_tr_b16 v[110:111], v108 offset:20480
    v_fma_f32 v62, -v102, v82, v62
    v_mfma_f32_16x16x32_bf16 v[78:81], v[18:21], v[18:21], v[78:81]
    ds_read_b64_tr_b16 v[32:33], v3 offset:20736
    v_fma_f32 v63, -v102, v83, v63
    v_mfma_f32_16x16x32_bf16 v[78:81], v[22:25], v[22:25], v[78:81]
    s_waitcnt lgkmcnt(3)
    v_mul_f32 v106, v62, v62
    v_mul_f32 v107, v63, v63
    v_mfma_f32_16x16x32_bf16 v[78:81], v[26:29], v[26:29], v[78:81]
    ds_read_b64_tr_b16 v[34:35], v3 offset:22528
    global_load_dwordx4 v[184:187], v253, s[26:27] offset:2048 sc1
    v_fma_f32 v106, v106, v104, v103
    v_mfma_f32_16x16x32_bf16 v[74:77], v[94:97], v[10:13], 0
    v_fma_f32 v107, v107, v104, v103
    v_mul_f32 v106, v106, v62
    v_mul_f32 v107, v107, v63
    v_mfma_f32_16x16x32_bf16 v[74:77], v[94:97], v[14:17], v[74:77]
    ds_read_b64_tr_b16 v[36:37], v3 offset:22784
    v_exp_f32 v106, v106
    v_mfma_f32_16x16x32_bf16 v[74:77], v[94:97], v[18:21], v[74:77]
    v_exp_f32 v107, v107
    v_mfma_f32_16x16x32_bf16 v[74:77], v[94:97], v[22:25], v[74:77]
    ds_read_b64_tr_b16 v[38:39], v3 offset:24576
    v_fma_f32 v64, -v102, v84, v64
    v_mfma_f32_16x16x32_bf16 v[74:77], v[94:97], v[26:29], v[74:77]
    global_load_lds_dwordx4 v117, s[22:23] offset:3072 sc1
    v_fma_f32 v65, -v102, v85, v65
    v_fma_f32 v106, v106, v105, v105
    v_mfma_f32_16x16x32_bf16 v[58:61], a[8:11], v[10:13], 0
    v_fma_f32 v107, v107, v105, v105
    v_rcp_f32 v106, v106
    v_mfma_f32_16x16x32_bf16 v[58:61], a[20:23], v[14:17], v[58:61]
    ds_read_b64_tr_b16 v[40:41], v3 offset:24832
    v_rcp_f32 v107, v107
    v_mfma_f32_16x16x32_bf16 v[58:61], a[32:35], v[18:21], v[58:61]
    v_add_u32 v253, s5, v252
    v_mul_f32 v62, v62, v64
    v_cndmask_b32 v75, v78, v79, s[50:51]
    v_mfma_f32_16x16x32_bf16 v[58:61], a[44:47], v[22:25], v[58:61]
    ds_read_b64_tr_b16 v[42:43], v3 offset:26624
    v_cndmask_b32 v75, v75, v80, s[52:53]
    v_cndmask_b32 v75, abs(v75), abs(v81), s[54:55]
    v_mfma_f32_16x16x32_bf16 v[58:61], a[56:59], v[26:29], v[58:61]
    ds_write_b64 v125, v[74:75] offset:0
    v_mfma_f32_16x16x32_bf16 v[54:57], a[4:7], v[10:13], 0
    global_load_dwordx4 v[188:191], v253, s[20:21] offset:0 sc1
    v_mul_f32 v63, v63, v65
    v_mfma_f32_16x16x32_bf16 v[54:57], a[16:19], v[14:17], v[54:57]
    s_add_u32 m0, s58, 8192
    ds_read_b64_tr_b16 v[44:45], v3 offset:26880
    v_mul_f32 v62, v62, v106
    v_mfma_f32_16x16x32_bf16 v[54:57], a[28:31], v[18:21], v[54:57]
    ds_read_b64_tr_b16 v[46:47], v3 offset:28672
    v_mul_f32 v63, v63, v107
    v_mfma_f32_16x16x32_bf16 v[54:57], a[40:43], v[22:25], v[54:57]
    s_waitcnt lgkmcnt(9)
    ds_write_b64 v109, v[110:111] offset:5632
    v_mfma_f32_16x16x32_bf16 v[54:57], a[52:55], v[26:29], v[54:57]
    global_load_lds_dwordx4 v117, s[24:25] offset:0 sc1
    v_cvt_pk_bf16_f32 v120, v62, v63
    v_mfma_f32_16x16x32_bf16 v[50:53], a[0:3], v[10:13], 0
    ds_read_b64_tr_b16 v[48:49], v3 offset:28928
    v_fma_f32 v66, -v102, v86, v66
    v_mfma_f32_16x16x32_bf16 v[50:53], a[12:15], v[14:17], v[50:53]
    ds_read_b64_tr_b16 v[110:111], v112 offset:24576
    v_fma_f32 v67, -v102, v87, v67
    v_mfma_f32_16x16x32_bf16 v[50:53], a[24:27], v[18:21], v[50:53]
    v_mul_f32 v106, v66, v66
    v_mul_f32 v107, v67, v67
    v_mfma_f32_16x16x32_bf16 v[50:53], a[36:39], v[22:25], v[50:53]
    v_fma_f32 v106, v106, v104, v103
    v_fma_f32 v107, v107, v104, v103
    v_mfma_f32_16x16x32_bf16 v[50:53], a[48:51], v[26:29], v[50:53]
    s_waitcnt lgkmcnt(9)
    v_mul_f32 v106, v106, v66
    v_mul_f32 v107, v107, v67
    v_mfma_f32_16x16x32_bf16 v[50:53], a[60:63], v[30:33], v[50:53]
    ds_read_b64_tr_b16 v[10:11], v4 offset:20480
    global_load_dwordx4 v[192:195], v253, s[20:21] offset:1024 sc1
    v_mfma_f32_16x16x32_bf16 v[50:53], a[72:75], v[34:37], v[50:53]
    s_waitcnt lgkmcnt(5)
    ds_read_b64_tr_b16 v[12:13], v4 offset:20736
    v_exp_f32 v106, v106
    v_mfma_f32_16x16x32_bf16 v[50:53], a[84:87], v[38:41], v[50:53]
    ds_read_b64_tr_b16 v[14:15], v4 offset:22528
    v_exp_f32 v107, v107
    v_mfma_f32_16x16x32_bf16 v[50:53], a[96:99], v[42:45], v[50:53]
    s_waitcnt lgkmcnt(4)
    ds_read_b64_tr_b16 v[16:17], v4 offset:22784
    v_fma_f32 v68, -v102, v88, v68
    v_mfma_f32_16x16x32_bf16 v[50:53], a[108:111], v[46:49], v[50:53]
    ds_read_b64_tr_b16 v[18:19], v4 offset:24576
    v_fma_f32 v69, -v102, v89, v69
    v_mfma_f32_16x16x32_bf16 v[54:57], a[64:67], v[30:33], v[54:57]
    global_load_lds_dwordx4 v117, s[24:25] offset:1024 sc1
    v_fma_f32 v106, v106, v105, v105
    v_mfma_f32_16x16x32_bf16 v[54:57], a[76:79], v[34:37], v[54:57]
    ds_read_b64_tr_b16 v[20:21], v4 offset:24832
    v_fma_f32 v107, v107, v105, v105
    v_mfma_f32_16x16x32_bf16 v[54:57], a[88:91], v[38:41], v[54:57]
    ds_read_b64_tr_b16 v[22:23], v4 offset:26624
    v_rcp_f32 v106, v106
    v_mfma_f32_16x16x32_bf16 v[54:57], a[100:103], v[42:45], v[54:57]
    ds_read_b64_tr_b16 v[24:25], v4 offset:26880
    v_rcp_f32 v107, v107
    v_mfma_f32_16x16x32_bf16 v[54:57], a[112:115], v[46:49], v[54:57]
    ds_read_b64_tr_b16 v[26:27], v4 offset:28672
    v_mul_f32 v66, v66, v68
    v_mfma_f32_16x16x32_bf16 v[58:61], a[68:71], v[30:33], v[58:61]
    ds_read_b64_tr_b16 v[28:29], v4 offset:28928
    global_load_dwordx4 v[196:199], v253, s[20:21] offset:2048 sc1
    v_mfma_f32_16x16x32_bf16 v[58:61], a[80:83], v[34:37], v[58:61]
    s_barrier
    ds_read_b128 v[74:77], v126 offset:0
    v_mul_f32 v67, v67, v69
    v_mfma_f32_16x16x32_bf16 v[58:61], a[92:95], v[38:41], v[58:61]
    ds_read_b128 v[78:81], v126 offset:16
    v_mul_f32 v66, v66, v106
    v_mfma_f32_16x16x32_bf16 v[58:61], a[104:107], v[42:45], v[58:61]
    s_waitcnt lgkmcnt(12)
    ds_write_b64 v113, v[110:111] offset:5760
    v_mfma_f32_16x16x32_bf16 v[58:61], a[116:119], v[46:49], v[58:61]
    s_waitcnt lgkmcnt(9)
    v_mul_f32 v67, v67, v107
    v_cvt_pk_bf16_f32 v121, v66, v67
    v_mfma_f32_16x16x32_bf16 v[58:61], a[128:131], v[10:13], v[58:61]
    ds_read_b64_tr_b16 v[30:31], v5 offset:20480
    global_load_dwordx4 v[200:203], v253, s[20:21] offset:3072 sc1
    v_mfma_f32_16x16x32_bf16 v[58:61], a[140:143], v[14:17], v[58:61]
    s_waitcnt lgkmcnt(6)
    ds_read_b64_tr_b16 v[32:33], v5 offset:20736
    v_fma_f32 v70, -v102, v90, v70
    v_fma_f32 v71, -v102, v91, v71
    v_mfma_f32_16x16x32_bf16 v[58:61], a[152:155], v[18:21], v[58:61]
    ds_read_b64_tr_b16 v[34:35], v5 offset:22528
    v_mul_f32 v106, v70, v70
    v_mul_f32 v107, v71, v71
    v_mfma_f32_16x16x32_bf16 v[58:61], a[164:167], v[22:25], v[58:61]
    s_waitcnt lgkmcnt(6)
    ds_read_b64_tr_b16 v[36:37], v5 offset:22784
    v_fma_f32 v106, v106, v104, v103
    v_fma_f32 v107, v107, v104, v103
    v_mfma_f32_16x16x32_bf16 v[58:61], a[176:179], v[26:29], v[58:61]
    s_waitcnt lgkmcnt(5)
    ds_read_b64_tr_b16 v[38:39], v5 offset:24576
    v_mul_f32 v106, v106, v70
    v_mul_f32 v107, v107, v71
    v_mfma_f32_16x16x32_bf16 v[54:57], a[124:127], v[10:13], v[54:57]
    global_load_dwordx4 v[204:207], v253, s[22:23] offset:0 sc1
    v_exp_f32 v106, v106
    v_mfma_f32_16x16x32_bf16 v[54:57], a[136:139], v[14:17], v[54:57]
    ds_read_b64_tr_b16 v[40:41], v5 offset:24832
    v_add_f32 v74, v74, v76
    v_mfma_f32_16x16x32_bf16 v[54:57], a[148:151], v[18:21], v[54:57]
    ds_read_b64_tr_b16 v[42:43], v5 offset:26624
    v_exp_f32 v107, v107
    v_mfma_f32_16x16x32_bf16 v[54:57], a[160:163], v[22:25], v[54:57]
    ds_read_b64_tr_b16 v[44:45], v5 offset:26880
    v_fma_f32 v72, -v102, v92, v72
    v_fma_f32 v73, -v102, v93, v73
    v_mfma_f32_16x16x32_bf16 v[54:57], a[172:175], v[26:29], v[54:57]
    ds_read_b64_tr_b16 v[46:47], v5 offset:28672
    v_add_f32 v75, v75, v77
    v_add_f32 v78, v78, v80
    v_mfma_f32_16x16x32_bf16 v[50:53], a[120:123], v[10:13], v[50:53]
    ds_read_b64_tr_b16 v[48:49], v5 offset:28928
    v_permlane32_swap_b32 v121, v123
    v_mfma_f32_16x16x32_bf16 v[50:53], a[132:135], v[14:17], v[50:53]
    global_load_dwordx4 v[208:211], v253, s[22:23] offset:1024 sc1
    v_fma_f32 v106, v106, v105, v105
    v_fma_f32 v107, v107, v105, v105
    v_mfma_f32_16x16x32_bf16 v[50:53], a[144:147], v[18:21], v[50:53]
L_padB_5:
    s_cbranch_execz L_backB
    v_add_f32 v79, v79, v81
    v_rcp_f32 v106, v106
    v_mfma_f32_16x16x32_bf16 v[50:53], a[156:159], v[22:25], v[50:53]
    v_rcp_f32 v107, v107
    v_mfma_f32_16x16x32_bf16 v[50:53], a[168:171], v[26:29], v[50:53]
    s_waitcnt lgkmcnt(6)
    v_mul_f32 v70, v70, v72
    v_mul_f32 v71, v71, v73
    v_mul_f32 v70, v70, v106
    v_mfma_f32_16x16x32_bf16 v[50:53], a[180:183], v[30:33], v[50:53]
    s_add_u32 s3, s56, 159744
    ds_read_b64_tr_b16 v[10:11], v6 offset:20480
    v_mul_f32 v71, v71, v107
    v_cvt_pk_bf16_f32 v122, v70, v71
    v_mfma_f32_16x16x32_bf16 v[50:53], a[192:195], v[34:37], v[50:53]
    s_waitcnt lgkmcnt(3)
    ds_read_b64_tr_b16 v[12:13], v6 offset:20736
    global_load_dwordx4 v[212:215], v253, s[22:23] offset:2048 sc1
    v_mfma_f32_16x16x32_bf16 v[50:53], a[204:207], v[38:41], v[50:53]
    ds_read_b64_tr_b16 v[14:15], v6 offset:22528
    v_permlane32_swap_b32 v120, v122
    v_mfma_f32_16x16x32_bf16 v[50:53], a[216:219], v[42:45], v[50:53]
    s_waitcnt lgkmcnt(3)
    ds_read_b64_tr_b16 v[16:17], v6 offset:22784
    v_add_f32 v74, v74, v78
    v_mfma_f32_16x16x32_bf16 v[50:53], a[228:231], v[46:49], v[50:53]
    ds_read_b64_tr_b16 v[18:19], v6 offset:24576
    v_permlane16_swap_b32 v120, v121
    v_mfma_f32_16x16x32_bf16 v[54:57], a[184:187], v[30:33], v[54:57]
    s_waitcnt vmcnt(13)
    v_permlane16_swap_b32 v122, v123
    v_mfma_f32_16x16x32_bf16 v[54:57], a[196:199], v[34:37], v[54:57]
    ds_read_b64_tr_b16 v[20:21], v6 offset:24832
    global_load_dwordx4 v[216:219], v253, s[22:23] offset:3072 sc1
    v_mfma_f32_16x16x32_bf16 v[54:57], a[208:211], v[38:41], v[54:57]
    ds_read_b64_tr_b16 v[22:23], v6 offset:26624
    v_add_f32 v75, v75, v79
    v_mfma_f32_16x16x32_bf16 v[54:57], a[220:223], v[42:45], v[54:57]
    ds_read_b64_tr_b16 v[24:25], v6 offset:26880
    v_mul_f32 v98, 0x3acccccd, v74
    v_mfma_f32_16x16x32_bf16 v[54:57], a[232:235], v[46:49], v[54:57]
    ds_read_b64_tr_b16 v[26:27], v6 offset:28672
    buffer_store_dwordx4 v[120:123], v124, s[40:43], s3 offen sc1
    v_mfma_f32_16x16x32_bf16 v[58:61], a[188:191], v[30:33], v[58:61]
    ds_read_b64_tr_b16 v[28:29], v6 offset:28928
    v_fma_f32 v75, abs(v75), s32, v114
    v_mfma_f32_16x16x32_bf16 v[58:61], a[200:203], v[34:37], v[58:61]
    global_load_dwordx4 v[220:223], v253, s[24:25] offset:0 sc1
    v_fma_f32 v75, -v98, v98, v75
    v_mfma_f32_16x16x32_bf16 v[58:61], a[212:215], v[38:41], v[58:61]
    v_max_f32 v101, 0x3727c5ac, v75
    v_rsq_f32 v76, v101
    v_mfma_f32_16x16x32_bf16 v[58:61], a[224:227], v[42:45], v[58:61]
    v_mul_f32 v99, 0xc0135761, v76
    v_mul_f32 v76, v76, v76
    v_mfma_f32_16x16x32_bf16 v[58:61], a[236:239], v[46:49], v[58:61]
    s_waitcnt lgkmcnt(6)
    v_mul_f32 v76, 0x3d372713, v76
    v_mul_f32 v100, v99, v76
    v_mfma_f32_16x16x32_bf16 v[78:81], v[10:13], v[10:13], 0
    ds_read_b64_tr_b16 v[30:31], v7 offset:20480
    v_mov_b32 v123, v0
    v_mfma_f32_16x16x32_bf16 v[78:81], v[14:17], v[14:17], v[78:81]
    s_waitcnt lgkmcnt(3)
    v_fma_f32 v50, -v98, v82, v50
    v_fma_f32 v51, -v98, v83, v51
    v_mfma_f32_16x16x32_bf16 v[78:81], v[18:21], v[18:21], v[78:81]
    ds_read_b64_tr_b16 v[32:33], v7 offset:20736
    global_load_dwordx4 v[224:227], v253, s[24:25] offset:1024 sc1
    v_mfma_f32_16x16x32_bf16 v[78:81], v[22:25], v[22:25], v[78:81]
    s_waitcnt lgkmcnt(2)
    v_mul_f32 v106, v50, v50
    v_mul_f32 v107, v51, v51
    v_fma_f32 v106, v106, v100, v99
    v_mfma_f32_16x16x32_bf16 v[78:81], v[26:29], v[26:29], v[78:81]
    ds_read_b64_tr_b16 v[34:35], v7 offset:22528
    v_fma_f32 v107, v107, v100, v99
    v_mul_f32 v106, v106, v50
    v_mfma_f32_16x16x32_bf16 v[74:77], v[94:97], v[10:13], 0
    v_mul_f32 v107, v107, v51
    v_exp_f32 v106, v106
    v_mfma_f32_16x16x32_bf16 v[74:77], v[94:97], v[14:17], v[74:77]
    ds_read_b64_tr_b16 v[36:37], v7 offset:22784
    v_exp_f32 v107, v107
    v_mfma_f32_16x16x32_bf16 v[74:77], v[94:97], v[18:21], v[74:77]
    global_load_dwordx4 v[228:231], v253, s[24:25] offset:2048 sc1
    v_fma_f32 v52, -v98, v84, v52
    v_mfma_f32_16x16x32_bf16 v[74:77], v[94:97], v[22:25], v[74:77]
    ds_read_b64_tr_b16 v[38:39], v7 offset:24576
    v_fma_f32 v53, -v98, v85, v53
    v_fma_f32 v106, v106, v101, v101
    v_mfma_f32_16x16x32_bf16 v[74:77], v[94:97], v[26:29], v[74:77]
    v_fma_f32 v107, v107, v101, v101
    v_rcp_f32 v106, v106
    v_mfma_f32_16x16x32_bf16 v[70:73], a[8:11], v[10:13], 0
    s_mov_b32 s73, 0
    v_rcp_f32 v107, v107
    v_mfma_f32_16x16x32_bf16 v[70:73], a[20:23], v[14:17], v[70:73]
    ds_read_b64_tr_b16 v[40:41], v7 offset:24832
    buffer_load_dwordx2 v[254:255], v127, s[40:43], s73 offen sc1
    v_mfma_f32_16x16x32_bf16 v[70:73], a[32:35], v[18:21], v[70:73]
    global_load_dwordx4 v[232:235], v253, s[24:25] offset:3072 sc1
    v_mul_f32 v50, v50, v52
    v_cndmask_b32 v75, v78, v79, s[50:51]
    v_mfma_f32_16x16x32_bf16 v[70:73], a[44:47], v[22:25], v[70:73]
    ds_read_b64_tr_b16 v[42:43], v7 offset:26624
    v_cndmask_b32 v75, v75, v80, s[52:53]
    v_cndmask_b32 v75, abs(v75), abs(v81), s[54:55]
    v_mfma_f32_16x16x32_bf16 v[70:73], a[56:59], v[26:29], v[70:73]
    ds_write_b64 v125, v[74:75] offset:512
    v_mfma_f32_16x16x32_bf16 v[66:69], a[4:7], v[10:13], 0
    v_mul_f32 v51, v51, v53
    v_mul_f32 v50, v50, v106
    v_mfma_f32_16x16x32_bf16 v[66:69], a[16:19], v[14:17], v[66:69]
    ds_read_b64_tr_b16 v[44:45], v7 offset:26880
    v_mul_f32 v51, v51, v107
    v_mfma_f32_16x16x32_bf16 v[66:69], a[28:31], v[18:21], v[66:69]
    ds_read_b64_tr_b16 v[46:47], v7 offset:28672
    global_load_dwordx4 v[236:239], v253, s[26:27] offset:0 sc1
    v_mfma_f32_16x16x32_bf16 v[66:69], a[40:43], v[22:25], v[66:69]
    v_cvt_pk_bf16_f32 v120, v50, v51
    v_fma_f32 v54, -v98, v86, v54
    v_mfma_f32_16x16x32_bf16 v[66:69], a[52:55], v[26:29], v[66:69]
    ds_read_b64_tr_b16 v[48:49], v7 offset:28928
    v_fma_f32 v55, -v98, v87, v55
    v_mfma_f32_16x16x32_bf16 v[62:65], a[0:3], v[10:13], 0
    v_mul_f32 v106, v54, v54
    v_mul_f32 v107, v55, v55
    v_mfma_f32_16x16x32_bf16 v[62:65], a[12:15], v[14:17], v[62:65]
    v_fma_f32 v106, v106, v100, v99
    v_fma_f32 v107, v107, v100, v99
    v_mfma_f32_16x16x32_bf16 v[62:65], a[24:27], v[18:21], v[62:65]
    v_mul_f32 v106, v106, v54
    v_mul_f32 v107, v107, v55
    v_mfma_f32_16x16x32_bf16 v[62:65], a[36:39], v[22:25], v[62:65]
    global_load_dwordx4 v[240:243], v253, s[26:27] offset:1024 sc1
    v_exp_f32 v106, v106
    v_mfma_f32_16x16x32_bf16 v[62:65], a[48:51], v[26:29], v[62:65]
    s_waitcnt lgkmcnt(7)
    v_exp_f32 v107, v107
    v_mfma_f32_16x16x32_bf16 v[62:65], a[60:63], v[30:33], v[62:65]
    ds_read_b64_tr_b16 v[10:11], v8 offset:20480
    v_fma_f32 v56, -v98, v88, v56
    v_mfma_f32_16x16x32_bf16 v[62:65], a[72:75], v[34:37], v[62:65]
    s_waitcnt lgkmcnt(3)
    ds_read_b64_tr_b16 v[12:13], v8 offset:20736
    v_fma_f32 v57, -v98, v89, v57
    v_mfma_f32_16x16x32_bf16 v[62:65], a[84:87], v[38:41], v[62:65]
    ds_read_b64_tr_b16 v[14:15], v8 offset:22528
    v_fma_f32 v106, v106, v101, v101
    v_mfma_f32_16x16x32_bf16 v[62:65], a[96:99], v[42:45], v[62:65]
    s_waitcnt lgkmcnt(3)
    ds_read_b64_tr_b16 v[16:17], v8 offset:22784
    global_load_dwordx4 v[244:247], v253, s[26:27] offset:2048 sc1
    v_mfma_f32_16x16x32_bf16 v[62:65], a[108:111], v[46:49], v[62:65]
    ds_read_b64_tr_b16 v[18:19], v8 offset:24576
    v_fma_f32 v107, v107, v101, v101
    v_mfma_f32_16x16x32_bf16 v[66:69], a[64:67], v[30:33], v[66:69]
    v_rcp_f32 v106, v106
    v_mfma_f32_16x16x32_bf16 v[66:69], a[76:79], v[34:37], v[66:69]
    ds_read_b64_tr_b16 v[20:21], v8 offset:24832
    v_rcp_f32 v107, v107
    v_mfma_f32_16x16x32_bf16 v[66:69], a[88:91], v[38:41], v[66:69]
    ds_read_b64_tr_b16 v[22:23], v8 offset:26624
    v_add_u32 v253, s6, v252
    v_mfma_f32_16x16x32_bf16 v[66:69], a[100:103], v[42:45], v[66:69]
    ds_read_b64_tr_b16 v[24:25], v8 offset:26880
    global_load_dwordx4 v[248:251], v253, s[20:21] offset:0 sc1
    v_mfma_f32_16x16x32_bf16 v[66:69], a[112:115], v[46:49], v[66:69]
    ds_read_b64_tr_b16 v[26:27], v8 offset:28672
    v_mul_f32 v54, v54, v56
    v_mfma_f32_16x16x32_bf16 v[70:73], a[68:71], v[30:33], v[70:73]
    s_waitcnt vmcnt(16)
    ds_read_b64_tr_b16 v[28:29], v8 offset:28928
    v_mul_f32 v55, v55, v57
    v_mfma_f32_16x16x32_bf16 v[70:73], a[80:83], v[34:37], v[70:73]
    s_barrier
    ds_read_b128 v[74:77], v126 offset:512
    v_mul_f32 v54, v54, v106
    v_mul_f32 v55, v55, v107
    v_mfma_f32_16x16x32_bf16 v[70:73], a[92:95], v[38:41], v[70:73]
    ds_read_b128 v[78:81], v126 offset:528
    v_cvt_pk_bf16_f32 v121, v54, v55
    v_fma_f32 v58, -v98, v90, v58
    v_mfma_f32_16x16x32_bf16 v[70:73], a[104:107], v[42:45], v[70:73]
    global_load_dwordx4 a[240:243], v253, s[20:21] offset:1024 sc1
    v_fma_f32 v59, -v98, v91, v59
    v_mul_f32 v106, v58, v58
    v_mfma_f32_16x16x32_bf16 v[70:73], a[116:119], v[46:49], v[70:73]
    s_waitcnt lgkmcnt(8)
    v_mul_f32 v107, v59, v59
    v_fma_f32 v106, v106, v100, v99
    v_fma_f32 v107, v107, v100, v99
    v_mfma_f32_16x16x32_bf16 v[70:73], a[128:131], v[10:13], v[70:73]
    ds_read_b64_tr_b16 v[30:31], v9 offset:20480
    v_mul_f32 v106, v106, v58
    v_mul_f32 v107, v107, v59
    v_mfma_f32_16x16x32_bf16 v[70:73], a[140:143], v[14:17], v[70:73]
    s_waitcnt lgkmcnt(5)
    ds_read_b64_tr_b16 v[32:33], v9 offset:20736
    v_exp_f32 v106, v106
    v_mfma_f32_16x16x32_bf16 v[70:73], a[152:155], v[18:21], v[70:73]
    ds_read_b64_tr_b16 v[34:35], v9 offset:22528
    v_exp_f32 v107, v107
    v_mfma_f32_16x16x32_bf16 v[70:73], a[164:167], v[22:25], v[70:73]
    s_waitcnt lgkmcnt(5)
    ds_read_b64_tr_b16 v[36:37], v9 offset:22784
    global_load_dwordx4 a[244:247], v253, s[20:21] offset:2048 sc1
    v_mfma_f32_16x16x32_bf16 v[70:73], a[176:179], v[26:29], v[70:73]
    s_waitcnt lgkmcnt(4)
    ds_read_b64_tr_b16 v[38:39], v9 offset:24576
    v_fma_f32 v60, -v98, v92, v60
    v_mfma_f32_16x16x32_bf16 v[66:69], a[124:127], v[10:13], v[66:69]
    v_fma_f32 v61, -v98, v93, v61
    v_permlane32_swap_b32 v121, v123
    v_mfma_f32_16x16x32_bf16 v[66:69], a[136:139], v[14:17], v[66:69]
    ds_read_b64_tr_b16 v[40:41], v9 offset:24832
    v_fma_f32 v106, v106, v101, v101
    v_mfma_f32_16x16x32_bf16 v[66:69], a[148:151], v[18:21], v[66:69]
    ds_read_b64_tr_b16 v[42:43], v9 offset:26624
    v_fma_f32 v107, v107, v101, v101
    v_add_f32 v74, v74, v76
    v_mfma_f32_16x16x32_bf16 v[66:69], a[160:163], v[22:25], v[66:69]
    ds_read_b64_tr_b16 v[44:45], v9 offset:26880
    v_rcp_f32 v106, v106
    v_mfma_f32_16x16x32_bf16 v[66:69], a[172:175], v[26:29], v[66:69]
    ds_read_b64_tr_b16 v[46:47], v9 offset:28672
    global_load_dwordx4 a[248:251], v253, s[20:21] offset:3072 sc1
    v_mfma_f32_16x16x32_bf16 v[62:65], a[120:123], v[10:13], v[62:65]
    ds_read_b64_tr_b16 v[48:49], v9 offset:28928
    v_rcp_f32 v107, v107
    v_mfma_f32_16x16x32_bf16 v[62:65], a[132:135], v[14:17], v[62:65]
    v_mul_f32 v58, v58, v60
    v_mul_f32 v59, v59, v61
    v_mfma_f32_16x16x32_bf16 v[62:65], a[144:147], v[18:21], v[62:65]
    s_add_u32 s3, s56, 212992
    v_mul_f32 v58, v58, v106
    v_mul_f32 v59, v59, v107
    v_cvt_pk_bf16_f32 v122, v58, v59
    v_mfma_f32_16x16x32_bf16 v[62:65], a[156:159], v[22:25], v[62:65]
    s_nop 0
    v_permlane32_swap_b32 v120, v122
    v_mfma_f32_16x16x32_bf16 v[62:65], a[168:171], v[26:29], v[62:65]
    s_waitcnt lgkmcnt(6)
    v_permlane16_swap_b32 v120, v121
    v_mfma_f32_16x16x32_bf16 v[62:65], a[180:183], v[30:33], v[62:65]
    s_waitcnt vmcnt(12)
    ds_read_b64_tr_b16 v[10:11], v2 offset:0
    global_load_dwordx4 a[252:255], v253, s[22:23] offset:0 sc1
    v_mfma_f32_16x16x32_bf16 v[62:65], a[192:195], v[34:37], v[62:65]
    s_waitcnt lgkmcnt(3)
    s_add_u32 m0, s58, 9216
    ds_read_b64_tr_b16 v[12:13], v2 offset:256
    v_mfma_f32_16x16x32_bf16 v[62:65], a[204:207], v[38:41], v[62:65]
    ds_read_b64_tr_b16 v[14:15], v2 offset:2048
    v_add_f32 v75, v75, v77
    v_mfma_f32_16x16x32_bf16 v[62:65], a[216:219], v[42:45], v[62:65]
    s_waitcnt lgkmcnt(3)
    ds_read_b64_tr_b16 v[16:17], v2 offset:2304
    v_add_f32 v78, v78, v80
    v_add_f32 v79, v79, v81
    v_mfma_f32_16x16x32_bf16 v[62:65], a[228:231], v[46:49], v[62:65]
    ds_read_b64_tr_b16 v[18:19], v2 offset:4096
    global_load_lds_dwordx4 v253, s[22:23] offset:1024 sc1
    v_add_f32 v74, v74, v78
    v_mfma_f32_16x16x32_bf16 v[66:69], a[184:187], v[30:33], v[66:69]
    v_add_f32 v75, v75, v79
    v_permlane16_swap_b32 v122, v123
    v_mfma_f32_16x16x32_bf16 v[66:69], a[196:199], v[34:37], v[66:69]
    ds_read_b64_tr_b16 v[20:21], v2 offset:4352
    v_mul_f32 v102, 0x3acccccd, v74
    v_mfma_f32_16x16x32_bf16 v[66:69], a[208:211], v[38:41], v[66:69]
    ds_read_b64_tr_b16 v[22:23], v2 offset:6144
    v_fma_f32 v75, abs(v75), s32, v114
    v_fma_f32 v75, -v102, v102, v75
    v_mfma_f32_16x16x32_bf16 v[66:69], a[220:223], v[42:45], v[66:69]
    ds_read_b64_tr_b16 v[24:25], v2 offset:6400
    v_max_f32 v105, 0x3727c5ac, v75
    s_waitcnt vmcnt(10)
    v_cmp_ne_u64 vcc, s[44:45], v[254:255]
    v_mfma_f32_16x16x32_bf16 v[66:69], a[232:235], v[46:49], v[66:69]
    s_nop 0
    s_cbranch_vccnz L_retry_15
L_seen_16:
    ds_read_b64_tr_b16 v[26:27], v2 offset:8192
    buffer_store_dwordx4 v[120:123], v124, s[40:43], s3 offen sc1
    v_mfma_f32_16x16x32_bf16 v[70:73], a[188:191], v[30:33], v[70:73]
    ds_read_b64_tr_b16 v[28:29], v2 offset:8448
    global_load_lds_dwordx4 v253, s[22:23] offset:2048 sc1
    v_mfma_f32_16x16x32_bf16 v[70:73], a[200:203], v[34:37], v[70:73]
    v_rsq_f32 v76, v105
    v_mfma_f32_16x16x32_bf16 v[70:73], a[212:215], v[38:41], v[70:73]
    v_mul_f32 v103, 0xc0135761, v76
    v_mul_f32 v76, v76, v76
    v_mfma_f32_16x16x32_bf16 v[70:73], a[224:227], v[42:45], v[70:73]
    v_mul_f32 v76, 0x3d372713, v76
    v_mul_f32 v104, v103, v76
    v_mfma_f32_16x16x32_bf16 v[70:73], a[236:239], v[46:49], v[70:73]
    s_waitcnt lgkmcnt(6)
    v_mov_b32 v123, v0
    v_fma_f32 v62, -v102, v82, v62
    v_mfma_f32_16x16x32_bf16 v[78:81], v[10:13], v[10:13], 0
    ds_read_b64_tr_b16 v[30:31], v3 offset:0
    global_load_lds_dwordx4 v253, s[22:23] offset:3072 sc1
    v_mfma_f32_16x16x32_bf16 v[78:81], v[14:17], v[14:17], v[78:81]
    s_waitcnt lgkmcnt(3)
    ds_read_b64_tr_b16 v[110:111], v108 offset:0
    v_fma_f32 v63, -v102, v83, v63
    v_mfma_f32_16x16x32_bf16 v[78:81], v[18:21], v[18:21], v[78:81]
    s_add_u32 m0, s58, 13312
    ds_read_b64_tr_b16 v[32:33], v3 offset:256
    v_mul_f32 v106, v62, v62
    v_mfma_f32_16x16x32_bf16 v[78:81], v[22:25], v[22:25], v[78:81]
    s_waitcnt lgkmcnt(3)
    v_mul_f32 v107, v63, v63
    v_fma_f32 v106, v106, v104, v103
    v_mfma_f32_16x16x32_bf16 v[78:81], v[26:29], v[26:29], v[78:81]
    ds_read_b64_tr_b16 v[34:35], v3 offset:2048
    v_fma_f32 v107, v107, v104, v103
    v_mfma_f32_16x16x32_bf16 v[74:77], v[94:97], v[10:13], 0
    global_load_lds_dwordx4 v253, s[24:25] offset:0 sc1
    v_mul_f32 v106, v106, v62
    v_mul_f32 v107, v107, v63
    v_mfma_f32_16x16x32_bf16 v[74:77], v[94:97], v[14:17], v[74:77]
    ds_read_b64_tr_b16 v[36:37], v3 offset:2304
    v_exp_f32 v106, v106
    v_mfma_f32_16x16x32_bf16 v[74:77], v[94:97], v[18:21], v[74:77]
    v_exp_f32 v107, v107
    v_mfma_f32_16x16x32_bf16 v[74:77], v[94:97], v[22:25], v[74:77]
    ds_read_b64_tr_b16 v[38:39], v3 offset:4096
    v_fma_f32 v64, -v102, v84, v64
    v_mfma_f32_16x16x32_bf16 v[74:77], v[94:97], v[26:29], v[74:77]
    v_fma_f32 v65, -v102, v85, v65
    v_fma_f32 v106, v106, v105, v105
    v_fma_f32 v107, v107, v105, v105
    v_mfma_f32_16x16x32_bf16 v[58:61], a[8:11], v[10:13], 0
    global_load_lds_dwordx4 v253, s[24:25] offset:1024 sc1
    v_rcp_f32 v106, v106
    v_mfma_f32_16x16x32_bf16 v[58:61], a[20:23], v[14:17], v[58:61]
    ds_read_b64_tr_b16 v[40:41], v3 offset:4352
    v_rcp_f32 v107, v107
    v_mfma_f32_16x16x32_bf16 v[58:61], a[32:35], v[18:21], v[58:61]
    v_cndmask_b32 v75, v78, v79, s[50:51]
    v_cndmask_b32 v75, v75, v80, s[52:53]
    v_cndmask_b32 v75, abs(v75), abs(v81), s[54:55]
    v_mfma_f32_16x16x32_bf16 v[58:61], a[44:47], v[22:25], v[58:61]
    ds_write_b64 v125, v[74:75] offset:0
    v_mfma_f32_16x16x32_bf16 v[58:61], a[56:59], v[26:29], v[58:61]
    v_mul_f32 v62, v62, v64
    v_mul_f32 v63, v63, v65
    v_mfma_f32_16x16x32_bf16 v[54:57], a[4:7], v[10:13], 0
    ds_read_b64_tr_b16 v[42:43], v3 offset:6144
    global_load_lds_dwordx4 v253, s[24:25] offset:2048 sc1
    v_mfma_f32_16x16x32_bf16 v[54:57], a[16:19], v[14:17], v[54:57]
    ds_read_b64_tr_b16 v[44:45], v3 offset:6400
    v_mul_f32 v62, v62, v106
    v_mfma_f32_16x16x32_bf16 v[54:57], a[28:31], v[18:21], v[54:57]
    ds_read_b64_tr_b16 v[46:47], v3 offset:8192
    v_mul_f32 v63, v63, v107
    v_mfma_f32_16x16x32_bf16 v[54:57], a[40:43], v[22:25], v[54:57]
    s_waitcnt lgkmcnt(9)
    ds_write_b64 v109, v[110:111] offset:8448
    v_mfma_f32_16x16x32_bf16 v[54:57], a[52:55], v[26:29], v[54:57]
    v_cvt_pk_bf16_f32 v120, v62, v63
    v_fma_f32 v66, -v102, v86, v66
    v_mfma_f32_16x16x32_bf16 v[50:53], a[0:3], v[10:13], 0
    ds_read_b64_tr_b16 v[48:49], v3 offset:8448
    v_fma_f32 v67, -v102, v87, v67
    v_mfma_f32_16x16x32_bf16 v[50:53], a[12:15], v[14:17], v[50:53]
    ds_read_b64_tr_b16 v[110:111], v112 offset:4096
    global_load_lds_dwordx4 v253, s[24:25] offset:3072 sc1
    v_mfma_f32_16x16x32_bf16 v[50:53], a[24:27], v[18:21], v[50:53]
    v_mul_f32 v106, v66, v66
    v_mul_f32 v107, v67, v67
    v_mfma_f32_16x16x32_bf16 v[50:53], a[36:39], v[22:25], v[50:53]
    s_add_u32 m0, s58, 17408
    v_fma_f32 v106, v106, v104, v103
    v_fma_f32 v107, v107, v104, v103
    v_mfma_f32_16x16x32_bf16 v[50:53], a[48:51], v[26:29], v[50:53]
    s_waitcnt lgkmcnt(9)
    v_mul_f32 v106, v106, v66
    v_mul_f32 v107, v107, v67
    v_mfma_f32_16x16x32_bf16 v[50:53], a[60:63], v[30:33], v[50:53]
    ds_read_b64_tr_b16 v[10:11], v4 offset:0
    v_exp_f32 v106, v106
    v_mfma_f32_16x16x32_bf16 v[50:53], a[72:75], v[34:37], v[50:53]
    s_waitcnt lgkmcnt(5)
    ds_read_b64_tr_b16 v[12:13], v4 offset:256
    global_load_lds_dwordx4 v253, s[26:27] offset:0 sc1
    v_mfma_f32_16x16x32_bf16 v[50:53], a[84:87], v[38:41], v[50:53]
    ds_read_b64_tr_b16 v[14:15], v4 offset:2048
    v_exp_f32 v107, v107
    v_mfma_f32_16x16x32_bf16 v[50:53], a[96:99], v[42:45], v[50:53]
    s_waitcnt lgkmcnt(4)
    ds_read_b64_tr_b16 v[16:17], v4 offset:2304
    v_fma_f32 v68, -v102, v88, v68
    v_mfma_f32_16x16x32_bf16 v[50:53], a[108:111], v[46:49], v[50:53]
    ds_read_b64_tr_b16 v[18:19], v4 offset:4096
    v_fma_f32 v69, -v102, v89, v69
    v_mfma_f32_16x16x32_bf16 v[54:57], a[64:67], v[30:33], v[54:57]
    v_fma_f32 v106, v106, v105, v105
    v_fma_f32 v107, v107, v105, v105
    v_mfma_f32_16x16x32_bf16 v[54:57], a[76:79], v[34:37], v[54:57]
    ds_read_b64_tr_b16 v[20:21], v4 offset:4352
    global_load_lds_dwordx4 v253, s[26:27] offset:1024 sc1
    v_mfma_f32_16x16x32_bf16 v[54:57], a[88:91], v[38:41], v[54:57]
    ds_read_b64_tr_b16 v[22:23], v4 offset:6144
    v_rcp_f32 v106, v106
    v_mfma_f32_16x16x32_bf16 v[54:57], a[100:103], v[42:45], v[54:57]
    ds_read_b64_tr_b16 v[24:25], v4 offset:6400
    v_rcp_f32 v107, v107
    v_mfma_f32_16x16x32_bf16 v[54:57], a[112:115], v[46:49], v[54:57]
    ds_read_b64_tr_b16 v[26:27], v4 offset:8192
    v_mul_f32 v66, v66, v68
    v_mfma_f32_16x16x32_bf16 v[58:61], a[68:71], v[30:33], v[58:61]
    s_barrier
    ds_read_b64_tr_b16 v[28:29], v4 offset:8448
    v_mul_f32 v67, v67, v69
    v_mfma_f32_16x16x32_bf16 v[58:61], a[80:83], v[34:37], v[58:61]
    ds_read_b128 v[74:77], v126 offset:0
    global_load_lds_dwordx4 v253, s[26:27] offset:2048 sc1
    v_mul_f32 v66, v66, v106
    v_mfma_f32_16x16x32_bf16 v[58:61], a[92:95], v[38:41], v[58:61]
    ds_read_b128 v[78:81], v126 offset:16
    v_mul_f32 v67, v67, v107
    v_cvt_pk_bf16_f32 v121, v66, v67
    v_mfma_f32_16x16x32_bf16 v[58:61], a[104:107], v[42:45], v[58:61]
    s_waitcnt lgkmcnt(12)
    ds_write_b64 v113, v[110:111] offset:8576
    v_mfma_f32_16x16x32_bf16 v[58:61], a[116:119], v[46:49], v[58:61]
    s_waitcnt lgkmcnt(9)
    s_add_u32 m0, s58, 18432
    v_fma_f32 v70, -v102, v90, v70
    v_add_u32 v253, s7, v252
    v_mfma_f32_16x16x32_bf16 v[58:61], a[128:131], v[10:13], v[58:61]
    ds_read_b64_tr_b16 v[30:31], v5 offset:0
    v_fma_f32 v71, -v102, v91, v71
    v_mfma_f32_16x16x32_bf16 v[58:61], a[140:143], v[14:17], v[58:61]
    s_waitcnt lgkmcnt(6)
    ds_read_b64_tr_b16 v[32:33], v5 offset:256
    v_mul_f32 v106, v70, v70
    v_mfma_f32_16x16x32_bf16 v[58:61], a[152:155], v[18:21], v[58:61]
    ds_read_b64_tr_b16 v[34:35], v5 offset:2048
    global_load_lds_dwordx4 v253, s[22:23] offset:2048 sc1
    v_mul_f32 v107, v71, v71
    v_mfma_f32_16x16x32_bf16 v[58:61], a[164:167], v[22:25], v[58:61]
    s_waitcnt lgkmcnt(6)
    ds_read_b64_tr_b16 v[36:37], v5 offset:2304
    v_fma_f32 v106, v106, v104, v103
    v_fma_f32 v107, v107, v104, v103
    v_mfma_f32_16x16x32_bf16 v[58:61], a[176:179], v[26:29], v[58:61]
    s_waitcnt lgkmcnt(5)
    ds_read_b64_tr_b16 v[38:39], v5 offset:4096
    v_mul_f32 v106, v106, v70
    v_mul_f32 v107, v107, v71
    v_mfma_f32_16x16x32_bf16 v[54:57], a[124:127], v[10:13], v[54:57]
    v_add_f32 v74, v74, v76
    v_exp_f32 v106, v106
    v_mfma_f32_16x16x32_bf16 v[54:57], a[136:139], v[14:17], v[54:57]
    ds_read_b64_tr_b16 v[40:41], v5 offset:4352
    global_load_lds_dwordx4 v253, s[22:23] offset:3072 sc1
    v_mfma_f32_16x16x32_bf16 v[54:57], a[148:151], v[18:21], v[54:57]
    s_add_u32 m0, s58, 22528
    ds_read_b64_tr_b16 v[42:43], v5 offset:6144
    v_add_f32 v75, v75, v77
    v_mfma_f32_16x16x32_bf16 v[54:57], a[160:163], v[22:25], v[54:57]
    ds_read_b64_tr_b16 v[44:45], v5 offset:6400
    v_exp_f32 v107, v107
    v_mfma_f32_16x16x32_bf16 v[54:57], a[172:175], v[26:29], v[54:57]
    ds_read_b64_tr_b16 v[46:47], v5 offset:8192
    v_fma_f32 v72, -v102, v92, v72
    v_fma_f32 v73, -v102, v93, v73
    v_mfma_f32_16x16x32_bf16 v[50:53], a[120:123], v[10:13], v[50:53]
    ds_read_b64_tr_b16 v[48:49], v5 offset:8448
    global_load_lds_dwordx4 v253, s[24:25] offset:0 sc1
    v_add_f32 v78, v78, v80
    v_mfma_f32_16x16x32_bf16 v[50:53], a[132:135], v[14:17], v[50:53]
    v_add_f32 v79, v79, v81
    v_permlane32_swap_b32 v121, v123
    v_mfma_f32_16x16x32_bf16 v[50:53], a[144:147], v[18:21], v[50:53]
    v_fma_f32 v106, v106, v105, v105
    v_fma_f32 v107, v107, v105, v105
    v_mfma_f32_16x16x32_bf16 v[50:53], a[156:159], v[22:25], v[50:53]
    v_add_f32 v74, v74, v78
    v_rcp_f32 v106, v106
    v_mfma_f32_16x16x32_bf16 v[50:53], a[168:171], v[26:29], v[50:53]
    s_waitcnt lgkmcnt(6)
    v_add_f32 v75, v75, v79
    v_rcp_f32 v107, v107
    v_mfma_f32_16x16x32_bf16 v[50:53], a[180:183], v[30:33], v[50:53]
    ds_read_b64_tr_b16 v[10:11], v6 offset:0
    global_load_lds_dwordx4 v253, s[24:25] offset:1024 sc1
    v_mfma_f32_16x16x32_bf16 v[50:53], a[192:195], v[34:37], v[50:53]
    s_waitcnt lgkmcnt(3)
    ds_read_b64_tr_b16 v[12:13], v6 offset:256
    v_mul_f32 v70, v70, v72
    v_mul_f32 v71, v71, v73
    v_mfma_f32_16x16x32_bf16 v[50:53], a[204:207], v[38:41], v[50:53]
    ds_read_b64_tr_b16 v[14:15], v6 offset:2048
    v_mul_f32 v70, v70, v106
    v_mul_f32 v71, v71, v107
    v_mfma_f32_16x16x32_bf16 v[50:53], a[216:219], v[42:45], v[50:53]
    s_waitcnt lgkmcnt(3)
    ds_read_b64_tr_b16 v[16:17], v6 offset:2304
    global_load_lds_dwordx4 v253, s[24:25] offset:2048 sc1
    v_cvt_pk_bf16_f32 v122, v70, v71
    v_mfma_f32_16x16x32_bf16 v[50:53], a[228:231], v[46:49], v[50:53]
    s_add_u32 s3, s56, 266240
    ds_read_b64_tr_b16 v[18:19], v6 offset:4096
    v_permlane32_swap_b32 v120, v122
    v_mfma_f32_16x16x32_bf16 v[54:57], a[184:187], v[30:33], v[54:57]
    s_nop 0
    v_permlane16_swap_b32 v120, v121
    v_mfma_f32_16x16x32_bf16 v[54:57], a[196:199], v[34:37], v[54:57]
    s_waitcnt vmcnt(14)
    ds_read_b64_tr_b16 v[20:21], v6 offset:4352
    v_permlane16_swap_b32 v122, v123
    v_mfma_f32_16x16x32_bf16 v[54:57], a[208:211], v[38:41], v[54:57]
    ds_read_b64_tr_b16 v[22:23], v6 offset:6144
    global_load_lds_dwordx4 v253, s[24:25] offset:3072 sc1
    v_mfma_f32_16x16x32_bf16 v[54:57], a[220:223], v[42:45], v[54:57]
    s_add_u32 m0, s58, 26624
    ds_read_b64_tr_b16 v[24:25], v6 offset:6400
    v_mul_f32 v98, 0x3acccccd, v74
    v_mfma_f32_16x16x32_bf16 v[54:57], a[232:235], v[46:49], v[54:57]
    ds_read_b64_tr_b16 v[26:27], v6 offset:8192
    buffer_store_dwordx4 v[120:123], v124, s[40:43], s3 offen sc1
    v_mfma_f32_16x16x32_bf16 v[58:61], a[188:191], v[30:33], v[58:61]
    ds_read_b64_tr_b16 v[28:29], v6 offset:8448
    v_fma_f32 v75, abs(v75), s32, v114
    v_mfma_f32_16x16x32_bf16 v[58:61], a[200:203], v[34:37], v[58:61]
    global_load_lds_dwordx4 v253, s[26:27] offset:0 sc1
    v_fma_f32 v75, -v98, v98, v75
    v_mfma_f32_16x16x32_bf16 v[58:61], a[212:215], v[38:41], v[58:61]
    v_max_f32 v101, 0x3727c5ac, v75
    v_rsq_f32 v76, v101
    v_mfma_f32_16x16x32_bf16 v[58:61], a[224:227], v[42:45], v[58:61]
    v_mul_f32 v99, 0xc0135761, v76
    v_mul_f32 v76, v76, v76
    v_mfma_f32_16x16x32_bf16 v[58:61], a[236:239], v[46:49], v[58:61]
    s_waitcnt lgkmcnt(6)
    v_mul_f32 v76, 0x3d372713, v76
    v_mul_f32 v100, v99, v76
    v_mfma_f32_16x16x32_bf16 v[78:81], v[10:13], v[10:13], 0
    s_mov_b32 s73, 106496
    ds_read_b64_tr_b16 v[30:31], v7 offset:0
    buffer_load_dwordx2 v[254:255], v127, s[40:43], s73 offen sc1
    v_mfma_f32_16x16x32_bf16 v[78:81], v[14:17], v[14:17], v[78:81]
    s_waitcnt lgkmcnt(3)
    v_mov_b32 v123, v0
    v_fma_f32 v50, -v98, v82, v50
    v_mfma_f32_16x16x32_bf16 v[78:81], v[18:21], v[18:21], v[78:81]
    ds_read_b64_tr_b16 v[32:33], v7 offset:256
    global_load_lds_dwordx4 v253, s[26:27] offset:1024 sc1
    v_mfma_f32_16x16x32_bf16 v[78:81], v[22:25], v[22:25], v[78:81]
    s_waitcnt lgkmcnt(2)
    v_fma_f32 v51, -v98, v83, v51
    v_mul_f32 v106, v50, v50
    v_mfma_f32_16x16x32_bf16 v[78:81], v[26:29], v[26:29], v[78:81]
    ds_read_b64_tr_b16 v[34:35], v7 offset:2048
    global_load_lds_dwordx4 v253, s[26:27] offset:2048 sc1
    v_mfma_f32_16x16x32_bf16 v[74:77], v[94:97], v[10:13], 0
    v_mul_f32 v107, v51, v51
    v_fma_f32 v106, v106, v100, v99
    v_mfma_f32_16x16x32_bf16 v[74:77], v[94:97], v[14:17], v[74:77]
    ds_read_b64_tr_b16 v[36:37], v7 offset:2304
    v_fma_f32 v107, v107, v100, v99
    v_mfma_f32_16x16x32_bf16 v[74:77], v[94:97], v[18:21], v[74:77]
    v_mul_f32 v106, v106, v50
    v_mul_f32 v107, v107, v51
    v_mfma_f32_16x16x32_bf16 v[74:77], v[94:97], v[22:25], v[74:77]
    ds_read_b64_tr_b16 v[38:39], v7 offset:4096
    v_exp_f32 v106, v106
    v_mfma_f32_16x16x32_bf16 v[74:77], v[94:97], v[26:29], v[74:77]
    v_exp_f32 v107, v107
    v_mfma_f32_16x16x32_bf16 v[70:73], a[8:11], v[10:13], 0
    v_fma_f32 v52, -v98, v84, v52
    v_fma_f32 v53, -v98, v85, v53
    v_mfma_f32_16x16x32_bf16 v[70:73], a[20:23], v[14:17], v[70:73]
    ds_read_b64_tr_b16 v[40:41], v7 offset:4352
    v_fma_f32 v106, v106, v101, v101
    v_fma_f32 v107, v107, v101, v101
    v_mfma_f32_16x16x32_bf16 v[70:73], a[32:35], v[18:21], v[70:73]
    v_rcp_f32 v106, v106
    v_cndmask_b32 v75, v78, v79, s[50:51]
    v_mfma_f32_16x16x32_bf16 v[70:73], a[44:47], v[22:25], v[70:73]
    ds_read_b64_tr_b16 v[42:43], v7 offset:6144
    v_cndmask_b32 v75, v75, v80, s[52:53]
    v_cndmask_b32 v75, abs(v75), abs(v81), s[54:55]
    v_mfma_f32_16x16x32_bf16 v[70:73], a[56:59], v[26:29], v[70:73]
    ds_write_b64 v125, v[74:75] offset:512
    v_mfma_f32_16x16x32_bf16 v[66:69], a[4:7], v[10:13], 0
    v_rcp_f32 v107, v107
    v_mfma_f32_16x16x32_bf16 v[66:69], a[16:19], v[14:17], v[66:69]
    ds_read_b64_tr_b16 v[44:45], v7 offset:6400
    v_mul_f32 v50, v50, v52
    v_mfma_f32_16x16x32_bf16 v[66:69], a[28:31], v[18:21], v[66:69]
    ds_read_b64_tr_b16 v[46:47], v7 offset:8192
    v_mul_f32 v51, v51, v53
    v_mfma_f32_16x16x32_bf16 v[66:69], a[40:43], v[22:25], v[66:69]
L_padB_6:
    s_cbranch_execz L_backB
    v_mul_f32 v50, v50, v106
    v_mul_f32 v51, v51, v107
    v_mfma_f32_16x16x32_bf16 v[66:69], a[52:55], v[26:29], v[66:69]
    ds_read_b64_tr_b16 v[48:49], v7 offset:8448
    v_cvt_pk_bf16_f32 v120, v50, v51
    v_mfma_f32_16x16x32_bf16 v[62:65], a[0:3], v[10:13], 0
    global_load_dwordx4 a[0:3], v252, s[8:9] offset:0 sc1
    v_fma_f32 v54, -v98, v86, v54
    v_mfma_f32_16x16x32_bf16 v[62:65], a[12:15], v[14:17], v[62:65]
    global_load_dwordx4 a[4:7], v252, s[8:9] offset:1024 sc1
    v_fma_f32 v55, -v98, v87, v55
    v_mfma_f32_16x16x32_bf16 v[62:65], a[24:27], v[18:21], v[62:65]
    v_mul_f32 v106, v54, v54
    v_mul_f32 v107, v55, v55
    v_mfma_f32_16x16x32_bf16 v[62:65], a[36:39], v[22:25], v[62:65]
    global_load_dwordx4 a[8:11], v252, s[8:9] offset:2048 sc1
    v_fma_f32 v106, v106, v100, v99
    v_mfma_f32_16x16x32_bf16 v[62:65], a[48:51], v[26:29], v[62:65]
    s_waitcnt lgkmcnt(7)
    v_fma_f32 v107, v107, v100, v99
    v_mul_f32 v106, v106, v54
    v_mfma_f32_16x16x32_bf16 v[62:65], a[60:63], v[30:33], v[62:65]
    ds_read_b64_tr_b16 v[10:11], v8 offset:0
    v_mul_f32 v107, v107, v55
    v_mfma_f32_16x16x32_bf16 v[62:65], a[72:75], v[34:37], v[62:65]
    s_waitcnt lgkmcnt(3)
    ds_read_b64_tr_b16 v[12:13], v8 offset:256
    v_exp_f32 v106, v106
    v_mfma_f32_16x16x32_bf16 v[62:65], a[84:87], v[38:41], v[62:65]
    ds_read_b64_tr_b16 v[14:15], v8 offset:2048
    global_load_dwordx4 a[12:15], v252, s[10:11] offset:0 sc1
    v_mfma_f32_16x16x32_bf16 v[62:65], a[96:99], v[42:45], v[62:65]
    s_waitcnt lgkmcnt(3)
    ds_read_b64_tr_b16 v[16:17], v8 offset:2304
    v_exp_f32 v107, v107
    v_mfma_f32_16x16x32_bf16 v[62:65], a[108:111], v[46:49], v[62:65]
    ds_read_b64_tr_b16 v[18:19], v8 offset:4096
    v_fma_f32 v56, -v98, v88, v56
    v_mfma_f32_16x16x32_bf16 v[66:69], a[64:67], v[30:33], v[66:69]
    v_fma_f32 v57, -v98, v89, v57
    v_fma_f32 v106, v106, v101, v101
    v_mfma_f32_16x16x32_bf16 v[66:69], a[76:79], v[34:37], v[66:69]
    ds_read_b64_tr_b16 v[20:21], v8 offset:4352
    v_fma_f32 v107, v107, v101, v101
    v_mfma_f32_16x16x32_bf16 v[66:69], a[88:91], v[38:41], v[66:69]
    ds_read_b64_tr_b16 v[22:23], v8 offset:6144
    global_load_dwordx4 a[16:19], v252, s[10:11] offset:1024 sc1
    v_mfma_f32_16x16x32_bf16 v[66:69], a[100:103], v[42:45], v[66:69]
    ds_read_b64_tr_b16 v[24:25], v8 offset:6400
    v_rcp_f32 v106, v106
    v_mfma_f32_16x16x32_bf16 v[66:69], a[112:115], v[46:49], v[66:69]
    ds_read_b64_tr_b16 v[26:27], v8 offset:8192
    v_rcp_f32 v107, v107
    v_mfma_f32_16x16x32_bf16 v[70:73], a[68:71], v[30:33], v[70:73]
    s_barrier
    ds_read_b64_tr_b16 v[28:29], v8 offset:8448
    v_mfma_f32_16x16x32_bf16 v[70:73], a[80:83], v[34:37], v[70:73]
    ds_read_b128 v[74:77], v126 offset:512
    global_load_dwordx4 a[20:23], v252, s[10:11] offset:2048 sc1
    v_mfma_f32_16x16x32_bf16 v[70:73], a[92:95], v[38:41], v[70:73]
    ds_read_b128 v[78:81], v126 offset:528
    v_mul_f32 v54, v54, v56
    v_mfma_f32_16x16x32_bf16 v[70:73], a[104:107], v[42:45], v[70:73]
    v_mul_f32 v55, v55, v57
    v_mul_f32 v54, v54, v106
    v_mfma_f32_16x16x32_bf16 v[70:73], a[116:119], v[46:49], v[70:73]
    s_waitcnt lgkmcnt(8)
    v_mul_f32 v55, v55, v107
    v_cvt_pk_bf16_f32 v121, v54, v55
    v_fma_f32 v58, -v98, v90, v58
    v_mfma_f32_16x16x32_bf16 v[70:73], a[128:131], v[10:13], v[70:73]
    ds_read_b64_tr_b16 v[30:31], v9 offset:0
    v_fma_f32 v59, -v98, v91, v59
    v_mul_f32 v106, v58, v58
    v_mfma_f32_16x16x32_bf16 v[70:73], a[140:143], v[14:17], v[70:73]
    s_waitcnt lgkmcnt(5)
    ds_read_b64_tr_b16 v[32:33], v9 offset:256
    global_load_dwordx4 a[24:27], v252, s[12:13] offset:0 sc1
    s_waitcnt vmcnt(9)
    v_cmp_ne_u64 vcc, s[44:45], v[254:255]
    v_mfma_f32_16x16x32_bf16 v[70:73], a[152:155], v[18:21], v[70:73]
    s_nop 0
    s_cbranch_vccnz L_retry_17
L_seen_18:
    ds_read_b64_tr_b16 v[34:35], v9 offset:2048
    v_mul_f32 v107, v59, v59
    v_mfma_f32_16x16x32_bf16 v[70:73], a[164:167], v[22:25], v[70:73]
    s_waitcnt lgkmcnt(5)
    ds_read_b64_tr_b16 v[36:37], v9 offset:2304
    v_fma_f32 v106, v106, v100, v99
    v_mfma_f32_16x16x32_bf16 v[70:73], a[176:179], v[26:29], v[70:73]
    s_waitcnt lgkmcnt(4)
    ds_read_b64_tr_b16 v[38:39], v9 offset:4096
    v_fma_f32 v107, v107, v100, v99
    v_mfma_f32_16x16x32_bf16 v[66:69], a[124:127], v[10:13], v[66:69]
    v_mul_f32 v106, v106, v58
    v_mul_f32 v107, v107, v59
    v_mfma_f32_16x16x32_bf16 v[66:69], a[136:139], v[14:17], v[66:69]
    ds_read_b64_tr_b16 v[40:41], v9 offset:4352
    global_load_dwordx4 a[28:31], v252, s[12:13] offset:1024 sc1
    v_mfma_f32_16x16x32_bf16 v[66:69], a[148:151], v[18:21], v[66:69]
    ds_read_b64_tr_b16 v[42:43], v9 offset:6144
    v_exp_f32 v106, v106
    v_mfma_f32_16x16x32_bf16 v[66:69], a[160:163], v[22:25], v[66:69]
    ds_read_b64_tr_b16 v[44:45], v9 offset:6400
    v_exp_f32 v107, v107
    v_mfma_f32_16x16x32_bf16 v[66:69], a[172:175], v[26:29], v[66:69]
    ds_read_b64_tr_b16 v[46:47], v9 offset:8192
    v_fma_f32 v60, -v98, v92, v60
    v_mfma_f32_16x16x32_bf16 v[62:65], a[120:123], v[10:13], v[62:65]
    ds_read_b64_tr_b16 v[48:49], v9 offset:8448
    global_load_dwordx4 a[32:35], v252, s[12:13] offset:2048 sc1
    v_mfma_f32_16x16x32_bf16 v[62:65], a[132:135], v[14:17], v[62:65]
    v_fma_f32 v61, -v98, v93, v61
    v_add_f32 v74, v74, v76
    v_mfma_f32_16x16x32_bf16 v[62:65], a[144:147], v[18:21], v[62:65]
    v_permlane32_swap_b32 v121, v123
    v_mfma_f32_16x16x32_bf16 v[62:65], a[156:159], v[22:25], v[62:65]
    v_fma_f32 v106, v106, v101, v101
    v_fma_f32 v107, v107, v101, v101
    v_mfma_f32_16x16x32_bf16 v[62:65], a[168:171], v[26:29], v[62:65]
    s_waitcnt lgkmcnt(6)
    v_rcp_f32 v106, v106
    v_add_f32 v75, v75, v77
    v_mfma_f32_16x16x32_bf16 v[62:65], a[180:183], v[30:33], v[62:65]
    global_load_dwordx4 a[36:39], v252, s[14:15] offset:0 sc1
    v_rcp_f32 v107, v107
    v_mfma_f32_16x16x32_bf16 v[62:65], a[192:195], v[34:37], v[62:65]
    s_waitcnt lgkmcnt(2)
    v_mul_f32 v58, v58, v60
    v_mul_f32 v59, v59, v61
    v_mul_f32 v58, v58, v106
    v_mfma_f32_16x16x32_bf16 v[62:65], a[204:207], v[38:41], v[62:65]
    s_add_u32 s3, s56, 319488
    v_mul_f32 v59, v59, v107
    v_cvt_pk_bf16_f32 v122, v58, v59
    v_add_f32 v78, v78, v80
    v_mfma_f32_16x16x32_bf16 v[62:65], a[216:219], v[42:45], v[62:65]
    s_waitcnt lgkmcnt(0)
    v_permlane32_swap_b32 v120, v122
    v_add_f32 v79, v79, v81
    v_mfma_f32_16x16x32_bf16 v[62:65], a[228:231], v[46:49], v[62:65]
    global_load_dwordx4 a[40:43], v252, s[14:15] offset:1024 sc1
    v_permlane16_swap_b32 v120, v121
    v_mfma_f32_16x16x32_bf16 v[66:69], a[184:187], v[30:33], v[66:69]
    v_permlane16_swap_b32 v122, v123
    v_mfma_f32_16x16x32_bf16 v[66:69], a[196:199], v[34:37], v[66:69]
    buffer_store_dwordx4 v[120:123], v124, s[40:43], s3 offen sc1
    v_mfma_f32_16x16x32_bf16 v[66:69], a[208:211], v[38:41], v[66:69]
    v_add_f32 v74, v74, v78
    v_mfma_f32_16x16x32_bf16 v[66:69], a[220:223], v[42:45], v[66:69]
    v_add_f32 v75, v75, v79
    v_mul_f32 v102, 0x3acccccd, v74
    v_mfma_f32_16x16x32_bf16 v[66:69], a[232:235], v[46:49], v[66:69]
    global_load_dwordx4 a[44:47], v252, s[14:15] offset:2048 sc1
    v_fma_f32 v75, abs(v75), s32, v114
    v_mfma_f32_16x16x32_bf16 v[70:73], a[188:191], v[30:33], v[70:73]
    v_fma_f32 v75, -v102, v102, v75
    v_max_f32 v105, 0x3727c5ac, v75
    v_mfma_f32_16x16x32_bf16 v[70:73], a[200:203], v[34:37], v[70:73]
    v_rsq_f32 v76, v105
    v_mfma_f32_16x16x32_bf16 v[70:73], a[212:215], v[38:41], v[70:73]
    v_mul_f32 v103, 0xc0135761, v76
    v_mfma_f32_16x16x32_bf16 v[70:73], a[224:227], v[42:45], v[70:73]
    v_mul_f32 v76, v76, v76
    v_mul_f32 v76, 0x3d372713, v76
    v_mfma_f32_16x16x32_bf16 v[70:73], a[236:239], v[46:49], v[70:73]
    v_mul_f32 v104, v103, v76
    v_mov_b32 v123, 0
    v_add_u32 v125, s58, v252
    v_add_u32 v112, s33, v252
    s_waitcnt vmcnt(13)
    v_pk_fma_f32 v[62:63], v[102:103], v[82:83], v[62:63] op_sel_hi:[0,1,1] neg_lo:[1,0,0] neg_hi:[1,0,0]
    v_pk_fma_f32 v[64:65], v[102:103], v[84:85], v[64:65] op_sel_hi:[0,1,1] neg_lo:[1,0,0] neg_hi:[1,0,0]
    v_pk_mul_f32 v[106:107], v[62:63], v[62:63]
    v_pk_fma_f32 v[106:107], v[106:107], v[104:105], v[102:103] op_sel:[0,0,1] op_sel_hi:[1,0,1]
    v_pk_mul_f32 v[106:107], v[106:107], v[62:63]
    v_exp_f32 v106, v106
    v_exp_f32 v107, v107
    v_pk_mul_f32 v[62:63], v[62:63], v[64:65]
    v_pk_fma_f32 v[106:107], v[106:107], v[104:105], v[104:105] op_sel:[0,1,1] op_sel_hi:[1,1,1]
    v_rcp_f32 v106, v106
    v_rcp_f32 v107, v107
    s_nop 0
    v_pk_mul_f32 v[62:63], v[62:63], v[106:107]
    v_cvt_pk_bf16_f32 v120, v62, v63
    v_pk_fma_f32 v[66:67], v[102:103], v[86:87], v[66:67] op_sel_hi:[0,1,1] neg_lo:[1,0,0] neg_hi:[1,0,0]
    v_pk_fma_f32 v[68:69], v[102:103], v[88:89], v[68:69] op_sel_hi:[0,1,1] neg_lo:[1,0,0] neg_hi:[1,0,0]
    v_pk_mul_f32 v[106:107], v[66:67], v[66:67]
    v_pk_fma_f32 v[106:107], v[106:107], v[104:105], v[102:103] op_sel:[0,0,1] op_sel_hi:[1,0,1]
    v_pk_mul_f32 v[106:107], v[106:107], v[66:67]
    v_exp_f32 v106, v106
    v_exp_f32 v107, v107
    v_pk_mul_f32 v[66:67], v[66:67], v[68:69]
    v_pk_fma_f32 v[106:107], v[106:107], v[104:105], v[104:105] op_sel:[0,1,1] op_sel_hi:[1,1,1]
    v_rcp_f32 v106, v106
    v_rcp_f32 v107, v107
    s_nop 0
    v_pk_mul_f32 v[66:67], v[66:67], v[106:107]
    v_cvt_pk_bf16_f32 v121, v66, v67
    v_pk_fma_f32 v[70:71], v[102:103], v[90:91], v[70:71] op_sel_hi:[0,1,1] neg_lo:[1,0,0] neg_hi:[1,0,0]
    v_pk_fma_f32 v[72:73], v[102:103], v[92:93], v[72:73] op_sel_hi:[0,1,1] neg_lo:[1,0,0] neg_hi:[1,0,0]
    v_pk_mul_f32 v[106:107], v[70:71], v[70:71]
    v_pk_fma_f32 v[106:107], v[106:107], v[104:105], v[102:103] op_sel:[0,0,1] op_sel_hi:[1,0,1]
    v_pk_mul_f32 v[106:107], v[106:107], v[70:71]
    v_exp_f32 v106, v106
    v_exp_f32 v107, v107
    v_pk_mul_f32 v[70:71], v[70:71], v[72:73]
    v_pk_fma_f32 v[106:107], v[106:107], v[104:105], v[104:105] op_sel:[0,1,1] op_sel_hi:[1,1,1]
    v_rcp_f32 v106, v106
    v_rcp_f32 v107, v107
    v_permlane32_swap_b32 v121, v123
    v_pk_mul_f32 v[70:71], v[70:71], v[106:107]
    v_cvt_pk_bf16_f32 v122, v70, v71
    s_add_u32 s3, s56, 372736
    s_nop 0
    v_permlane32_swap_b32 v120, v122
    s_nop 1
    v_permlane16_swap_b32 v120, v121
    v_permlane16_swap_b32 v122, v123
    buffer_store_dwordx4 v[120:123], v124, s[40:43], s3 offen sc1
    v_add_u32 v117, 106496, v252
    global_load_dwordx4 a[48:51], v117, s[8:9] offset:0 sc1
    global_load_dwordx4 a[52:55], v117, s[8:9] offset:1024 sc1
    s_waitcnt vmcnt(15)
    v_mfma_f32_16x16x32_bf16 v[10:13], v[128:131], a[0:3], 0
    s_waitcnt vmcnt(14)
    ds_read_b128 a[96:99], v125 offset:10240
    global_load_dwordx4 a[56:59], v117, s[8:9] offset:2048 sc1
    v_mfma_f32_16x16x32_bf16 v[10:13], v[148:151], a[4:7], v[10:13]
    s_waitcnt vmcnt(14)
    ds_read_b128 a[100:103], v125 offset:11264
    v_and_b32 v110, 15, v1
    v_mfma_f32_16x16x32_bf16 v[10:13], v[168:171], a[8:11], v[10:13]
    s_waitcnt vmcnt(13)
    ds_read_b128 a[104:107], v125 offset:12288
    v_lshrrev_b32 v111, 4, v1
    v_mfma_f32_16x16x32_bf16 v[10:13], v[188:191], a[12:15], v[10:13]
    ds_read_b128 a[108:111], v125 offset:13312
    v_mul_u32_u24 v2, 176, v110
    v_mfma_f32_16x16x32_bf16 v[14:17], v[132:135], a[0:3], 0
    global_load_dwordx4 a[60:63], v117, s[10:11] offset:0 sc1
    ds_read_b128 a[112:115], v125 offset:14336
    v_mfma_f32_16x16x32_bf16 v[14:17], v[152:155], a[4:7], v[14:17]
    ds_read_b128 a[116:119], v125 offset:15360
    v_lshrrev_b32 v110, 1, v111
    v_mfma_f32_16x16x32_bf16 v[14:17], v[172:175], a[8:11], v[14:17]
    ds_read_b128 a[120:123], v125 offset:16384
    v_lshl_add_u32 v2, v110, 4, v2
    v_mfma_f32_16x16x32_bf16 v[14:17], v[192:195], a[12:15], v[14:17]
    ds_read_b128 a[124:127], v125 offset:17408
    v_and_b32 v110, 1, v111
    v_mfma_f32_16x16x32_bf16 v[18:21], v[136:139], a[0:3], 0
    ds_read_b128 a[128:131], v125 offset:18432
    v_mul_u32_u24 v110, 2816, v110
    v_mfma_f32_16x16x32_bf16 v[18:21], v[156:159], a[4:7], v[18:21]
    global_load_dwordx4 a[64:67], v117, s[10:11] offset:1024 sc1
    ds_read_b128 a[132:135], v125 offset:19456
    v_mfma_f32_16x16x32_bf16 v[18:21], v[176:179], a[8:11], v[18:21]
    s_mul_i32 s48, s36, 5632
    ds_read_b128 a[136:139], v112 offset:0
    v_add_u32 v2, v2, v110
    v_mfma_f32_16x16x32_bf16 v[18:21], v[196:199], a[12:15], v[18:21]
    s_add_u32 s48, s48, 0
    ds_read_b128 a[140:143], v112 offset:1024
    v_add_u32 v2, s48, v2
    v_mfma_f32_16x16x32_bf16 v[22:25], v[140:143], a[0:3], 0
    ds_read_b128 a[144:147], v112 offset:2048
    v_min_u32 v110, 39, v1
    v_mfma_f32_16x16x32_bf16 v[22:25], v[160:163], a[4:7], v[22:25]
    v_mul_u32_u24 v111, 6554, v110
    v_lshrrev_b32 v111, 16, v111
    v_mfma_f32_16x16x32_bf16 v[22:25], v[180:183], a[8:11], v[22:25]
    global_load_dwordx4 a[68:71], v117, s[10:11] offset:2048 sc1
    ds_read_b128 a[148:151], v112 offset:3072
    v_mfma_f32_16x16x32_bf16 v[22:25], v[200:203], a[12:15], v[22:25]
    ds_read_b128 a[152:155], v112 offset:4096
    v_mul_u32_u24 v113, 10, v111
    v_mfma_f32_16x16x32_bf16 v[26:29], v[144:147], a[0:3], 0
    s_lshl_b32 s48, s36, 2
    ds_read_b128 a[156:159], v112 offset:5120
    v_sub_u32 v110, v110, v113
    v_mfma_f32_16x16x32_bf16 v[26:29], v[164:167], a[4:7], v[26:29]
    ds_read_b128 a[160:163], v125 offset:20480
    v_add_u32 v111, s48, v111
    v_mfma_f32_16x16x32_bf16 v[26:29], v[184:187], a[8:11], v[26:29]
    global_load_dwordx4 a[72:75], v117, s[12:13] offset:0 sc1
    ds_read_b128 a[164:167], v125 offset:21504
    v_mfma_f32_16x16x32_bf16 v[26:29], v[204:207], a[12:15], v[26:29]
    s_waitcnt vmcnt(16)
    ds_read_b128 a[168:171], v125 offset:22528
    v_mul_u32_u24 v3, 176, v111
    v_mfma_f32_16x16x32_bf16 v[26:29], v[224:227], a[16:19], v[26:29]
    s_waitcnt vmcnt(15)
    ds_read_b128 a[172:175], v125 offset:23552
    v_lshl_add_u32 v3, v110, 4, v3
    v_mfma_f32_16x16x32_bf16 v[26:29], v[244:247], a[20:23], v[26:29]
    s_waitcnt vmcnt(14)
    ds_read_b128 a[176:179], v125 offset:24576
    v_add_u32 v4, 124928, v3
    v_mfma_f32_16x16x32_bf16 v[26:29], a[252:255], a[24:27], v[26:29]
    s_waitcnt vmcnt(13)
    ds_read_b128 a[180:183], v125 offset:25600
    v_mul_u32_u24 v5, 1280, v111
    s_waitcnt lgkmcnt(15)
    v_mfma_f32_16x16x32_bf16 v[26:29], a[112:115], a[28:31], v[26:29]
    global_load_dwordx4 a[76:79], v117, s[12:13] offset:1024 sc1
    ds_read_b128 a[184:187], v125 offset:26624
    v_mfma_f32_16x16x32_bf16 v[22:25], v[220:223], a[16:19], v[22:25]
    ds_read_b128 a[188:191], v125 offset:27648
    v_lshl_add_u32 v5, v110, 4, v5
    v_mfma_f32_16x16x32_bf16 v[22:25], v[240:243], a[20:23], v[22:25]
    ds_read_b128 a[192:195], v125 offset:28672
    v_cmp_gt_u32 s[50:51], 40, v1
    v_mfma_f32_16x16x32_bf16 v[22:25], a[248:251], a[24:27], v[22:25]
    s_mov_b32 s64, s30
    s_mov_b32 s65, s31
    v_mov_b32 v111, 0x40000000
    v_mfma_f32_16x16x32_bf16 v[22:25], a[108:111], a[28:31], v[22:25]
    s_mov_b32 s66, 2621440
    s_mov_b32 s67, 0x20000
    v_cndmask_b32 v5, v111, v5, s[50:51]
    v_mfma_f32_16x16x32_bf16 v[18:21], v[216:219], a[16:19], v[18:21]
    s_lshl1_add_u32 s46, s62, s72
    s_mul_i32 s46, s46, 20480
    s_mul_i32 s48, s68, 160
    v_mfma_f32_16x16x32_bf16 v[18:21], v[236:239], a[20:23], v[18:21]
    s_add_u32 s46, s46, s48
    ds_read_b128 v[82:85], v4 offset:0
    global_load_dwordx4 a[80:83], v117, s[12:13] offset:2048 sc1
    v_mfma_f32_16x16x32_bf16 v[18:21], a[244:247], a[24:27], v[18:21]
    v_mfma_f32_16x16x32_bf16 v[18:21], a[104:107], a[28:31], v[18:21]
    v_mfma_f32_16x16x32_bf16 v[14:17], v[212:215], a[16:19], v[14:17]
    global_load_dwordx4 a[84:87], v117, s[14:15] offset:0 sc1
    v_mfma_f32_16x16x32_bf16 v[14:17], v[232:235], a[20:23], v[14:17]
    s_waitcnt lgkmcnt(1)
    s_barrier
    s_waitcnt lgkmcnt(0)
    v_mfma_f32_16x16x32_bf16 v[14:17], a[240:243], a[24:27], v[14:17]
    s_mov_b32 s73, 212992
    v_mfma_f32_16x16x32_bf16 v[14:17], a[100:103], a[28:31], v[14:17]
    buffer_load_dwordx2 v[254:255], v127, s[40:43], s73 offen sc1
    v_mfma_f32_16x16x32_bf16 v[10:13], v[208:211], a[16:19], v[10:13]
    s_waitcnt vmcnt(11)
    s_add_u32 s61, s56, 372736
    v_mfma_f32_16x16x32_bf16 v[10:13], v[228:231], a[20:23], v[10:13]
    buffer_store_dwordx2 v[118:119], v116, s[40:43], s61 offen sc1
    v_mfma_f32_16x16x32_bf16 v[10:13], v[248:251], a[24:27], v[10:13]
    global_load_dwordx4 a[88:91], v117, s[14:15] offset:1024 sc1
    v_mfma_f32_16x16x32_bf16 v[10:13], a[96:99], a[28:31], v[10:13]
    v_mfma_f32_16x16x32_bf16 v[10:13], a[116:119], a[32:35], v[10:13]
    v_mfma_f32_16x16x32_bf16 v[10:13], a[136:139], a[36:39], v[10:13]
    v_mfma_f32_16x16x32_bf16 v[10:13], a[156:159], a[40:43], v[10:13]
    v_mfma_f32_16x16x32_bf16 v[10:13], a[176:179], a[44:47], v[10:13]
    global_load_dwordx4 a[92:95], v117, s[14:15] offset:2048 sc1
    v_mfma_f32_16x16x32_bf16 v[14:17], a[120:123], a[32:35], v[14:17]
    v_mfma_f32_16x16x32_bf16 v[14:17], a[140:143], a[36:39], v[14:17]
    v_mfma_f32_16x16x32_bf16 v[14:17], a[160:163], a[40:43], v[14:17]
    v_mfma_f32_16x16x32_bf16 v[14:17], a[180:183], a[44:47], v[14:17]
    v_mfma_f32_16x16x32_bf16 v[18:21], a[124:127], a[32:35], v[18:21]
    v_mfma_f32_16x16x32_bf16 v[18:21], a[144:147], a[36:39], v[18:21]
    s_nop 0
    ds_write_b128 v2, v[10:13] offset:0
    v_mfma_f32_16x16x32_bf16 v[18:21], a[164:167], a[40:43], v[18:21]
    v_mfma_f32_16x16x32_bf16 v[18:21], a[184:187], a[44:47], v[18:21]
    v_mfma_f32_16x16x32_bf16 v[22:25], a[128:131], a[32:35], v[22:25]
    v_mfma_f32_16x16x32_bf16 v[22:25], a[148:151], a[36:39], v[22:25]
    ds_write_b128 v2, v[14:17] offset:32
    v_mfma_f32_16x16x32_bf16 v[22:25], a[168:171], a[40:43], v[22:25]
    v_mfma_f32_16x16x32_bf16 v[22:25], a[188:191], a[44:47], v[22:25]
    v_mfma_f32_16x16x32_bf16 v[26:29], a[132:135], a[32:35], v[26:29]
    v_mfma_f32_16x16x32_bf16 v[26:29], a[152:155], a[36:39], v[26:29]
    s_nop 0
    ds_write_b128 v2, v[18:21] offset:64
    v_mfma_f32_16x16x32_bf16 v[26:29], a[172:175], a[40:43], v[26:29]
    v_mfma_f32_16x16x32_bf16 v[26:29], a[192:195], a[44:47], v[26:29]
    s_waitcnt vmcnt(13)
    v_mfma_f32_16x16x32_bf16 v[30:33], v[128:131], a[48:51], 0
    s_waitcnt vmcnt(12)
    v_mfma_f32_16x16x32_bf16 v[30:33], v[148:151], a[52:55], v[30:33]
    s_waitcnt vmcnt(11)
    ds_write_b128 v2, v[22:25] offset:96
    v_mfma_f32_16x16x32_bf16 v[30:33], v[168:171], a[56:59], v[30:33]
    s_waitcnt vmcnt(10)
    v_mfma_f32_16x16x32_bf16 v[30:33], v[188:191], a[60:63], v[30:33]
    v_mfma_f32_16x16x32_bf16 v[34:37], v[132:135], a[48:51], 0
    v_mfma_f32_16x16x32_bf16 v[34:37], v[152:155], a[52:55], v[34:37]
    ds_write_b128 v2, v[26:29] offset:128
    v_mfma_f32_16x16x32_bf16 v[34:37], v[172:175], a[56:59], v[34:37]
    v_lshlrev_b32 v86, 16, v82
    v_and_b32 v87, 0xffff0000, v82
    v_mfma_f32_16x16x32_bf16 v[34:37], v[192:195], a[60:63], v[34:37]
    v_lshlrev_b32 v88, 16, v83
    v_and_b32 v89, 0xffff0000, v83
    v_mfma_f32_16x16x32_bf16 v[38:41], v[136:139], a[48:51], 0
    v_lshlrev_b32 v90, 16, v84
    v_and_b32 v91, 0xffff0000, v84
    v_mfma_f32_16x16x32_bf16 v[38:41], v[156:159], a[52:55], v[38:41]
    v_lshlrev_b32 v92, 16, v85
    v_and_b32 v93, 0xffff0000, v85
    v_mfma_f32_16x16x32_bf16 v[38:41], v[176:179], a[56:59], v[38:41]
    s_waitcnt lgkmcnt(0)
    s_barrier
    ds_read_b128 v[50:53], v3 offset:0
    v_mfma_f32_16x16x32_bf16 v[38:41], v[196:199], a[60:63], v[38:41]
    ds_read_b128 v[54:57], v3 offset:2816
    ds_read_b128 v[58:61], v3 offset:5632
    v_mfma_f32_16x16x32_bf16 v[42:45], v[140:143], a[48:51], 0
    ds_read_b128 v[62:65], v3 offset:8448
    s_waitcnt vmcnt(3)
    v_cmp_ne_u64 vcc, s[44:45], v[254:255]
    v_mfma_f32_16x16x32_bf16 v[42:45], v[160:163], a[52:55], v[42:45]
    s_nop 0
    s_cbranch_vccnz L_retry_19
L_seen_20:
    ds_read_b128 v[66:69], v3 offset:11264
    v_mfma_f32_16x16x32_bf16 v[42:45], v[180:183], a[56:59], v[42:45]
    ds_read_b128 v[70:73], v3 offset:14080
    v_add_u32 v253, 212992, v252
    v_mfma_f32_16x16x32_bf16 v[42:45], v[200:203], a[60:63], v[42:45]
    global_load_dwordx4 a[196:199], v253, s[8:9] offset:0 sc1
    v_mfma_f32_16x16x32_bf16 v[46:49], v[144:147], a[48:51], 0
    ds_read_b128 v[74:77], v3 offset:16896
    v_mfma_f32_16x16x32_bf16 v[46:49], v[164:167], a[52:55], v[46:49]
    ds_read_b128 v[78:81], v3 offset:19712
    v_mfma_f32_16x16x32_bf16 v[46:49], v[184:187], a[56:59], v[46:49]
    global_load_dwordx4 a[200:203], v253, s[8:9] offset:1024 sc1
    v_mfma_f32_16x16x32_bf16 v[46:49], v[204:207], a[60:63], v[46:49]
    v_mfma_f32_16x16x32_bf16 v[46:49], v[224:227], a[64:67], v[46:49]
    v_mfma_f32_16x16x32_bf16 v[46:49], v[244:247], a[68:71], v[46:49]
    v_mfma_f32_16x16x32_bf16 v[46:49], a[252:255], a[72:75], v[46:49]
    v_mfma_f32_16x16x32_bf16 v[46:49], a[112:115], a[76:79], v[46:49]
    global_load_dwordx4 a[204:207], v253, s[8:9] offset:2048 sc1
    v_mfma_f32_16x16x32_bf16 v[42:45], v[220:223], a[64:67], v[42:45]
    global_load_dwordx4 a[208:211], v253, s[10:11] offset:0 sc1
    v_mfma_f32_16x16x32_bf16 v[42:45], v[240:243], a[68:71], v[42:45]
    s_waitcnt lgkmcnt(0)
    s_add_u32 s47, s46, 0
    v_add_f32 v86, v86, v50
    v_mfma_f32_16x16x32_bf16 v[42:45], a[248:251], a[72:75], v[42:45]
    v_add_f32 v87, v87, v51
    v_add_f32 v88, v88, v52
    v_mfma_f32_16x16x32_bf16 v[42:45], a[108:111], a[76:79], v[42:45]
    global_load_dwordx4 a[212:215], v253, s[10:11] offset:1024 sc1
    v_add_f32 v89, v89, v53
    v_mfma_f32_16x16x32_bf16 v[38:41], v[216:219], a[64:67], v[38:41]
    v_add_f32 v90, v90, v54
    v_add_f32 v91, v91, v55
    v_mfma_f32_16x16x32_bf16 v[38:41], v[236:239], a[68:71], v[38:41]
    v_add_f32 v92, v92, v56
    v_add_f32 v93, v93, v57
    v_mfma_f32_16x16x32_bf16 v[38:41], a[244:247], a[72:75], v[38:41]
    global_load_dwordx4 a[216:219], v253, s[10:11] offset:2048 sc1
    v_add_f32 v86, v86, v58
    v_mfma_f32_16x16x32_bf16 v[38:41], a[104:107], a[76:79], v[38:41]
    v_add_f32 v87, v87, v59
    v_add_f32 v88, v88, v60
    v_mfma_f32_16x16x32_bf16 v[34:37], v[212:215], a[64:67], v[34:37]
    v_add_f32 v89, v89, v61
    v_add_f32 v90, v90, v62
    v_mfma_f32_16x16x32_bf16 v[34:37], v[232:235], a[68:71], v[34:37]
    global_load_dwordx4 a[220:223], v253, s[12:13] offset:0 sc1
    v_add_f32 v91, v91, v63
    v_mfma_f32_16x16x32_bf16 v[34:37], a[240:243], a[72:75], v[34:37]
    v_add_f32 v92, v92, v64
    v_add_f32 v93, v93, v65
    v_mfma_f32_16x16x32_bf16 v[34:37], a[100:103], a[76:79], v[34:37]
    v_add_f32 v86, v86, v66
    v_add_f32 v87, v87, v67
    v_mfma_f32_16x16x32_bf16 v[30:33], v[208:211], a[64:67], v[30:33]
    global_load_dwordx4 a[224:227], v253, s[12:13] offset:1024 sc1
    v_add_f32 v88, v88, v68
    v_mfma_f32_16x16x32_bf16 v[30:33], v[228:231], a[68:71], v[30:33]
    v_add_f32 v89, v89, v69
    v_add_f32 v90, v90, v70
    v_mfma_f32_16x16x32_bf16 v[30:33], v[248:251], a[72:75], v[30:33]
    v_add_f32 v91, v91, v71
    v_add_f32 v92, v92, v72
    v_mfma_f32_16x16x32_bf16 v[30:33], a[96:99], a[76:79], v[30:33]
    v_add_f32 v93, v93, v73
    v_add_f32 v86, v86, v74
    v_mfma_f32_16x16x32_bf16 v[30:33], a[116:119], a[80:83], v[30:33]
    s_mov_b32 s73, 319488
    v_add_f32 v87, v87, v75
    v_mfma_f32_16x16x32_bf16 v[30:33], a[136:139], a[84:87], v[30:33]
    s_waitcnt vmcnt(9)
    global_load_dwordx4 a[228:231], v253, s[12:13] offset:2048 sc1
    v_mfma_f32_16x16x32_bf16 v[30:33], a[156:159], a[88:91], v[30:33]
    s_waitcnt vmcnt(9)
    v_add_f32 v88, v88, v76
    v_add_f32 v89, v89, v77
    v_mfma_f32_16x16x32_bf16 v[30:33], a[176:179], a[92:95], v[30:33]
    buffer_load_dwordx2 v[254:255], v127, s[40:43], s73 offen sc1
    v_mfma_f32_16x16x32_bf16 v[34:37], a[120:123], a[80:83], v[34:37]
    global_load_dwordx4 a[232:235], v253, s[14:15] offset:0 sc1
    v_add_f32 v90, v90, v78
    v_mfma_f32_16x16x32_bf16 v[34:37], a[140:143], a[84:87], v[34:37]
    global_load_dwordx4 a[236:239], v253, s[14:15] offset:1024 sc1
    v_add_f32 v91, v91, v79
    v_mfma_f32_16x16x32_bf16 v[34:37], a[160:163], a[88:91], v[34:37]
    v_add_f32 v92, v92, v80
    v_add_f32 v93, v93, v81
    v_mfma_f32_16x16x32_bf16 v[34:37], a[180:183], a[92:95], v[34:37]
    v_cvt_pk_bf16_f32 v120, v86, v87
    v_cvt_pk_bf16_f32 v121, v88, v89
    v_mfma_f32_16x16x32_bf16 v[38:41], a[124:127], a[80:83], v[38:41]
    global_load_dwordx4 a[0:3], v253, s[14:15] offset:2048 sc1
    v_cvt_pk_bf16_f32 v122, v90, v91
    v_cvt_pk_bf16_f32 v123, v92, v93
    v_mfma_f32_16x16x32_bf16 v[38:41], a[144:147], a[84:87], v[38:41]
    ds_write_b128 v2, v[30:33] offset:22528
    v_mfma_f32_16x16x32_bf16 v[38:41], a[164:167], a[88:91], v[38:41]
    buffer_store_dwordx4 v[120:123], v5, s[64:67], s47 offen nt
    v_mfma_f32_16x16x32_bf16 v[38:41], a[184:187], a[92:95], v[38:41]
    v_mfma_f32_16x16x32_bf16 v[42:45], a[128:131], a[80:83], v[42:45]
    ds_read_b128 v[82:85], v4 offset:2816
    v_mfma_f32_16x16x32_bf16 v[42:45], a[148:151], a[84:87], v[42:45]
    ds_write_b128 v2, v[34:37] offset:22560
    v_mfma_f32_16x16x32_bf16 v[42:45], a[168:171], a[88:91], v[42:45]
    v_mfma_f32_16x16x32_bf16 v[42:45], a[188:191], a[92:95], v[42:45]
    v_mfma_f32_16x16x32_bf16 v[46:49], a[132:135], a[80:83], v[46:49]
    s_waitcnt lgkmcnt(1)
    v_mfma_f32_16x16x32_bf16 v[46:49], a[152:155], a[84:87], v[46:49]
    ds_write_b128 v2, v[38:41] offset:22592
    v_mfma_f32_16x16x32_bf16 v[46:49], a[172:175], a[88:91], v[46:49]
    v_mfma_f32_16x16x32_bf16 v[46:49], a[192:195], a[92:95], v[46:49]
    s_waitcnt vmcnt(13)
    v_mfma_f32_16x16x32_bf16 v[10:13], v[128:131], a[196:199], 0
    s_waitcnt vmcnt(12)
    v_mfma_f32_16x16x32_bf16 v[10:13], v[148:151], a[200:203], v[10:13]
    s_waitcnt vmcnt(11)
    ds_write_b128 v2, v[42:45] offset:22624
    v_mfma_f32_16x16x32_bf16 v[10:13], v[168:171], a[204:207], v[10:13]
    s_waitcnt vmcnt(10)
    v_mfma_f32_16x16x32_bf16 v[10:13], v[188:191], a[208:211], v[10:13]
    v_mfma_f32_16x16x32_bf16 v[14:17], v[132:135], a[196:199], 0
    v_mfma_f32_16x16x32_bf16 v[14:17], v[152:155], a[200:203], v[14:17]
    ds_write_b128 v2, v[46:49] offset:22656
    v_mfma_f32_16x16x32_bf16 v[14:17], v[172:175], a[204:207], v[14:17]
    v_lshlrev_b32 v86, 16, v82
    v_and_b32 v87, 0xffff0000, v82
    v_mfma_f32_16x16x32_bf16 v[14:17], v[192:195], a[208:211], v[14:17]
    v_lshlrev_b32 v88, 16, v83
    v_and_b32 v89, 0xffff0000, v83
    v_mfma_f32_16x16x32_bf16 v[18:21], v[136:139], a[196:199], 0
    v_lshlrev_b32 v90, 16, v84
    v_and_b32 v91, 0xffff0000, v84
    v_mfma_f32_16x16x32_bf16 v[18:21], v[156:159], a[200:203], v[18:21]
    v_lshlrev_b32 v92, 16, v85
    v_and_b32 v93, 0xffff0000, v85
    v_mfma_f32_16x16x32_bf16 v[18:21], v[176:179], a[204:207], v[18:21]
    s_waitcnt lgkmcnt(0)
    s_barrier
    ds_read_b128 v[50:53], v3 offset:22528
    v_mfma_f32_16x16x32_bf16 v[18:21], v[196:199], a[208:211], v[18:21]
    ds_read_b128 v[54:57], v3 offset:25344
    ds_read_b128 v[58:61], v3 offset:28160
    v_mfma_f32_16x16x32_bf16 v[22:25], v[140:143], a[196:199], 0
    ds_read_b128 v[62:65], v3 offset:30976
    v_mfma_f32_16x16x32_bf16 v[22:25], v[160:163], a[200:203], v[22:25]
    ds_read_b128 v[66:69], v3 offset:33792
    s_waitcnt vmcnt(4)
    v_cmp_ne_u64 vcc, s[44:45], v[254:255]
    v_mfma_f32_16x16x32_bf16 v[22:25], v[180:183], a[204:207], v[22:25]
    s_nop 0
    s_cbranch_vccnz L_retry_21
L_seen_22:
    ds_read_b128 v[70:73], v3 offset:36608
    v_add_u32 v117, 319488, v252
    v_mfma_f32_16x16x32_bf16 v[22:25], v[200:203], a[208:211], v[22:25]
    global_load_dwordx4 a[4:7], v117, s[8:9] offset:0 sc1
    global_load_dwordx4 a[8:11], v117, s[8:9] offset:1024 sc1
    v_mfma_f32_16x16x32_bf16 v[26:29], v[144:147], a[196:199], 0
    global_load_dwordx4 a[12:15], v117, s[8:9] offset:2048 sc1
    global_load_dwordx4 a[16:19], v117, s[10:11] offset:0 sc1
    v_mfma_f32_16x16x32_bf16 v[26:29], v[164:167], a[200:203], v[26:29]
    global_load_dwordx4 a[20:23], v117, s[10:11] offset:1024 sc1
    ds_read_b128 v[74:77], v3 offset:39424
    v_mfma_f32_16x16x32_bf16 v[26:29], v[184:187], a[204:207], v[26:29]
    ds_read_b128 v[78:81], v3 offset:42240
    v_mfma_f32_16x16x32_bf16 v[26:29], v[204:207], a[208:211], v[26:29]
    v_mfma_f32_16x16x32_bf16 v[26:29], v[224:227], a[212:215], v[26:29]
    v_mfma_f32_16x16x32_bf16 v[26:29], v[244:247], a[216:219], v[26:29]
    v_mfma_f32_16x16x32_bf16 v[26:29], a[252:255], a[220:223], v[26:29]
    v_mfma_f32_16x16x32_bf16 v[26:29], a[112:115], a[224:227], v[26:29]
    global_load_dwordx4 a[24:27], v117, s[10:11] offset:2048 sc1
    v_mfma_f32_16x16x32_bf16 v[22:25], v[220:223], a[212:215], v[22:25]
    v_mfma_f32_16x16x32_bf16 v[22:25], v[240:243], a[216:219], v[22:25]
    global_load_dwordx4 a[28:31], v117, s[12:13] offset:0 sc1
    v_mfma_f32_16x16x32_bf16 v[22:25], a[248:251], a[220:223], v[22:25]
    s_waitcnt lgkmcnt(0)
    s_add_u32 s47, s46, 655360
    v_mfma_f32_16x16x32_bf16 v[22:25], a[108:111], a[224:227], v[22:25]
    v_add_f32 v86, v86, v50
    v_add_f32 v87, v87, v51
    v_mfma_f32_16x16x32_bf16 v[18:21], v[216:219], a[212:215], v[18:21]
    v_add_f32 v88, v88, v52
    v_add_f32 v89, v89, v53
    v_mfma_f32_16x16x32_bf16 v[18:21], v[236:239], a[216:219], v[18:21]
    v_add_f32 v90, v90, v54
    v_add_f32 v91, v91, v55
    v_mfma_f32_16x16x32_bf16 v[18:21], a[244:247], a[220:223], v[18:21]
    global_load_dwordx4 a[32:35], v117, s[12:13] offset:1024 sc1
    v_add_f32 v92, v92, v56
    v_mfma_f32_16x16x32_bf16 v[18:21], a[104:107], a[224:227], v[18:21]
    v_add_f32 v93, v93, v57
    v_add_f32 v86, v86, v58
    v_mfma_f32_16x16x32_bf16 v[14:17], v[212:215], a[212:215], v[14:17]
L_padB_7:
    s_cbranch_execz L_backB
    v_add_f32 v87, v87, v59
    v_add_f32 v88, v88, v60
    v_mfma_f32_16x16x32_bf16 v[14:17], v[232:235], a[216:219], v[14:17]
    v_add_f32 v89, v89, v61
    v_add_f32 v90, v90, v62
    v_mfma_f32_16x16x32_bf16 v[14:17], a[240:243], a[220:223], v[14:17]
    v_add_f32 v91, v91, v63
    v_add_f32 v92, v92, v64
    v_mfma_f32_16x16x32_bf16 v[14:17], a[100:103], a[224:227], v[14:17]
    global_load_dwordx4 a[36:39], v117, s[12:13] offset:2048 sc1
    v_add_f32 v93, v93, v65
    v_mfma_f32_16x16x32_bf16 v[10:13], v[208:211], a[212:215], v[10:13]
    v_add_f32 v86, v86, v66
    v_add_f32 v87, v87, v67
    v_mfma_f32_16x16x32_bf16 v[10:13], v[228:231], a[216:219], v[10:13]
    v_add_f32 v88, v88, v68
    v_add_f32 v89, v89, v69
    v_mfma_f32_16x16x32_bf16 v[10:13], v[248:251], a[220:223], v[10:13]
    v_add_f32 v90, v90, v70
    v_add_f32 v91, v91, v71
    v_mfma_f32_16x16x32_bf16 v[10:13], a[96:99], a[224:227], v[10:13]
    v_add_f32 v92, v92, v72
    v_add_f32 v93, v93, v73
    v_mfma_f32_16x16x32_bf16 v[10:13], a[116:119], a[228:231], v[10:13]
    s_waitcnt vmcnt(12)
    v_add_f32 v86, v86, v74
    v_add_f32 v87, v87, v75
    v_mfma_f32_16x16x32_bf16 v[10:13], a[136:139], a[232:235], v[10:13]
    s_waitcnt vmcnt(11)
    v_add_f32 v88, v88, v76
    v_add_f32 v89, v89, v77
    v_mfma_f32_16x16x32_bf16 v[10:13], a[156:159], a[236:239], v[10:13]
    s_waitcnt vmcnt(10)
    v_add_f32 v90, v90, v78
    v_add_f32 v91, v91, v79
    v_mfma_f32_16x16x32_bf16 v[10:13], a[176:179], a[0:3], v[10:13]
    global_load_dwordx4 a[40:43], v117, s[14:15] offset:0 sc1
    v_add_f32 v92, v92, v80
    v_mfma_f32_16x16x32_bf16 v[14:17], a[120:123], a[228:231], v[14:17]
    v_add_f32 v93, v93, v81
    v_cvt_pk_bf16_f32 v120, v86, v87
    v_mfma_f32_16x16x32_bf16 v[14:17], a[140:143], a[232:235], v[14:17]
    global_load_dwordx4 a[44:47], v117, s[14:15] offset:1024 sc1
    v_cvt_pk_bf16_f32 v121, v88, v89
    v_mfma_f32_16x16x32_bf16 v[14:17], a[160:163], a[236:239], v[14:17]
    v_cvt_pk_bf16_f32 v122, v90, v91
    v_cvt_pk_bf16_f32 v123, v92, v93
    v_mfma_f32_16x16x32_bf16 v[14:17], a[180:183], a[0:3], v[14:17]
    buffer_store_dwordx4 v[120:123], v5, s[64:67], s47 offen nt
    v_mfma_f32_16x16x32_bf16 v[18:21], a[124:127], a[228:231], v[18:21]
    ds_read_b128 v[82:85], v4 offset:5632
    v_mfma_f32_16x16x32_bf16 v[18:21], a[144:147], a[232:235], v[18:21]
    ds_write_b128 v2, v[10:13] offset:0
    v_mfma_f32_16x16x32_bf16 v[18:21], a[164:167], a[236:239], v[18:21]
    global_load_dwordx4 a[48:51], v117, s[14:15] offset:2048 sc1
    v_mfma_f32_16x16x32_bf16 v[18:21], a[184:187], a[0:3], v[18:21]
    v_mfma_f32_16x16x32_bf16 v[22:25], a[128:131], a[228:231], v[22:25]
    s_waitcnt lgkmcnt(1)
    v_mfma_f32_16x16x32_bf16 v[22:25], a[148:151], a[232:235], v[22:25]
    ds_write_b128 v2, v[14:17] offset:32
    v_mfma_f32_16x16x32_bf16 v[22:25], a[168:171], a[236:239], v[22:25]
    v_mfma_f32_16x16x32_bf16 v[22:25], a[188:191], a[0:3], v[22:25]
    v_mfma_f32_16x16x32_bf16 v[26:29], a[132:135], a[228:231], v[26:29]
    v_mfma_f32_16x16x32_bf16 v[26:29], a[152:155], a[232:235], v[26:29]
    ds_write_b128 v2, v[18:21] offset:64
    v_mfma_f32_16x16x32_bf16 v[26:29], a[172:175], a[236:239], v[26:29]
    v_mfma_f32_16x16x32_bf16 v[26:29], a[192:195], a[0:3], v[26:29]
    s_waitcnt vmcnt(12)
    v_mfma_f32_16x16x32_bf16 v[30:33], v[128:131], a[4:7], 0
    s_waitcnt vmcnt(11)
    v_mfma_f32_16x16x32_bf16 v[30:33], v[148:151], a[8:11], v[30:33]
    s_waitcnt vmcnt(10)
    ds_write_b128 v2, v[22:25] offset:96
    v_mfma_f32_16x16x32_bf16 v[30:33], v[168:171], a[12:15], v[30:33]
    s_waitcnt vmcnt(9)
    v_mfma_f32_16x16x32_bf16 v[30:33], v[188:191], a[16:19], v[30:33]
    v_mfma_f32_16x16x32_bf16 v[34:37], v[132:135], a[4:7], 0
    v_mfma_f32_16x16x32_bf16 v[34:37], v[152:155], a[8:11], v[34:37]
    ds_write_b128 v2, v[26:29] offset:128
    v_mfma_f32_16x16x32_bf16 v[34:37], v[172:175], a[12:15], v[34:37]
    v_lshlrev_b32 v86, 16, v82
    v_and_b32 v87, 0xffff0000, v82
    v_mfma_f32_16x16x32_bf16 v[34:37], v[192:195], a[16:19], v[34:37]
    v_lshlrev_b32 v88, 16, v83
    v_and_b32 v89, 0xffff0000, v83
    v_mfma_f32_16x16x32_bf16 v[38:41], v[136:139], a[4:7], 0
    v_lshlrev_b32 v90, 16, v84
    v_and_b32 v91, 0xffff0000, v84
    v_mfma_f32_16x16x32_bf16 v[38:41], v[156:159], a[8:11], v[38:41]
    v_lshlrev_b32 v92, 16, v85
    v_and_b32 v93, 0xffff0000, v85
    v_mfma_f32_16x16x32_bf16 v[38:41], v[176:179], a[12:15], v[38:41]
    s_waitcnt lgkmcnt(0)
    s_barrier
    ds_read_b128 v[50:53], v3 offset:0
    v_mfma_f32_16x16x32_bf16 v[38:41], v[196:199], a[16:19], v[38:41]
    ds_read_b128 v[54:57], v3 offset:2816
    ds_read_b128 v[58:61], v3 offset:5632
    v_mfma_f32_16x16x32_bf16 v[42:45], v[140:143], a[4:7], 0
    ds_read_b128 v[62:65], v3 offset:8448
    v_mfma_f32_16x16x32_bf16 v[42:45], v[160:163], a[8:11], v[42:45]
    ds_read_b128 v[66:69], v3 offset:11264
    v_mfma_f32_16x16x32_bf16 v[42:45], v[180:183], a[12:15], v[42:45]
    ds_read_b128 v[70:73], v3 offset:14080
    v_mfma_f32_16x16x32_bf16 v[42:45], v[200:203], a[16:19], v[42:45]
    v_mfma_f32_16x16x32_bf16 v[46:49], v[144:147], a[4:7], 0
    ds_read_b128 v[74:77], v3 offset:16896
    v_mfma_f32_16x16x32_bf16 v[46:49], v[164:167], a[8:11], v[46:49]
    ds_read_b128 v[78:81], v3 offset:19712
    v_mfma_f32_16x16x32_bf16 v[46:49], v[184:187], a[12:15], v[46:49]
    v_mfma_f32_16x16x32_bf16 v[46:49], v[204:207], a[16:19], v[46:49]
    s_waitcnt vmcnt(8)
    v_mfma_f32_16x16x32_bf16 v[46:49], v[224:227], a[20:23], v[46:49]
    s_waitcnt vmcnt(7)
    v_mfma_f32_16x16x32_bf16 v[46:49], v[244:247], a[24:27], v[46:49]
    s_waitcnt vmcnt(6)
    v_mfma_f32_16x16x32_bf16 v[46:49], a[252:255], a[28:31], v[46:49]
    s_waitcnt vmcnt(5)
    v_mfma_f32_16x16x32_bf16 v[46:49], a[112:115], a[32:35], v[46:49]
    v_mfma_f32_16x16x32_bf16 v[42:45], v[220:223], a[20:23], v[42:45]
    v_mfma_f32_16x16x32_bf16 v[42:45], v[240:243], a[24:27], v[42:45]
    s_waitcnt lgkmcnt(0)
    s_add_u32 s47, s46, 1310720
    v_mfma_f32_16x16x32_bf16 v[42:45], a[248:251], a[28:31], v[42:45]
    v_add_f32 v86, v86, v50
    v_add_f32 v87, v87, v51
    v_mfma_f32_16x16x32_bf16 v[42:45], a[108:111], a[32:35], v[42:45]
    v_add_f32 v88, v88, v52
    v_add_f32 v89, v89, v53
    v_mfma_f32_16x16x32_bf16 v[38:41], v[216:219], a[20:23], v[38:41]
    v_add_f32 v90, v90, v54
    v_add_f32 v91, v91, v55
    v_mfma_f32_16x16x32_bf16 v[38:41], v[236:239], a[24:27], v[38:41]
    v_add_f32 v92, v92, v56
    v_add_f32 v93, v93, v57
    v_mfma_f32_16x16x32_bf16 v[38:41], a[244:247], a[28:31], v[38:41]
    v_add_f32 v86, v86, v58
    v_add_f32 v87, v87, v59
    v_mfma_f32_16x16x32_bf16 v[38:41], a[104:107], a[32:35], v[38:41]
    v_add_f32 v88, v88, v60
    v_add_f32 v89, v89, v61
    v_mfma_f32_16x16x32_bf16 v[34:37], v[212:215], a[20:23], v[34:37]
    v_add_f32 v90, v90, v62
    v_add_f32 v91, v91, v63
    v_mfma_f32_16x16x32_bf16 v[34:37], v[232:235], a[24:27], v[34:37]
    v_add_f32 v92, v92, v64
    v_add_f32 v93, v93, v65
    v_mfma_f32_16x16x32_bf16 v[34:37], a[240:243], a[28:31], v[34:37]
    v_add_f32 v86, v86, v66
    v_add_f32 v87, v87, v67
    v_mfma_f32_16x16x32_bf16 v[34:37], a[100:103], a[32:35], v[34:37]
    v_add_f32 v88, v88, v68
    v_add_f32 v89, v89, v69
    v_mfma_f32_16x16x32_bf16 v[30:33], v[208:211], a[20:23], v[30:33]
    v_add_f32 v90, v90, v70
    v_add_f32 v91, v91, v71
    v_mfma_f32_16x16x32_bf16 v[30:33], v[228:231], a[24:27], v[30:33]
    v_add_f32 v92, v92, v72
    v_add_f32 v93, v93, v73
    v_mfma_f32_16x16x32_bf16 v[30:33], v[248:251], a[28:31], v[30:33]
    v_add_f32 v86, v86, v74
    v_add_f32 v87, v87, v75
    v_mfma_f32_16x16x32_bf16 v[30:33], a[96:99], a[32:35], v[30:33]
    s_waitcnt vmcnt(4)
    v_add_f32 v88, v88, v76
    v_add_f32 v89, v89, v77
    v_mfma_f32_16x16x32_bf16 v[30:33], a[116:119], a[36:39], v[30:33]
    s_waitcnt vmcnt(3)
    v_add_f32 v90, v90, v78
    v_add_f32 v91, v91, v79
    v_mfma_f32_16x16x32_bf16 v[30:33], a[136:139], a[40:43], v[30:33]
    s_waitcnt vmcnt(2)
    v_add_f32 v92, v92, v80
    v_add_f32 v93, v93, v81
    v_mfma_f32_16x16x32_bf16 v[30:33], a[156:159], a[44:47], v[30:33]
    s_waitcnt vmcnt(0)
    v_cvt_pk_bf16_f32 v120, v86, v87
    v_cvt_pk_bf16_f32 v121, v88, v89
    v_mfma_f32_16x16x32_bf16 v[30:33], a[176:179], a[48:51], v[30:33]
    v_cvt_pk_bf16_f32 v122, v90, v91
    v_cvt_pk_bf16_f32 v123, v92, v93
    v_mfma_f32_16x16x32_bf16 v[34:37], a[120:123], a[36:39], v[34:37]
    buffer_store_dwordx4 v[120:123], v5, s[64:67], s47 offen nt
    v_mfma_f32_16x16x32_bf16 v[34:37], a[140:143], a[40:43], v[34:37]
    ds_read_b128 v[82:85], v4 offset:8448
    v_mfma_f32_16x16x32_bf16 v[34:37], a[160:163], a[44:47], v[34:37]
    v_mfma_f32_16x16x32_bf16 v[34:37], a[180:183], a[48:51], v[34:37]
    v_mfma_f32_16x16x32_bf16 v[38:41], a[124:127], a[36:39], v[38:41]
    v_mfma_f32_16x16x32_bf16 v[38:41], a[144:147], a[40:43], v[38:41]
    s_waitcnt lgkmcnt(0)
    ds_write_b128 v2, v[30:33] offset:22528
    v_mfma_f32_16x16x32_bf16 v[38:41], a[164:167], a[44:47], v[38:41]
    v_mfma_f32_16x16x32_bf16 v[38:41], a[184:187], a[48:51], v[38:41]
    v_mfma_f32_16x16x32_bf16 v[42:45], a[128:131], a[36:39], v[42:45]
    v_mfma_f32_16x16x32_bf16 v[42:45], a[148:151], a[40:43], v[42:45]
    ds_write_b128 v2, v[34:37] offset:22560
    v_mfma_f32_16x16x32_bf16 v[42:45], a[168:171], a[44:47], v[42:45]
    v_mfma_f32_16x16x32_bf16 v[42:45], a[188:191], a[48:51], v[42:45]
    v_lshlrev_b32 v86, 16, v82
    v_and_b32 v87, 0xffff0000, v82
    v_mfma_f32_16x16x32_bf16 v[46:49], a[132:135], a[36:39], v[46:49]
    v_lshlrev_b32 v88, 16, v83
    v_and_b32 v89, 0xffff0000, v83
    v_mfma_f32_16x16x32_bf16 v[46:49], a[152:155], a[40:43], v[46:49]
    ds_write_b128 v2, v[38:41] offset:22592
    v_mfma_f32_16x16x32_bf16 v[46:49], a[172:175], a[44:47], v[46:49]
    v_lshlrev_b32 v90, 16, v84
    v_and_b32 v91, 0xffff0000, v84
    v_mfma_f32_16x16x32_bf16 v[46:49], a[192:195], a[48:51], v[46:49]
    v_lshlrev_b32 v92, 16, v85
    v_and_b32 v93, 0xffff0000, v85
    ds_write_b128 v2, v[42:45] offset:22624
    s_nop 4
    ds_write_b128 v2, v[46:49] offset:22656
    s_waitcnt lgkmcnt(0)
    s_barrier
    ds_read_b128 v[50:53], v3 offset:22528
    ds_read_b128 v[54:57], v3 offset:25344
    ds_read_b128 v[58:61], v3 offset:28160
    ds_read_b128 v[62:65], v3 offset:30976
    ds_read_b128 v[66:69], v3 offset:33792
    ds_read_b128 v[70:73], v3 offset:36608
    ds_read_b128 v[74:77], v3 offset:39424
    ds_read_b128 v[78:81], v3 offset:42240
    s_add_u32 s47, s46, 1966080
    s_waitcnt lgkmcnt(7)
    v_pk_add_f32 v[86:87], v[86:87], v[50:51]
    v_pk_add_f32 v[88:89], v[88:89], v[52:53]
    s_waitcnt lgkmcnt(6)
    v_pk_add_f32 v[90:91], v[90:91], v[54:55]
    v_pk_add_f32 v[92:93], v[92:93], v[56:57]
    s_waitcnt lgkmcnt(5)
    v_pk_add_f32 v[86:87], v[86:87], v[58:59]
    v_pk_add_f32 v[88:89], v[88:89], v[60:61]
    s_waitcnt lgkmcnt(4)
    v_pk_add_f32 v[90:91], v[90:91], v[62:63]
    v_pk_add_f32 v[92:93], v[92:93], v[64:65]
    s_waitcnt lgkmcnt(3)
    v_pk_add_f32 v[86:87], v[86:87], v[66:67]
    v_pk_add_f32 v[88:89], v[88:89], v[68:69]
    s_waitcnt lgkmcnt(2)
    v_pk_add_f32 v[90:91], v[90:91], v[70:71]
    v_pk_add_f32 v[92:93], v[92:93], v[72:73]
    s_waitcnt lgkmcnt(1)
    v_pk_add_f32 v[86:87], v[86:87], v[74:75]
    v_pk_add_f32 v[88:89], v[88:89], v[76:77]
    s_waitcnt lgkmcnt(0)
    v_pk_add_f32 v[90:91], v[90:91], v[78:79]
    v_pk_add_f32 v[92:93], v[92:93], v[80:81]
    v_cvt_pk_bf16_f32 v120, v86, v87
    v_cvt_pk_bf16_f32 v121, v88, v89
    v_cvt_pk_bf16_f32 v122, v90, v91
    v_cvt_pk_bf16_f32 v123, v92, v93
    buffer_store_dwordx4 v[120:123], v5, s[64:67], s47 offen
L_end:
    s_endpgm
L_helper:
    buffer_load_dword v179, v138, s[40:43], 0 offen sc1
    s_sub_u32 s50, s2, 160
    v_and_b32 v196, 31, v1
    v_lshlrev_b32 v196, 2, v196
    v_mov_b32 v197, 0
    v_lshl_add_u64 v[198:199], v[196:197], 0, s[26:27]
    s_mov_b32 exec_hi, 0
    v_lshl_add_u64 v[198:199], v[196:197], 0, s[24:25]
    s_mov_b32 exec_hi, -1
    s_lshl3_add_u32 s60, s50, s36
    s_add_u32 s60, s60, 0
    s_mul_i32 s66, s50, 2731
    s_lshr_b32 s66, s66, 16
    s_mul_i32 s66, s66, 48
    s_add_u32 s60, s60, s66
    s_mul_i32 s61, s60, 5462
    s_lshr_b32 s61, s61, 16
    s_lshl3_add_u32 s62, s50, s36
    s_add_u32 s62, s62, 4
    s_mul_i32 s66, s50, 2731
    s_lshr_b32 s66, s66, 16
    s_mul_i32 s66, s66, 48
    s_add_u32 s62, s62, s66
    s_mul_i32 s63, s62, 5462
    s_lshr_b32 s63, s63, 16
    s_lshr_b32 s66, s36, 1
    s_and_b32 s69, s36, 1
    s_lshl1_add_u32 s64, s50, s66
    s_mul_i32 s66, s64, 1366
    s_lshr_b32 s66, s66, 16
    s_add_u32 s66, s66, 1
    s_mul_i32 s66, s66, 192
    s_add_u32 s64, s64, s66
    s_mul_i32 s65, s64, 5462
    s_lshr_b32 s65, s65, 16
    v_mul_u32_u24 v141, 1344, v5
    v_add_u32 v141, 123904, v141
    v_lshl_add_u32 v140, v6, 2, v141
    v_add_u32 v140, 1024, v140
    v_lshl_add_u32 v141, v6, 4, v141
    v_and_b32 v143, 3, v5
    v_mul_u32_u24 v143, 2688, v143
    v_add_u32 v143, 125184, v143
    v_mov_b32 v2, 0
    v_mov_b32 v3, 0
    ds_write_b64 v143, v[2:3]
    v_lshrrev_b32 v139, 2, v5
    v_lshl_add_u32 v143, v139, 1, v143
    v_bfe_u32 v142, v1, 2, 2
    v_mul_u32_u24 v142, 1344, v142
    v_lshrrev_b32 v139, 4, v1
    v_lshl_add_u32 v142, v139, 5, v142
    v_and_b32 v139, 3, v1
    v_lshl_add_u32 v142, v139, 3, v142
    s_lshl_b32 s48, s36, 7
    s_add_u32 s48, s48, 123904
    v_add_u32 v142, s48, v142
    s_lshr_b32 s51, s2, 2
    s_and_b32 s48, s51, 7
    s_lshl_b32 s49, s2, 1
    s_and_b32 s49, s49, 4
    s_xor_b32 s48, s48, s49
    v_xor_b32 v139, s48, v139
    v_lshrrev_b32 v8, 2, v1
    v_lshlrev_b32 v8, 8, v8
    v_lshl_add_u32 v8, v139, 4, v8
    v_cmp_gt_u32 vcc, 132, v0
    v_mov_b32 v37, 0x40000000
    s_mul_i32 s51, s51, 41216
    s_and_b32 s48, s2, 1
    v_cndmask_b32 v37, v37, v8, vcc
    s_lshl_b32 s48, s48, 7
    s_add_u32 s51, s51, s48
    s_lshl_b32 s48, s36, 12
    s_add_u32 s51, s51, s48
    s_add_u32 s51, s51, 1048576
    s_add_u32 s52, s51, 16384
    s_add_u32 s53, s51, 32768
    s_mov_b32 s54, 0x3f803f80
    s_lshl_b32 s48, s2, 6
    v_lshrrev_b32 v174, 3, v1
    v_lshl_add_u32 v174, v174, 15, s48
    v_and_b32 v175, 7, v1
    v_lshl_add_u32 v174, v175, 3, v174
    s_min_u32 s48, s36, 1
    s_lshl_b32 s48, s48, 30
    v_add_u32 v177, s48, v174
    s_mul_i32 s48, s36, 327680
    s_add_u32 s48, s48, 4194304
    buffer_store_dwordx2 v[2:3], v174, s[40:43], s48 offen sc1
    s_mov_b32 s48, 5505024
    buffer_store_dwordx2 v[2:3], v177, s[40:43], s48 offen sc1
    s_waitcnt vmcnt(6)
    v_dot2c_f32_bf16 v2, s54, v10
    v_dot2c_f32_bf16 v3, v10, v10
    v_dot2c_f32_bf16 v2, s54, v11
    v_dot2c_f32_bf16 v3, v11, v11
    v_dot2c_f32_bf16 v2, s54, v12
    v_dot2c_f32_bf16 v3, v12, v12
    v_dot2c_f32_bf16 v2, s54, v13
    v_dot2c_f32_bf16 v3, v13, v13
    s_waitcnt vmcnt(5)
    v_dot2c_f32_bf16 v2, s54, v14
    v_dot2c_f32_bf16 v3, v14, v14
    v_dot2c_f32_bf16 v2, s54, v15
    v_dot2c_f32_bf16 v3, v15, v15
    v_dot2c_f32_bf16 v2, s54, v16
    v_dot2c_f32_bf16 v3, v16, v16
    v_dot2c_f32_bf16 v2, s54, v17
    v_dot2c_f32_bf16 v3, v17, v17
    s_waitcnt vmcnt(4)
    v_dot2c_f32_bf16 v2, s54, v18
    v_dot2c_f32_bf16 v3, v18, v18
    s_waitcnt vmcnt(3)
    v_dot2c_f32_bf16 v2, s54, v19
    v_dot2c_f32_bf16 v3, v19, v19
    s_mov_b32 s49, 0
    s_mul_i32 s48, s61, 21504
    s_lshl_b32 s67, s60, 8
    s_add_u32 s48, s48, s67
    s_add_u32 s48, s48, 3072
    v_lshl_add_u64 v[190:191], v[198:199], 0, s[48:49]
    s_add_u32 s48, s48, 9216
    v_lshl_add_u64 v[192:193], v[198:199], 0, s[48:49]
    s_add_u32 s48, s48, 9216
    v_lshl_add_u64 v[194:195], v[198:199], 0, s[48:49]
    global_load_dword v200, v[190:191], off offset:-3072
    global_load_dword v208, v[190:191], off offset:-2944
    global_load_dword v201, v[190:191], off offset:0
    global_load_dword v209, v[190:191], off offset:128
    global_load_dword v202, v[190:191], off offset:3072
    global_load_dword v210, v[190:191], off offset:3200
    global_load_dword v203, v[192:193], off offset:-3072
    global_load_dword v211, v[192:193], off offset:-2944
    global_load_dword v204, v[192:193], off offset:0
    global_load_dword v212, v[192:193], off offset:128
    global_load_dword v205, v[192:193], off offset:3072
    global_load_dword v213, v[192:193], off offset:3200
    global_load_dword v206, v[194:195], off offset:-3072
    global_load_dword v214, v[194:195], off offset:-2944
    global_load_dword v207, v[194:195], off offset:0
    global_load_dword v215, v[194:195], off offset:128
    v_and_b32 v99, 0xffff0000, v19
    v_and_b32 v97, 0xffff0000, v18
    v_and_b32 v95, 0xffff0000, v17
    v_add_f32_dpp v2, v2, v2 quad_perm:[1,0,3,2] row_mask:0xf bank_mask:0xf
    v_add_f32_dpp v3, v3, v3 quad_perm:[1,0,3,2] row_mask:0xf bank_mask:0xf
    v_and_b32 v93, 0xffff0000, v16
    v_add_f32_dpp v2, v2, v2 quad_perm:[2,3,0,1] row_mask:0xf bank_mask:0xf
    v_add_f32_dpp v3, v3, v3 quad_perm:[2,3,0,1] row_mask:0xf bank_mask:0xf
    v_and_b32 v91, 0xffff0000, v15
    v_add_f32_dpp v2, v2, v2 row_half_mirror row_mask:0xf bank_mask:0xf
    v_add_f32_dpp v3, v3, v3 row_half_mirror row_mask:0xf bank_mask:0xf
    v_and_b32 v89, 0xffff0000, v14
    v_add_f32_dpp v2, v2, v2 row_mirror row_mask:0xf bank_mask:0xf
    v_add_f32_dpp v3, v3, v3 row_mirror row_mask:0xf bank_mask:0xf
    v_and_b32 v87, 0xffff0000, v13
    v_mov_b32 v4, v2
    v_mov_b32 v5, v3
    v_and_b32 v85, 0xffff0000, v12
    v_and_b32 v83, 0xffff0000, v11
    v_permlane16_swap_b32 v4, v2
    v_permlane16_swap_b32 v5, v3
    v_add_f32 v2, v2, v4
    v_add_f32 v3, v3, v5
    v_mul_f32 v2, 0x3acccccd, v2
    v_mul_f32 v3, 0x3acccccd, v3
    v_fma_f32 v3, -v2, v2, v3
    v_max_f32 v3, 0, v3
    v_cvt_pk_bf16_f32 v2, v2, v3
    v_and_b32 v3, 0xffff0000, v2
    v_add_f32 v3, 0x3727c5ac, v3
    v_cvt_pk_bf16_f32 v3, v3, v3
    v_lshlrev_b32 v3, 16, v3
    v_sqrt_f32 v3, v3
    v_lshlrev_b32 v2, 16, v2
    v_cvt_pk_bf16_f32 v3, v3, v3
    v_lshlrev_b32 v3, 16, v3
    v_rcp_f32 v4, v3
    v_lshlrev_b32 v80, 16, v10
    v_lshlrev_b32 v82, 16, v11
    v_lshlrev_b32 v84, 16, v12
    v_lshlrev_b32 v86, 16, v13
    v_lshlrev_b32 v88, 16, v14
    v_lshlrev_b32 v90, 16, v15
    v_lshlrev_b32 v92, 16, v16
    v_lshlrev_b32 v94, 16, v17
    v_lshlrev_b32 v96, 16, v18
    v_lshlrev_b32 v98, 16, v19
    v_and_b32 v81, 0xffff0000, v10
    v_mul_f32_e64 v6, -v2, v4
    v_pk_fma_f32 v[80:81], v[80:81], v[4:5], v[6:7] op_sel_hi:[1,0,0]
    v_pk_fma_f32 v[82:83], v[82:83], v[4:5], v[6:7] op_sel_hi:[1,0,0]
    v_pk_fma_f32 v[84:85], v[84:85], v[4:5], v[6:7] op_sel_hi:[1,0,0]
    v_pk_fma_f32 v[86:87], v[86:87], v[4:5], v[6:7] op_sel_hi:[1,0,0]
    v_pk_fma_f32 v[88:89], v[88:89], v[4:5], v[6:7] op_sel_hi:[1,0,0]
    v_pk_fma_f32 v[90:91], v[90:91], v[4:5], v[6:7] op_sel_hi:[1,0,0]
    v_pk_fma_f32 v[92:93], v[92:93], v[4:5], v[6:7] op_sel_hi:[1,0,0]
    v_pk_fma_f32 v[94:95], v[94:95], v[4:5], v[6:7] op_sel_hi:[1,0,0]
    v_pk_fma_f32 v[96:97], v[96:97], v[4:5], v[6:7] op_sel_hi:[1,0,0]
    v_pk_fma_f32 v[98:99], v[98:99], v[4:5], v[6:7] op_sel_hi:[1,0,0]
    v_cvt_pk_bf16_f32 v128, v80, v81
    v_cvt_pk_bf16_f32 v129, v82, v83
    v_cvt_pk_bf16_f32 v130, v84, v85
    v_cvt_pk_bf16_f32 v131, v86, v87
    v_cvt_pk_bf16_f32 v132, v88, v89
    v_cvt_pk_bf16_f32 v133, v90, v91
    v_cvt_pk_bf16_f32 v134, v92, v93
    v_cvt_pk_bf16_f32 v135, v94, v95
    v_cvt_pk_bf16_f32 v136, v96, v97
    v_cvt_pk_bf16_f32 v137, v98, v99
    ds_write_b128 v141, v[128:131]
    ds_write_b128 v141, v[132:135] offset:512
    ds_write2_b32 v140, v136, v137 offset1:32
    ds_write_b16_d16_hi v143, v3 offset:1344
    ds_write_b16_d16_hi v143, v2 offset:1348
    s_waitcnt lgkmcnt(0)
    s_barrier
    ds_read_b64_tr_b16 v[100:101], v142 offset:0
    ds_read_b64_tr_b16 v[102:103], v142 offset:5376
    ds_read_b64_tr_b16 v[104:105], v142 offset:512
    ds_read_b64_tr_b16 v[106:107], v142 offset:5888
    ds_read_b64_tr_b16 v[108:109], v142 offset:1024
    ds_read_b64_tr_b16 v[110:111], v142 offset:6400
    s_waitcnt lgkmcnt(4)
    buffer_store_dwordx4 v[100:103], v8, s[40:43], s51 offen sc1
    s_waitcnt lgkmcnt(2)
    buffer_store_dwordx4 v[104:107], v8, s[40:43], s52 offen sc1
    s_waitcnt lgkmcnt(0)
    buffer_store_dwordx4 v[108:111], v37, s[40:43], s53 offen sc1
    s_mov_b32 s49, 0
    s_mul_i32 s48, s63, 21504
    s_lshl_b32 s67, s62, 8
    s_add_u32 s48, s48, s67
    s_add_u32 s48, s48, 3072
    v_lshl_add_u64 v[190:191], v[198:199], 0, s[48:49]
    s_add_u32 s48, s48, 9216
    v_lshl_add_u64 v[192:193], v[198:199], 0, s[48:49]
    s_add_u32 s48, s48, 9216
    v_lshl_add_u64 v[194:195], v[198:199], 0, s[48:49]
    global_load_dword v216, v[190:191], off offset:-3072
    global_load_dword v224, v[190:191], off offset:-2944
    global_load_dword v217, v[190:191], off offset:0
    global_load_dword v225, v[190:191], off offset:128
    global_load_dword v218, v[190:191], off offset:3072
    global_load_dword v226, v[190:191], off offset:3200
    global_load_dword v219, v[192:193], off offset:-3072
    global_load_dword v227, v[192:193], off offset:-2944
    global_load_dword v220, v[192:193], off offset:0
    global_load_dword v228, v[192:193], off offset:128
    global_load_dword v221, v[192:193], off offset:3072
    global_load_dword v229, v[192:193], off offset:3200
    global_load_dword v222, v[194:195], off offset:-3072
    global_load_dword v230, v[194:195], off offset:-2944
    global_load_dword v223, v[194:195], off offset:0
    global_load_dword v231, v[194:195], off offset:128
    s_waitcnt vmcnt(37)
    v_readfirstlane_b32 s44, v179
    s_nop 1
    s_add_u32 s44, s44, 1
    s_xor_b32 s45, s44, 0x5bd1e995
    v_mov_b32 v178, s44
    v_mov_b32 v179, s45
    s_waitcnt vmcnt(16)
    s_barrier
    s_mov_b32 s48, 4194304
    buffer_store_dwordx2 v[178:179], v177, s[40:43], s48 offen sc1
    v_bfe_u32 v180, v1, 3, 2
    v_and_b32 v181, 1, v1
    v_lshlrev_b32 v181, 4, v181
    v_bfe_u32 v182, v1, 1, 2
    v_lshl_add_u32 v181, v182, 6, v181
    v_and_b32 v182, 32, v1
    v_add_u32 v181, v181, v182
    s_mov_b32 s68, 57
    s_mov_b32 s72, 0x05040100
    s_mov_b32 s73, 0x07060302
    s_mul_i32 s48, s61, 12
    s_sub_u32 s48, s60, s48
    s_lshl_b32 s48, s48, 4
    v_lshl_add_u32 v183, v180, 1, s48
    s_lshr_b32 s48, s61, 2
    s_mul_i32 s48, s48, 3072
    s_and_b32 s67, s61, 3
    s_lshl_b32 s67, s67, 8
    s_add_u32 s48, s48, s67
    s_add_u32 s48, s48, 10485760
    v_add_u32 v184, s48, v181
    v_mul_u32_u24 v182, 21846, v183
    v_lshrrev_b32 v182, 16, v182
    v_mad_u32_u24 v182, v182, s68, v183
    v_lshl_add_u32 v160, v182, 10, v184
    v_add_u32 v183, 1, v183
    v_mul_u32_u24 v182, 21846, v183
    v_lshrrev_b32 v182, 16, v182
    v_mad_u32_u24 v182, v182, s68, v183
    v_lshl_add_u32 v161, v182, 10, v184
    v_add_u32 v183, 7, v183
    v_mul_u32_u24 v182, 21846, v183
    v_lshrrev_b32 v182, 16, v182
    v_mad_u32_u24 v182, v182, s68, v183
    v_lshl_add_u32 v162, v182, 10, v184
    v_add_u32 v183, 1, v183
    v_mul_u32_u24 v182, 21846, v183
    v_lshrrev_b32 v182, 16, v182
    v_mad_u32_u24 v182, v182, s68, v183
    v_lshl_add_u32 v163, v182, 10, v184
    s_mul_i32 s48, s63, 12
    s_sub_u32 s48, s62, s48
    s_lshl_b32 s48, s48, 4
    v_lshl_add_u32 v183, v180, 1, s48
    s_lshr_b32 s48, s63, 2
    s_mul_i32 s48, s48, 3072
    s_and_b32 s67, s63, 3
    s_lshl_b32 s67, s67, 8
    s_add_u32 s48, s48, s67
    s_add_u32 s48, s48, 10485760
    v_add_u32 v184, s48, v181
    v_mul_u32_u24 v182, 21846, v183
    v_lshrrev_b32 v182, 16, v182
    v_mad_u32_u24 v182, v182, s68, v183
    v_lshl_add_u32 v164, v182, 10, v184
    v_add_u32 v183, 1, v183
    v_mul_u32_u24 v182, 21846, v183
    v_lshrrev_b32 v182, 16, v182
    v_mad_u32_u24 v182, v182, s68, v183
    v_lshl_add_u32 v165, v182, 10, v184
    v_add_u32 v183, 7, v183
    v_mul_u32_u24 v182, 21846, v183
    v_lshrrev_b32 v182, 16, v182
    v_mad_u32_u24 v182, v182, s68, v183
    v_lshl_add_u32 v166, v182, 10, v184
    v_add_u32 v183, 1, v183
    v_mul_u32_u24 v182, 21846, v183
    v_lshrrev_b32 v182, 16, v182
    v_mad_u32_u24 v182, v182, s68, v183
    v_lshl_add_u32 v167, v182, 10, v184
    s_mul_i32 s48, s65, 12
    s_sub_u32 s48, s64, s48
    s_lshl_b32 s48, s48, 4
    s_lshl3_add_u32 s48, s69, s48
    v_lshl_add_u32 v183, v180, 1, s48
    s_lshr_b32 s48, s65, 2
    s_mul_i32 s48, s48, 3072
    s_and_b32 s67, s65, 3
    s_lshl_b32 s67, s67, 8
    s_add_u32 s48, s48, s67
    s_add_u32 s48, s48, 10485760
    v_add_u32 v184, s48, v181
    v_mul_u32_u24 v182, 21846, v183
    v_lshrrev_b32 v182, 16, v182
    v_mad_u32_u24 v182, v182, s68, v183
    v_lshl_add_u32 v168, v182, 10, v184
    v_add_u32 v183, 1, v183
    v_mul_u32_u24 v182, 21846, v183
    v_lshrrev_b32 v182, 16, v182
    v_mad_u32_u24 v182, v182, s68, v183
    v_lshl_add_u32 v169, v182, 10, v184
    v_add_u32 v183, 7, v183
    s_sub_u32 s50, s2, 160
    v_lshlrev_b32 v252, 4, v1
    s_lshr_b32 s55, s50, 1
    s_and_b32 s56, s50, 1
    s_mul_i32 s48, s55, 40960
    s_mul_i32 s49, s56, 640
    s_add_u32 s48, s48, s49
    s_mul_i32 s49, s36, 10240
    s_add_u32 s48, s48, s49
    s_lshl2_add_u32 s56, s56, s36
    s_mul_i32 s56, s56, 48
    s_add_u32 s55, s55, s56
    s_mul_i32 s56, s36, 5120
    v_add_u32 v20, 0, v1
    v_mul_u32_u24 v21, 1639, v20
    v_lshrrev_b32 v21, 16, v21
    v_mul_u32_u24 v21, 640, v21
    v_lshl_add_u32 v21, v20, 4, v21
    v_add_u32 v24, s48, v21
    v_add_u32 v20, 64, v1
    v_mul_u32_u24 v21, 1639, v20
    v_lshrrev_b32 v21, 16, v21
    v_mul_u32_u24 v21, 640, v21
    v_lshl_add_u32 v21, v20, 4, v21
    v_add_u32 v25, s48, v21
    v_add_u32 v20, 128, v1
    v_mul_u32_u24 v21, 1639, v20
    v_lshrrev_b32 v21, 16, v21
    v_mul_u32_u24 v21, 640, v21
    v_lshl_add_u32 v21, v20, 4, v21
    v_add_u32 v26, s48, v21
    v_add_u32 v20, 192, v1
    v_mul_u32_u24 v21, 1639, v20
    v_lshrrev_b32 v21, 16, v21
    v_mul_u32_u24 v21, 640, v21
    v_lshl_add_u32 v21, v20, 4, v21
    v_add_u32 v27, s48, v21
    v_add_u32 v20, 256, v1
    v_mul_u32_u24 v21, 1639, v20
    v_lshrrev_b32 v21, 16, v21
    v_mul_u32_u24 v21, 640, v21
    v_lshl_add_u32 v21, v20, 4, v21
    v_add_u32 v28, s48, v21
    v_bfe_u32 v20, v1, 2, 2
    v_bfe_u32 v21, v1, 4, 1
    v_lshl_add_u32 v20, v20, 1, v21
    v_lshrrev_b32 v21, 5, v1
    v_lshl_add_u32 v20, v21, 4, v20
    v_mul_u32_u24 v20, 640, v20
    v_and_b32 v21, 3, v1
    v_lshl_add_u32 v20, v21, 3, v20
    s_mul_i32 s48, s36, 160
    v_add_u32 v20, s48, v20
    v_perm_b32 v52, v201, v200, s72
    v_perm_b32 v53, v203, v202, s72
    v_perm_b32 v54, v205, v204, s72
    v_perm_b32 v55, v207, v206, s72
    v_perm_b32 v56, v201, v200, s73
    v_perm_b32 v57, v203, v202, s73
    v_perm_b32 v58, v205, v204, s73
    v_perm_b32 v59, v207, v206, s73
    v_perm_b32 v60, v209, v208, s72
    v_perm_b32 v61, v211, v210, s72
    v_perm_b32 v62, v213, v212, s72
    v_perm_b32 v63, v215, v214, s72
    v_perm_b32 v64, v209, v208, s73
    v_perm_b32 v65, v211, v210, s73
    v_perm_b32 v66, v213, v212, s73
    v_perm_b32 v67, v215, v214, s73
    global_store_dwordx4 v160, v[52:55], s[34:35] sc1
    global_store_dwordx4 v161, v[56:59], s[34:35] sc1
    global_store_dwordx4 v162, v[60:63], s[34:35] sc1
    global_store_dwordx4 v163, v[64:67], s[34:35] sc1
    s_waitcnt vmcnt(18)
    v_perm_b32 v68, v217, v216, s72
    s_waitcnt vmcnt(14)
    v_perm_b32 v69, v219, v218, s72
    s_waitcnt vmcnt(10)
    v_perm_b32 v70, v221, v220, s72
    s_waitcnt vmcnt(6)
    v_perm_b32 v71, v223, v222, s72
    v_perm_b32 v72, v217, v216, s73
    v_perm_b32 v73, v219, v218, s73
    v_perm_b32 v74, v221, v220, s73
    v_perm_b32 v75, v223, v222, s73
    v_perm_b32 v76, v225, v224, s72
    v_perm_b32 v77, v227, v226, s72
    v_perm_b32 v78, v229, v228, s72
    s_waitcnt vmcnt(5)
    v_perm_b32 v79, v231, v230, s72
    v_perm_b32 v80, v225, v224, s73
    v_perm_b32 v81, v227, v226, s73
    v_perm_b32 v82, v229, v228, s73
    v_perm_b32 v83, v231, v230, s73
    global_store_dwordx4 v164, v[68:71], s[34:35] sc1
    global_store_dwordx4 v165, v[72:75], s[34:35] sc1
    global_store_dwordx4 v166, v[76:79], s[34:35] sc1
    global_store_dwordx4 v167, v[80:83], s[34:35] sc1
    s_waitcnt vmcnt(0)
    s_barrier
    s_mov_b32 s48, 4521984
    buffer_store_dwordx2 v[178:179], v177, s[40:43], s48 offen sc1
    s_mov_b32 s49, 0
    s_mul_i32 s48, s65, 21504
    s_lshl_b32 s67, s64, 8
    s_add_u32 s48, s48, s67
    s_add_u32 s48, s48, 3072
    s_lshl_b32 s67, s69, 7
    s_add_u32 s48, s48, s67
    v_lshl_add_u64 v[190:191], v[198:199], 0, s[48:49]
    s_add_u32 s48, s48, 9216
    v_lshl_add_u64 v[192:193], v[198:199], 0, s[48:49]
    s_add_u32 s48, s48, 9216
    v_lshl_add_u64 v[194:195], v[198:199], 0, s[48:49]
    global_load_dword v232, v[190:191], off offset:-3072
    global_load_dword v233, v[190:191], off offset:0
    global_load_dword v234, v[190:191], off offset:3072
    global_load_dword v235, v[192:193], off offset:-3072
    global_load_dword v236, v[192:193], off offset:0
    global_load_dword v237, v[192:193], off offset:3072
    global_load_dword v238, v[194:195], off offset:-3072
    global_load_dword v239, v[194:195], off offset:0
    s_add_u32 m0, s56, 0
    s_nop 0
    global_load_lds_dwordx4 v24, s[28:29]
    s_add_u32 m0, s56, 1024
    s_nop 0
    global_load_lds_dwordx4 v25, s[28:29]
    s_add_u32 m0, s56, 2048
    s_nop 0
    global_load_lds_dwordx4 v26, s[28:29]
    s_add_u32 m0, s56, 3072
    s_nop 0
    global_load_lds_dwordx4 v27, s[28:29]
    s_add_u32 m0, s56, 4096
    s_nop 0
    global_load_lds_dwordx4 v28, s[28:29]
    s_and_b32 s62, s37, 1
    s_lshl_b32 s62, s62, 3
    s_lshr_b32 s67, s38, 2
    s_add_u32 s62, s62, s67
    s_lshr_b32 s63, s37, 1
    s_and_b32 s67, s38, 3
    s_lshl2_add_u32 s63, s63, s67
    s_lshl2_add_u32 s60, s63, s36
    s_mul_i32 s60, s60, 61440
    s_add_u32 s60, s60, 10489856
    s_add_u32 s39, s36, 0
    s_and_b32 s39, s39, 3
    s_add_u32 s67, s39, 0
    s_and_b32 s67, s67, 3
    s_mul_i32 s67, s67, 15360
    s_add_u32 s67, s67, s60
    s_add_u32 s4, s34, s67
    s_addc_u32 s5, s35, 0
    s_add_u32 s6, s4, 8192
    s_addc_u32 s7, s5, 0
    s_add_u32 s67, s39, 1
    s_and_b32 s67, s67, 3
    s_mul_i32 s67, s67, 15360
    s_add_u32 s67, s67, s60
    s_add_u32 s8, s34, s67
    s_addc_u32 s9, s35, 0
    s_add_u32 s10, s8, 8192
    s_addc_u32 s11, s9, 0
    s_add_u32 s67, s39, 2
    s_and_b32 s67, s67, 3
    s_mul_i32 s67, s67, 15360
    s_add_u32 s67, s67, s60
    s_add_u32 s12, s34, s67
    s_addc_u32 s13, s35, 0
    s_add_u32 s14, s12, 8192
    s_addc_u32 s15, s13, 0
    s_add_u32 s67, s39, 3
    s_and_b32 s67, s67, 3
    s_mul_i32 s67, s67, 15360
    s_add_u32 s67, s67, s60
    s_add_u32 s16, s34, s67
    s_addc_u32 s17, s35, 0
    s_add_u32 s18, s16, 8192
    s_addc_u32 s19, s17, 0
    s_lshl_b32 s48, s37, 15
    s_mul_i32 s49, s36, 1536
    s_add_u32 s48, s48, s49
    s_add_u32 s48, s48, 4532224
    v_min_u32 v180, 23, v1
    v_lshl_add_u32 v180, v180, 6, s48
    s_mul_i32 s64, s55, 5120
    s_add_u32 s64, s64, 14680064
    s_add_u32 s65, s64, 4096
    s_lshl_b32 s48, s50, 7
    s_add_u32 s48, s48, 5111808
    v_mov_b32 v197, s48
    v_mov_b32 v198, 0x40000000
    s_waitcnt vmcnt(0)
    buffer_load_dwordx2 v[192:193], v180, s[40:43], 0 offen sc1
    s_barrier
    ds_read_b64_tr_b16 v[32:33], v20 offset:0
    ds_read_b64_tr_b16 v[34:35], v20 offset:5120
    ds_read_b64_tr_b16 v[36:37], v20 offset:32
    ds_read_b64_tr_b16 v[38:39], v20 offset:5152
    ds_read_b64_tr_b16 v[40:41], v20 offset:64
    ds_read_b64_tr_b16 v[42:43], v20 offset:5184
    ds_read_b64_tr_b16 v[44:45], v20 offset:96
    ds_read_b64_tr_b16 v[46:47], v20 offset:5216
    ds_read_b64_tr_b16 v[48:49], v20 offset:128
    ds_read_b64_tr_b16 v[50:51], v20 offset:5248
    v_perm_b32 v84, v233, v232, s72
    v_perm_b32 v85, v235, v234, s72
    v_perm_b32 v86, v237, v236, s72
    v_perm_b32 v87, v239, v238, s72
    v_perm_b32 v88, v233, v232, s73
    v_perm_b32 v89, v235, v234, s73
    v_perm_b32 v90, v237, v236, s73
    v_perm_b32 v91, v239, v238, s73
    global_store_dwordx4 v168, v[84:87], s[34:35] sc1
    global_store_dwordx4 v169, v[88:91], s[34:35] sc1
    s_waitcnt lgkmcnt(8)
    buffer_store_dwordx4 v[32:35], v252, s[40:43], s64 offen offset:0 sc1
    s_waitcnt lgkmcnt(6)
    buffer_store_dwordx4 v[36:39], v252, s[40:43], s64 offen offset:1024 sc1
    s_waitcnt lgkmcnt(4)
    buffer_store_dwordx4 v[40:43], v252, s[40:43], s64 offen offset:2048 sc1
    s_waitcnt lgkmcnt(2)
    buffer_store_dwordx4 v[44:47], v252, s[40:43], s64 offen offset:3072 sc1
    s_waitcnt lgkmcnt(0)
    buffer_store_dwordx4 v[48:51], v252, s[40:43], s65 offen offset:0 sc1
    s_mov_b64 exec, 0
    s_mov_b32 s1, 1
    s_cmp_eq_u32 s36, 0
    s_cbranch_scc1 L_padB_0
    s_cmp_eq_u32 s36, 1
    s_cbranch_scc1 L_padB_1
    s_cmp_eq_u32 s36, 2
    s_cbranch_scc1 L_padB_2
    s_branch L_padB_3
L_walkedB_1:
    s_mov_b64 exec, -1
    s_waitcnt vmcnt(7)
    v_cmp_ne_u64 vcc, s[44:45], v[192:193]
    s_nop 1
    s_cbranch_vccnz L_retry_7
L_seen_8:
    s_barrier
    global_load_dwordx4 a[0:3], v252, s[4:5] offset:-4096 sc1
    s_mul_i32 s57, s62, 40960
    s_mul_i32 s58, s39, 10240
    s_add_u32 s57, s57, s58
    s_add_u32 s57, s57, 7340032
    s_mul_i32 s58, s58, 3
    v_add_u32 v117, s57, v252
    s_lshl_b32 s46, s37, 15
    s_mul_i32 s47, s39, 2560
    s_add_u32 s47, s47, s46
    global_load_dwordx4 a[4:7], v252, s[4:5] offset:-3072 sc1
    s_add_u32 s47, s47, 4849664
    v_min_u32 v127, 39, v1
    v_lshl_add_u32 v127, v127, 6, s47
    s_mul_i32 s47, s36, 1536
    s_add_u32 s47, s47, s46
    s_add_u32 s47, s47, 4857344
    v_cmp_lt_u32 s[28:29], 39, v1
    v_lshl_add_u32 v0, v1, 6, s47
    s_nop 0
    v_cndmask_b32 v0, v127, v0, s[28:29]
    global_load_dwordx4 a[8:11], v252, s[4:5] offset:-2048 sc1
    v_mov_b32 v94, 0x3f803f80
    v_mov_b32 v95, 0x3f803f80
    v_mov_b32 v96, 0x3f803f80
    v_mov_b32 v97, 0x3f803f80
    s_add_u32 s22, s34, 4096
    s_addc_u32 s23, s35, 0
    s_add_u32 s24, s34, 8192
    s_addc_u32 s25, s35, 0
    s_add_u32 s26, s34, 12288
    s_addc_u32 s27, s35, 0
    s_mov_b64 s[20:21], s[34:35]
    s_and_b32 s68, s63, 7
    global_load_dwordx4 a[12:15], v252, s[4:5] offset:-1024 sc1
    s_lshr_b32 s72, s63, 3
    v_mov_b32 v118, s44
    v_mov_b32 v119, s45
    v_and_b32 v106, 15, v1
    v_lshrrev_b32 v107, 4, v1
    v_bfe_u32 v108, v1, 2, 2
    v_and_b32 v109, 3, v1
    v_lshlrev_b32 v110, 9, v107
    v_lshl_add_u32 v110, v108, 6, v110
    global_load_dwordx4 a[16:19], v252, s[4:5] offset:0 sc1
    v_lshl_add_u32 v110, v109, 3, v110
    v_and_b32 v111, 1, v107
    v_lshl_add_u32 v110, v111, 5, v110
    s_add_u32 s47, s39, 0
    s_and_b32 s47, s47, 3
    s_mul_i32 s47, s47, 30720
    v_add_u32 v2, s47, v110
    v_xor_b32 v6, 32, v2
    s_add_u32 s47, s39, 1
    global_load_dwordx4 a[20:23], v252, s[4:5] offset:1024 sc1
    s_and_b32 s47, s47, 3
    s_mul_i32 s47, s47, 30720
    v_add_u32 v3, s47, v110
    v_xor_b32 v7, 32, v3
    s_add_u32 s47, s39, 2
    s_and_b32 s47, s47, 3
    s_mul_i32 s47, s47, 30720
    v_add_u32 v4, s47, v110
    v_xor_b32 v8, 32, v4
    global_load_dwordx4 a[24:27], v252, s[4:5] offset:2048 sc1
    s_add_u32 s47, s39, 3
    s_and_b32 s47, s47, 3
    s_mul_i32 s47, s47, 30720
    v_add_u32 v5, s47, v110
    v_xor_b32 v9, 32, v5
    v_mov_b32 v123, 0
    v_cmp_eq_u32 s[50:51], v107, v108
    v_cmp_gt_u32 s[52:53], 48, v1
    s_lshl_b32 s47, s36, 3
    global_load_dwordx4 a[28:31], v252, s[4:5] offset:3072 sc1
    s_add_u32 s47, s47, 122880
    v_lshl_add_u32 v125, v106, 5, s47
    v_mov_b32 v111, 123904
    v_lshl_add_u32 v111, v1, 3, v111
    v_cndmask_b32 v125, v111, v125, s[50:51]
    v_lshlrev_b32 v126, 5, v106
    v_add_u32 v126, 122880, v126
    v_mov_b32 v111, 0x40000000
    v_cmp_gt_u32 s[50:51], 16, v1
    global_load_dwordx4 a[32:35], v252, s[6:7] offset:-4096 sc1
    s_mul_i32 s56, s62, 479232
    s_add_u32 s60, s56, 16777216
    s_lshl2_add_u32 s47, s63, s36
    s_mul_i32 s56, s47, 768
    s_add_u32 s56, s56, s60
    s_mul_i32 s61, s47, -704
    s_add_u32 s61, s61, 48384
    v_add_u32 v116, s61, v252
    v_cndmask_b32 v124, v116, v252, s[52:53]
    global_load_dwordx4 a[36:39], v252, s[6:7] offset:-3072 sc1
    v_cmp_gt_u32 s[52:53], 52, v1
    s_add_u32 s61, s61, 768
    v_lshrrev_b32 v116, 3, v1
    v_mul_u32_u24 v116, 53184, v116
    v_lshl_add_u32 v116, v1, 3, v116
    v_add_u32 v116, s61, v116
    v_cndmask_b32 v124, v111, v124, s[52:53]
    v_cndmask_b32 v116, v111, v116, s[50:51]
    v_cmp_eq_u32 s[50:51], 1, v109
    global_load_dwordx4 a[40:43], v252, s[6:7] offset:-2048 sc1
    v_cmp_eq_u32 s[52:53], 2, v109
    v_cmp_eq_u32 s[54:55], 3, v109
    s_lshl2_add_u32 s59, s68, s36
    s_mul_i32 s59, s59, 61440
    s_add_u32 s59, s59, 14680064
    s_mul_i32 s47, s72, 53248
    s_add_u32 s60, s60, s47
    s_mul_i32 s47, s36, 12288
    s_add_u32 s60, s60, s47
    global_load_dwordx4 a[44:47], v252, s[6:7] offset:-1024 sc1
    s_lshr_b32 s47, s68, 1
    s_mul_i32 s47, s47, 30720
    s_and_b32 s46, s68, 1
    s_mul_i32 s46, s46, 5120
    s_add_u32 s47, s47, s46
    v_lshl_add_u32 v112, v107, 2, v108
    v_lshlrev_b32 v112, 6, v112
    v_lshl_add_u32 v112, v109, 3, v112
    v_lshrrev_b32 v113, 1, v107
    global_load_dwordx4 a[60:63], v252, s[8:9] offset:-4096 sc1
    v_xor_b32 v113, s72, v113
    v_lshl_add_u32 v112, v113, 5, v112
    v_add_u32 v112, s47, v112
    v_mul_u32_u24 v113, 176, v106
    v_lshl_add_u32 v113, v107, 3, v113
    v_add_u32 v113, 124928, v113
    s_mul_i32 s33, s36, 6144
    s_add_u32 s33, s33, 139264
    s_mov_b32 s32, 0x3acccccd
    global_load_dwordx4 a[64:67], v252, s[8:9] offset:-3072 sc1
    v_mov_b32 v114, 0x3727c5ac
    s_waitcnt vmcnt(14)
    s_barrier
    s_mov_b32 s48, 4849664
    buffer_store_dwordx2 v[178:179], v177, s[40:43], s48 offen sc1
    global_load_dwordx4 a[68:71], v252, s[8:9] offset:-2048 sc1
    s_waitcnt vmcnt(15)
    v_mfma_f32_16x16x32_bf16 v[82:85], a[0:3], v[94:97], 0
    global_load_dwordx4 a[72:75], v252, s[8:9] offset:-1024 sc1
    s_waitcnt vmcnt(15)
    v_mfma_f32_16x16x32_bf16 v[86:89], a[4:7], v[94:97], 0
    global_load_dwordx4 a[76:79], v252, s[8:9] offset:0 sc1
    s_waitcnt vmcnt(15)
    v_mfma_f32_16x16x32_bf16 v[90:93], a[8:11], v[94:97], 0
    global_load_dwordx4 a[80:83], v252, s[8:9] offset:1024 sc1
    s_waitcnt vmcnt(15)
    v_mfma_f32_16x16x32_bf16 v[82:85], a[12:15], v[94:97], v[82:85]
    global_load_dwordx4 a[84:87], v252, s[8:9] offset:2048 sc1
    s_waitcnt vmcnt(15)
    v_mfma_f32_16x16x32_bf16 v[86:89], a[16:19], v[94:97], v[86:89]
    global_load_dwordx4 a[88:91], v252, s[8:9] offset:3072 sc1
    s_waitcnt vmcnt(15)
    v_mfma_f32_16x16x32_bf16 v[90:93], a[20:23], v[94:97], v[90:93]
    global_load_dwordx4 a[92:95], v252, s[10:11] offset:-4096 sc1
    s_waitcnt vmcnt(15)
    v_mfma_f32_16x16x32_bf16 v[82:85], a[24:27], v[94:97], v[82:85]
    global_load_dwordx4 a[96:99], v252, s[10:11] offset:-3072 sc1
    s_waitcnt vmcnt(15)
    v_mfma_f32_16x16x32_bf16 v[86:89], a[28:31], v[94:97], v[86:89]
    global_load_dwordx4 a[100:103], v252, s[10:11] offset:-2048 sc1
    s_waitcnt vmcnt(15)
    v_mfma_f32_16x16x32_bf16 v[90:93], a[32:35], v[94:97], v[90:93]
    global_load_dwordx4 a[104:107], v252, s[10:11] offset:-1024 sc1
    s_waitcnt vmcnt(15)
    v_mfma_f32_16x16x32_bf16 v[82:85], a[36:39], v[94:97], v[82:85]
    global_load_dwordx4 a[120:123], v252, s[12:13] offset:-4096 sc1
    s_waitcnt vmcnt(15)
    v_mfma_f32_16x16x32_bf16 v[86:89], a[40:43], v[94:97], v[86:89]
    global_load_dwordx4 a[124:127], v252, s[12:13] offset:-3072 sc1
    s_waitcnt vmcnt(15)
    v_mfma_f32_16x16x32_bf16 v[90:93], a[44:47], v[94:97], v[90:93]
    global_load_dwordx4 a[128:131], v252, s[12:13] offset:-2048 sc1
    s_waitcnt vmcnt(15)
    v_mfma_f32_16x16x32_bf16 v[82:85], a[60:63], v[94:97], v[82:85]
    global_load_dwordx4 a[132:135], v252, s[12:13] offset:-1024 sc1
    s_waitcnt vmcnt(15)
    v_mfma_f32_16x16x32_bf16 v[86:89], a[64:67], v[94:97], v[86:89]
    global_load_dwordx4 a[136:139], v252, s[12:13] offset:0 sc1
    s_waitcnt vmcnt(14)
    v_mfma_f32_16x16x32_bf16 v[90:93], a[68:71], v[94:97], v[90:93]
    global_load_dwordx4 a[140:143], v252, s[12:13] offset:1024 sc1
    s_waitcnt vmcnt(14)
    v_mfma_f32_16x16x32_bf16 v[82:85], a[72:75], v[94:97], v[82:85]
    global_load_dwordx4 a[144:147], v252, s[12:13] offset:2048 sc1
    s_waitcnt vmcnt(14)
    v_mfma_f32_16x16x32_bf16 v[86:89], a[76:79], v[94:97], v[86:89]
    global_load_dwordx4 a[148:151], v252, s[12:13] offset:3072 sc1
    s_waitcnt vmcnt(14)
    v_mfma_f32_16x16x32_bf16 v[90:93], a[80:83], v[94:97], v[90:93]
    global_load_dwordx4 a[152:155], v252, s[14:15] offset:-4096 sc1
    s_waitcnt vmcnt(14)
    v_mfma_f32_16x16x32_bf16 v[82:85], a[84:87], v[94:97], v[82:85]
    global_load_dwordx4 a[156:159], v252, s[14:15] offset:-3072 sc1
    s_waitcnt vmcnt(14)
    v_mfma_f32_16x16x32_bf16 v[86:89], a[88:91], v[94:97], v[86:89]
    global_load_dwordx4 a[160:163], v252, s[14:15] offset:-2048 sc1
    s_waitcnt vmcnt(14)
    v_mfma_f32_16x16x32_bf16 v[90:93], a[92:95], v[94:97], v[90:93]
    global_load_dwordx4 a[164:167], v252, s[14:15] offset:-1024 sc1
    s_waitcnt vmcnt(14)
    v_mfma_f32_16x16x32_bf16 v[82:85], a[96:99], v[94:97], v[82:85]
    global_load_dwordx4 a[180:183], v252, s[16:17] offset:-4096 sc1
    s_waitcnt vmcnt(14)
    v_mfma_f32_16x16x32_bf16 v[86:89], a[100:103], v[94:97], v[86:89]
    global_load_dwordx4 a[184:187], v252, s[16:17] offset:-3072 sc1
    s_waitcnt vmcnt(14)
    v_mfma_f32_16x16x32_bf16 v[90:93], a[104:107], v[94:97], v[90:93]
    global_load_dwordx4 a[188:191], v252, s[16:17] offset:-2048 sc1
    s_waitcnt vmcnt(14)
    v_mfma_f32_16x16x32_bf16 v[82:85], a[120:123], v[94:97], v[82:85]
    global_load_dwordx4 a[192:195], v252, s[16:17] offset:-1024 sc1
    s_waitcnt vmcnt(14)
    v_mfma_f32_16x16x32_bf16 v[86:89], a[124:127], v[94:97], v[86:89]
    global_load_dwordx4 a[196:199], v252, s[16:17] offset:0 sc1
    s_waitcnt vmcnt(14)
    v_mfma_f32_16x16x32_bf16 v[90:93], a[128:131], v[94:97], v[90:93]
    global_load_dwordx4 a[200:203], v252, s[16:17] offset:1024 sc1
    s_waitcnt vmcnt(14)
    v_mfma_f32_16x16x32_bf16 v[82:85], a[132:135], v[94:97], v[82:85]
    global_load_dwordx4 a[204:207], v252, s[16:17] offset:2048 sc1
    s_waitcnt vmcnt(14)
    v_mfma_f32_16x16x32_bf16 v[86:89], a[136:139], v[94:97], v[86:89]
    global_load_dwordx4 a[208:211], v252, s[16:17] offset:3072 sc1
    s_waitcnt vmcnt(14)
    v_mfma_f32_16x16x32_bf16 v[90:93], a[140:143], v[94:97], v[90:93]
    global_load_dwordx4 a[212:215], v252, s[18:19] offset:-4096 sc1
    s_waitcnt vmcnt(14)
    v_mfma_f32_16x16x32_bf16 v[82:85], a[144:147], v[94:97], v[82:85]
    global_load_dwordx4 a[216:219], v252, s[18:19] offset:-3072 sc1
    s_waitcnt vmcnt(14)
    v_mfma_f32_16x16x32_bf16 v[86:89], a[148:151], v[94:97], v[86:89]
    global_load_dwordx4 a[220:223], v252, s[18:19] offset:-2048 sc1
    s_waitcnt vmcnt(14)
    v_mfma_f32_16x16x32_bf16 v[90:93], a[152:155], v[94:97], v[90:93]
    global_load_dwordx4 a[224:227], v252, s[18:19] offset:-1024 sc1
    buffer_load_dwordx2 v[254:255], v0, s[40:43], 0 offen sc1
    s_waitcnt vmcnt(15)
    v_mfma_f32_16x16x32_bf16 v[82:85], a[156:159], v[94:97], v[82:85]
    s_waitcnt vmcnt(14)
    v_mfma_f32_16x16x32_bf16 v[86:89], a[160:163], v[94:97], v[86:89]
    s_waitcnt vmcnt(13)
    v_mfma_f32_16x16x32_bf16 v[90:93], a[164:167], v[94:97], v[90:93]
    s_waitcnt vmcnt(12)
    v_mfma_f32_16x16x32_bf16 v[82:85], a[180:183], v[94:97], v[82:85]
    s_waitcnt vmcnt(11)
    v_mfma_f32_16x16x32_bf16 v[86:89], a[184:187], v[94:97], v[86:89]
    s_waitcnt vmcnt(10)
    v_mfma_f32_16x16x32_bf16 v[90:93], a[188:191], v[94:97], v[90:93]
    s_waitcnt vmcnt(9)
    v_mfma_f32_16x16x32_bf16 v[82:85], a[192:195], v[94:97], v[82:85]
    s_waitcnt vmcnt(8)
    v_mfma_f32_16x16x32_bf16 v[86:89], a[196:199], v[94:97], v[86:89]
    s_waitcnt vmcnt(7)
    v_mfma_f32_16x16x32_bf16 v[90:93], a[200:203], v[94:97], v[90:93]
    s_waitcnt vmcnt(6)
    v_mfma_f32_16x16x32_bf16 v[82:85], a[204:207], v[94:97], v[82:85]
    s_waitcnt vmcnt(5)
    v_mfma_f32_16x16x32_bf16 v[86:89], a[208:211], v[94:97], v[86:89]
    s_waitcnt vmcnt(4)
    v_mfma_f32_16x16x32_bf16 v[90:93], a[212:215], v[94:97], v[90:93]
    s_waitcnt vmcnt(3)
    v_mfma_f32_16x16x32_bf16 v[82:85], a[216:219], v[94:97], v[82:85]
    s_waitcnt vmcnt(2)
    v_mfma_f32_16x16x32_bf16 v[86:89], a[220:223], v[94:97], v[86:89]
    s_waitcnt vmcnt(1)
    v_mfma_f32_16x16x32_bf16 v[90:93], a[224:227], v[94:97], v[90:93]
    s_waitcnt vmcnt(0)
    v_cmp_ne_u64 vcc, s[44:45], v[254:255]
    s_nop 1
    s_cbranch_vccnz L_retry_9
L_seen_10:
    s_barrier
    s_add_u32 m0, s58, 0
    s_nop 0
    global_load_lds_dwordx4 v117, s[20:21] offset:0 sc1
    global_load_lds_dwordx4 v117, s[20:21] offset:1024 sc1
    global_load_lds_dwordx4 v117, s[20:21] offset:2048 sc1
    global_load_lds_dwordx4 v117, s[20:21] offset:3072 sc1
    s_add_u32 m0, s58, 4096
    s_nop 0
    global_load_lds_dwordx4 v117, s[22:23] offset:0 sc1
    global_load_lds_dwordx4 v117, s[22:23] offset:1024 sc1
    global_load_lds_dwordx4 v117, s[22:23] offset:2048 sc1
    global_load_lds_dwordx4 v117, s[22:23] offset:3072 sc1
    s_add_u32 m0, s58, 8192
    s_nop 0
    global_load_lds_dwordx4 v117, s[24:25] offset:0 sc1
    global_load_lds_dwordx4 v117, s[24:25] offset:1024 sc1
    v_add_u32 v117, 655360, v117
    s_branch L_join
L_retry_1:
    s_mov_b32 s49, 0
L_retry_1_l:
    s_mov_b64 exec, vcc
    s_sleep 2
    buffer_load_dwordx2 v[18:19], v211, s[40:43], 0 offen sc1
    s_add_u32 s49, s49, 1
    s_waitcnt vmcnt(0)
    v_cmp_ne_u64 vcc, s[44:45], v[18:19]
    s_mov_b64 exec, -1
    s_cmp_ge_u32 s49, 20000
    s_cbranch_scc1 L_seen_2
    s_nop 1
    s_cbranch_vccnz L_retry_1_l

    s_branch L_seen_2
L_retry_3:
    s_mov_b32 s49, 0
L_retry_3_l:
    s_mov_b64 exec, vcc
    s_sleep 2
    buffer_load_dwordx2 v[234:235], v211, s[40:43], s70 offen sc1
    s_add_u32 s49, s49, 1
    s_waitcnt vmcnt(0)
    v_cmp_ne_u64 vcc, s[44:45], v[234:235]
    s_mov_b64 exec, -1
    s_cmp_ge_u32 s49, 20000
    s_cbranch_scc1 L_seen_4
    s_nop 1
    s_cbranch_vccnz L_retry_3_l

    s_branch L_seen_4
L_retry_5:
    s_mov_b32 s49, 0
L_retry_5_l:
    s_mov_b64 exec, vcc
    s_sleep 2
    buffer_load_dwordx2 v[254:255], v0, s[40:43], 0 offen sc1
    s_add_u32 s49, s49, 1
    s_waitcnt vmcnt(0)
    v_cmp_ne_u64 vcc, s[44:45], v[254:255]
    s_mov_b64 exec, -1
    s_cmp_ge_u32 s49, 20000
    s_cbranch_scc1 L_seen_6
    s_nop 1
    s_cbranch_vccnz L_retry_5_l

    s_branch L_seen_6
L_retry_7:
    s_mov_b32 s49, 0
L_retry_7_l:
    s_mov_b64 exec, vcc
    s_sleep 4
    buffer_load_dwordx2 v[192:193], v180, s[40:43], 0 offen sc1
    s_add_u32 s49, s49, 1
    s_waitcnt vmcnt(0)
    v_cmp_ne_u64 vcc, s[44:45], v[192:193]
    s_mov_b64 exec, -1
    s_cmp_ge_u32 s49, 20000
    s_cbranch_scc1 L_seen_8
    s_nop 1
    s_cbranch_vccnz L_retry_7_l

    s_branch L_seen_8
L_retry_9:
    s_mov_b32 s49, 0
L_retry_9_l:
    s_mov_b64 exec, vcc
    s_sleep 2
    buffer_load_dwordx2 v[254:255], v0, s[40:43], 0 offen sc1
    s_add_u32 s49, s49, 1
    s_waitcnt vmcnt(0)
    v_cmp_ne_u64 vcc, s[44:45], v[254:255]
    s_mov_b64 exec, -1
    s_cmp_ge_u32 s49, 20000
    s_cbranch_scc1 L_seen_10
    s_nop 1
    s_cbranch_vccnz L_retry_9_l

    s_branch L_seen_10
L_retry_11:
    s_mov_b32 s49, 0
L_retry_11_l:
    s_mov_b64 exec, vcc
    s_sleep 2
    buffer_load_dwordx2 v[254:255], v127, s[40:43], s73 offen sc1
    s_add_u32 s49, s49, 1
    s_waitcnt vmcnt(0)
    v_cmp_ne_u64 vcc, s[44:45], v[254:255]
    s_mov_b64 exec, -1
    s_cmp_ge_u32 s49, 20000
    s_cbranch_scc1 L_seen_12
    s_nop 1
    s_cbranch_vccnz L_retry_11_l

    s_branch L_seen_12
L_retry_13:
    s_mov_b32 s49, 0
L_retry_13_l:
    s_mov_b64 exec, vcc
    s_sleep 2
    buffer_load_dwordx2 v[254:255], v127, s[40:43], s73 offen sc1
    s_add_u32 s49, s49, 1
    s_waitcnt vmcnt(0)
    v_cmp_ne_u64 vcc, s[44:45], v[254:255]
    s_mov_b64 exec, -1
    s_cmp_ge_u32 s49, 20000
    s_cbranch_scc1 L_seen_14
    s_nop 1
    s_cbranch_vccnz L_retry_13_l

    s_branch L_seen_14
L_retry_15:
    s_mov_b32 s49, 0
L_retry_15_l:
    s_mov_b64 exec, vcc
    s_sleep 2
    buffer_load_dwordx2 v[254:255], v127, s[40:43], s73 offen sc1
    s_add_u32 s49, s49, 1
    s_waitcnt vmcnt(0)
    v_cmp_ne_u64 vcc, s[44:45], v[254:255]
    s_mov_b64 exec, -1
    s_cmp_ge_u32 s49, 20000
    s_cbranch_scc1 L_seen_16
    s_nop 1
    s_cbranch_vccnz L_retry_15_l

    s_branch L_seen_16
L_retry_17:
    s_mov_b32 s49, 0
L_retry_17_l:
    s_mov_b64 exec, vcc
    s_sleep 2
    buffer_load_dwordx2 v[254:255], v127, s[40:43], s73 offen sc1
    s_add_u32 s49, s49, 1
    s_waitcnt vmcnt(0)
    v_cmp_ne_u64 vcc, s[44:45], v[254:255]
    s_mov_b64 exec, -1
    s_cmp_ge_u32 s49, 20000
    s_cbranch_scc1 L_seen_18
    s_nop 1
    s_cbranch_vccnz L_retry_17_l

    s_branch L_seen_18
L_retry_19:
    s_mov_b32 s49, 0
L_retry_19_l:
    s_mov_b64 exec, vcc
    s_sleep 2
    buffer_load_dwordx2 v[254:255], v127, s[40:43], s73 offen sc1
    s_add_u32 s49, s49, 1
    s_waitcnt vmcnt(0)
    v_cmp_ne_u64 vcc, s[44:45], v[254:255]
    s_mov_b64 exec, -1
    s_cmp_ge_u32 s49, 20000
    s_cbranch_scc1 L_seen_20
    s_nop 1
    s_cbranch_vccnz L_retry_19_l

    s_branch L_seen_20
L_retry_21:
    s_mov_b32 s49, 0
L_retry_21_l:
    s_mov_b64 exec, vcc
    s_sleep 2
    buffer_load_dwordx2 v[254:255], v127, s[40:43], s73 offen sc1
    s_add_u32 s49, s49, 1
    s_waitcnt vmcnt(0)
    v_cmp_ne_u64 vcc, s[44:45], v[254:255]
    s_mov_b64 exec, -1
    s_cmp_ge_u32 s49, 20000
    s_cbranch_scc1 L_seen_22
    s_nop 1
    s_cbranch_vccnz L_retry_21_l

    s_branch L_seen_22
.p2align 7
L_table:
.long 2048,1904,1632,1360,2320,2048,1904,1632,2592,2320,2048,1904,2864,2592,2320,2048
.long 3136,2864,2592,2320,3408,3136,2864,2592,3680,3408,3136,2864,3952,3680,3408,3136
.long 4096,3952,3680,3408,4368,4096,3952,3680,4640,4368,4096,3952,4912,4640,4368,4096
.long 5184,4912,4640,4368,5456,5184,4912,4640,5728,5456,5184,4912,6000,5728,5456,5184
.long 2176,2032,1760,1488,2448,2176,2032,1760,2720,2448,2176,2032,2992,2720,2448,2176
.long 3264,2992,2720,2448,3536,3264,2992,2720,3808,3536,3264,2992,4080,3808,3536,3264
.long 4224,4080,3808,3536,4496,4224,4080,3808,4768,4496,4224,4080,5040,4768,4496,4224
.long 5312,5040,4768,4496,5584,5312,5040,4768,5856,5584,5312,5040,6128,5856,5584,5312
.long 2112,1840,1568,1296,2384,2112,1840,1568,2656,2384,2112,1840,2928,2656,2384,2112
.long 3072,2928,2656,2384,3344,3072,2928,2656,3616,3344,3072,2928,3888,3616,3344,3072
.long 4160,3888,3616,3344,4432,4160,3888,3616,4704,4432,4160,3888,4976,4704,4432,4160
.long 5120,4976,4704,4432,5392,5120,4976,4704,5664,5392,5120,4976,5936,5664,5392,5120
.long 2240,1968,1696,1424,2512,2240,1968,1696,2784,2512,2240,1968,3056,2784,2512,2240
.long 3200,3056,2784,2512,3472,3200,3056,2784,3744,3472,3200,3056,4016,3744,3472,3200
.long 4288,4016,3744,3472,4560,4288,4016,3744,4832,4560,4288,4016,5104,4832,4560,4288
.long 5248,5104,4832,4560,5520,5248,5104,4832,5792,5520,5248,5104,6064,5792,5520,5248
.long 1088,816,544,272,1360,1088,816,544,1632,1360,1088,816,1904,1632,1360,1088
.long 2048,1904,1632,1360,2320,2048,1904,1632,2592,2320,2048,1904,2864,2592,2320,2048
.long 3136,2864,2592,2320,3408,3136,2864,2592,3680,3408,3136,2864,3952,3680,3408,3136
.long 4096,3952,3680,3408,4368,4096,3952,3680,4640,4368,4096,3952,4912,4640,4368,4096
.long 1216,944,672,400,1488,1216,944,672,1760,1488,1216,944,2032,1760,1488,1216
.long 2176,2032,1760,1488,2448,2176,2032,1760,2720,2448,2176,2032,2992,2720,2448,2176
.long 3264,2992,2720,2448,3536,3264,2992,2720,3808,3536,3264,2992,4080,3808,3536,3264
.long 4224,4080,3808,3536,4496,4224,4080,3808,4768,4496,4224,4080,5040,4768,4496,4224
.long 1024,880,608,336,1296,1024,880,608,1568,1296,1024,880,1840,1568,1296,1024
.long 2112,1840,1568,1296,2384,2112,1840,1568,2656,2384,2112,1840,2928,2656,2384,2112
.long 3072,2928,2656,2384,3344,3072,2928,2656,3616,3344,3072,2928,3888,3616,3344,3072
.long 4160,3888,3616,3344,4432,4160,3888,3616,4704,4432,4160,3888,4976,4704,4432,4160
.long 1152,1008,736,464,1424,1152,1008,736,1696,1424,1152,1008,1968,1696,1424,1152
.long 2240,1968,1696,1424,2512,2240,1968,1696,2784,2512,2240,1968,3056,2784,2512,2240
.long 3200,3056,2784,2512,3472,3200,3056,2784,3744,3472,3200,3056,4016,3744,3472,3200
.long 4288,4016,3744,3472,4560,4288,4016,3744,4832,4560,4288,4016,5104,4832,4560,4288
.long 4016,0,0x10a000,0x400000,4224,40960,0x10a010,0x400040,4288,81920,0x10a020,0x400080,4496,0x1e000,0x10a030,0x4000c0
.long 4560,0x28000,0x10a040,0x400100,4768,0x32000,0x10a050,0x400140,4832,0x3c000,0x10a060,0x400180,5040,0x46000,0x10a070,0x4001c0
.long 5104,0x50000,0x10a080,0x400200,5312,0x5a000,0x10a090,0x400240,5248,0x64000,0x10a0a0,0x400280,5584,0x6e000,0x10a0b0,0x4002c0
.long 5520,0x78000,0x10a0c0,0x400300,5856,0x82000,0x10a0d0,0x400340,5792,0x8c000,0x10a0e0,0x400380,6128,0x96000,0x10a0f0,0x4003c0
.long 4096,16,0x114100,0x400400,4160,40976,0x114110,0x400440,4368,81936,0x114120,0x400480,4432,0x1e010,0x114130,0x4004c0
.long 4640,0x28010,0x114140,0x400500,4704,0x32010,0x114150,0x400540,4912,0x3c010,0x114160,0x400580,4976,0x46010,0x114170,0x4005c0
.long 5184,0x50010,0x114180,0x400600,5120,0x5a010,0x114190,0x400640,5456,0x64010,0x1141a0,0x400680,5392,0x6e010,0x1141b0,0x4006c0
.long 5728,0x78010,0x1141c0,0x400700,5664,0x82010,0x1141d0,0x400740,6000,0x8c010,0x1141e0,0x400780,5936,0x96010,0x1141f0,0x4007c0
.long 4224,32,0x11e200,0x400800,4288,40992,0x11e210,0x400840,4496,81952,0x11e220,0x400880,4560,0x1e020,0x11e230,0x4008c0
.long 4768,0x28020,0x11e240,0x400900,4832,0x32020,0x11e250,0x400940,5040,0x3c020,0x11e260,0x400980,5104,0x46020,0x11e270,0x4009c0
.long 5312,0x50020,0x11e280,0x400a00,5248,0x5a020,0x11e290,0x400a40,5584,0x64020,0x11e2a0,0x400a80,5520,0x6e020,0x11e2b0,0x400ac0
.long 5856,0x78020,0x11e2c0,0x400b00,5792,0x82020,0x11e2d0,0x400b40,6128,0x8c020,0x11e2e0,0x400b80,6064,0x96020,0x11e2f0,0x400bc0
.long 4160,48,0x128300,0x400c00,4368,41008,0x128310,0x400c40,4432,81968,0x128320,0x400c80,4640,0x1e030,0x128330,0x400cc0
.long 4704,0x28030,0x128340,0x400d00,4912,0x32030,0x128350,0x400d40,4976,0x3c030,0x128360,0x400d80,5184,0x46030,0x128370,0x400dc0
.long 5120,0x50030,0x128380,0x400e00,5456,0x5a030,0x128390,0x400e40,5392,0x64030,0x1283a0,0x400e80,5728,0x6e030,0x1283b0,0x400ec0
.long 5664,0x78030,0x1283c0,0x400f00,6000,0x82030,0x1283d0,0x400f40,5936,0x8c030,0x1283e0,0x400f80,6144,0x96030,0x1283f0,0x400fc0
.long 2048,2064,2080,2096,2320,2304,2352,2336,2592,2608,2560,2576,2864,2848,2832,2816
.long 3136,3152,3168,3184,3408,3392,3440,3424,3680,3696,3648,3664,3952,3936,3920,3904
.long 4096,4112,4128,4144,4368,4352,4400,4384,4640,4656,4608,4624,4912,4896,4880,4864
.long 5184,5200,5216,5232,5456,5440,5488,5472,5728,5744,5696,5712,6000,5984,5968,5952
.long 2176,2192,2208,2224,2448,2432,2480,2464,2720,2736,2688,2704,2992,2976,2960,2944
.long 3264,3280,3296,3312,3536,3520,3568,3552,3808,3824,3776,3792,4080,4064,4048,4032
.long 4224,4240,4256,4272,4496,4480,4528,4512,4768,4784,4736,4752,5040,5024,5008,4992
.long 5312,5328,5344,5360,5584,5568,5616,5600,5856,5872,5824,5840,6128,6112,6096,6080
.long 2112,2128,2144,2160,2384,2368,2416,2400,2656,2672,2624,2640,2928,2912,2896,2880
.long 3072,3088,3104,3120,3344,3328,3376,3360,3616,3632,3584,3600,3888,3872,3856,3840
.long 4160,4176,4192,4208,4432,4416,4464,4448,4704,4720,4672,4688,4976,4960,4944,4928
.long 5120,5136,5152,5168,5392,5376,5424,5408,5664,5680,5632,5648,5936,5920,5904,5888
.long 2240,2256,2272,2288,2512,2496,2544,2528,2784,2800,2752,2768,3056,3040,3024,3008
.long 3200,3216,3232,3248,3472,3456,3504,3488,3744,3760,3712,3728,4016,4000,3984,3968
.long 4288,4304,4320,4336,4560,4544,4592,4576,4832,4848,4800,4816,5104,5088,5072,5056
.long 5248,5264,5280,5296,5520,5504,5552,5536,5792,5808,5760,5776,6064,6048,6032,6016
.long 36864,39368,36864,37696,36872,39376,38528,39360,36880,39384,36872,37704,36888,39392,38536,39368
.long 36896,39400,41024,41856,36904,39408,42688,40200,36912,39416,41032,41864,36920,39424,42696,40208
.long 36928,39432,38528,39360,36936,39440,36872,37704,36944,39448,38536,39368,36952,39456,36880,37712
.long 36960,39464,42688,40200,36968,39472,41032,41864,36976,39480,42696,40208,36984,39488,41040,41872
.long 36832,36880,36880,37712,36840,36888,38544,39376,36848,36896,36888,37720,36856,36904,38552,39384
.long 36864,36912,41040,41872,36872,36920,42704,40216,36880,36928,41048,41880,36888,36936,42712,40224
.long 36896,36944,38544,39376,36904,36952,36888,37720,36912,36960,38552,39384,36920,36968,36896,37728
.long 36928,36976,42704,40216,36936,36984,41048,41880,36944,36992,42712,40224,36952,37000,41056,41888
.long 36800,37712,36896,37728,36808,37720,38560,39392,36816,37728,36904,37736,36824,37736,38568,39400
.long 36832,37744,41056,41888,36840,37752,42720,40232,36848,37760,41064,41896,36856,37768,42728,40240
.long 36864,37776,38560,39392,36872,37784,36904,37736,36880,37792,38568,39400,36888,37800,36912,37744
.long 36896,37808,42720,40232,36904,37816,41064,41896,36912,37824,42728,40240,36920,37832,41072,41904
.long 36768,38544,36912,37744,36776,38552,38576,39408,36784,38560,36920,37752,36792,38568,38584,39416
.long 36800,38576,41072,41904,36808,38584,42736,40248,36816,38592,41080,41912,36824,38600,42744,40256
.long 36832,38608,38576,39408,36840,38616,36920,37752,36848,38624,38584,39416,36856,38632,36928,37760
.long 36864,38640,42736,40248,36872,38648,41080,41912,36880,38656,42744,40256,36888,38664,41088,41920
.long 43520,44352,36864,36864,45184,46016,36848,36856,43528,44360,36832,36848,45192,46024,36816,36840
.long 48576,49408,36800,36832,46920,47752,36784,36824,48584,49416,36768,36816,46928,47760,36752,36808
.long 43528,44360,36736,36800,45192,46024,36720,36792,43536,44368,36704,36784,45200,46032,36688,36776
.long 48584,49416,36672,36768,46928,47760,36656,36760,48592,49424,36640,36752,46936,47768,36624,36744
.long 43552,44384,36880,36880,45216,46048,36864,36872,43560,44392,36848,36864,45224,46056,36832,36856
.long 48608,49440,36816,36848,46952,47784,36800,36840,48616,49448,36784,36832,46960,47792,36768,36824
.long 43560,44392,36752,36816,45224,46056,36736,36808,43568,44400,36720,36800,45232,46064,36704,36792
.long 48616,49448,36688,36784,46960,47792,36672,36776,48624,49456,36656,36768,46968,47800,36640,36760
.long 43584,44416,36896,36896,45248,46080,36880,36888,43592,44424,36864,36880,45256,46088,36848,36872
.long 48640,49472,36832,36864,46984,47816,36816,36856,48648,49480,36800,36848,46992,47824,36784,36840
.long 43592,44424,36768,36832,45256,46088,36752,36824,43600,44432,36736,36816,45264,46096,36720,36808
.long 48648,49480,36704,36800,46992,47824,36688,36792,48656,49488,36672,36784,47000,47832,36656,36776
.long 43616,44448,36912,36912,45280,46112,36896,36904,43624,44456,36880,36896,45288,46120,36864,36888
.long 48672,49504,36848,36880,47016,47848,36832,36872,48680,49512,36816,36864,47024,47856,36800,36856
.long 43624,44456,36784,36848,45288,46120,36768,36840,43632,44464,36752,36832,45296,46128,36736,36824
.long 48680,49512,36720,36816,47024,47856,36704,36808,48688,49520,36688,36800,47032,47864,36672,36792
.long 36864,36864,36864,36864,37136,37136,36880,36860,37408,37408,36896,36856,37680,37680,36912,36852
.long 37952,37952,36928,36848,38224,38224,36944,36844,38496,38496,36960,36840,38768,38768,36976,36836
.long 39040,39040,36992,36832,39312,39312,37008,36828,39584,39584,37024,36824,39856,39856,37040,36820
.long 40128,40128,37056,36816,40400,40400,37072,36812,40672,40672,37088,36808,40944,40944,37104,36804
.long 41216,41216,37120,36800,41488,41488,37136,36796,41760,41760,37152,36792,42032,42032,37168,36788
.long 42304,42304,37184,36784,42576,42576,37200,36780,42848,42848,37216,36776,38768,43120,37232,36772
.long 39040,43392,37248,36768,39312,43664,37264,36764,39584,43936,37280,36760,39856,44208,37296,36756
.long 40128,44480,37312,36752,40400,44752,37328,36748,40672,45024,37344,36744,40944,45296,37360,36740
.long 36880,36880,36872,36736,37152,37152,36888,36732,37424,37424,36904,36728,37696,37696,36920,36724
.long 37968,37968,36936,36720,38240,38240,36952,36716,38512,38512,36968,36712,38784,38784,36984,36708
.long 39056,39056,37000,36704,39328,39328,37016,36700,39600,39600,37032,36696,39872,39872,37048,36692
.long 40144,40144,37064,36688,40416,40416,37080,36684,40688,40688,37096,36680,40960,40960,37112,36676
.long 41232,41232,37128,36672,41504,41504,37144,36668,41776,41776,37160,36664,42048,42048,37176,36660
.long 42320,42320,37192,36656,42592,42592,37208,36652,42864,42864,37224,36648,38784,43136,37240,36644
.long 39056,43408,37256,36640,39328,43680,37272,36636,39600,43952,37288,36632,39872,44224,37304,36628
.long 40144,44496,37320,36624,40416,44768,37336,36620,40688,45040,37352,36616,40960,45312,37368,36612
.long 36864,36864,36864,37896,36862,36872,39696,37904,36860,36880,36896,36864,36858,36888,39728,36864
.long 36856,36896,36928,36864,36854,36904,39760,36864,36852,36912,36960,36864,36850,36920,39792,36864
.long 36848,36928,36992,36864,36846,36936,39824,36864,36844,36944,37024,36864,36842,36952,39856,36864
.long 36840,36960,37056,36864,36838,36968,39888,36864,36836,36976,37088,36864,36834,36984,39920,36864
.long 36832,36992,37120,36864,36830,37000,39952,36864,36828,37008,37152,36864,36826,37016,39984,36864
.long 36824,37024,37184,36864,36822,37032,40016,36864,36820,37040,37216,36864,36818,37048,40048,36864
.long 36816,37056,37248,37912,36814,37064,40080,37920,36812,37072,37280,36864,36810,37080,40112,36864
.long 36808,37088,37312,36864,36806,37096,40144,36864,36804,37104,37344,36864,36802,37112,40176,36864
.long 36736,37120,37376,36864,36734,37128,40208,36864,36732,37136,37408,36864,36730,37144,40240,36864
.long 36728,37152,37440,36864,36726,37160,40272,36864,36724,37168,37472,36864,36722,37176,40304,36864
.long 36720,37184,37504,36864,36718,37192,40336,36864,36716,37200,37536,36864,36714,37208,40368,36864
.long 36712,37216,37568,36864,36710,37224,40400,36864,36708,37232,37600,36864,36706,37240,40432,36864
.long 36704,37248,37632,36864,36702,37256,40464,36864,36700,37264,37664,36864,36698,37272,40496,36864
.long 36696,37280,37696,36864,36694,37288,40528,36864,36692,37296,37728,36864,36690,37304,40560,36864
.long 36688,37312,37760,36864,36686,37320,40592,36864,36684,37328,37792,36864,36682,37336,40624,36864
.long 36680,37344,37824,36864,36678,37352,40656,36864,36676,37360,37856,36864,36674,37368,40688,36864
.long 39040,36864,0,0,41872,37696,0,0,39072,38528,0,0,41904,39360,0,0
.long 39104,40192,0,0,41936,41024,0,0,39136,41856,0,0,41968,42688,0,0
.long 39168,43520,0,0,42000,44352,0,0,39200,45184,0,0,42032,46016,0,0
.long 39232,46912,0,0,42064,47744,0,0,39264,48576,0,0,42096,49408,0,0
.long 39296,50240,0,0,42128,51280,0,0,39328,51296,0,0,42160,39360,0,0
.long 39360,40192,0,0,42192,41024,0,0,39392,41856,0,0,42224,42688,0,0
.long 39424,43520,0,0,42256,44352,0,0,39456,45184,0,0,42288,46016,0,0
.long 39488,46912,0,0,42320,47744,0,0,39520,48576,0,0,42352,49408,0,0
.long 39552,36864,0,0,42384,37696,0,0,39584,38528,0,0,42416,39360,0,0
.long 39616,40192,0,0,42448,41024,0,0,39648,41856,0,0,42480,42688,0,0
.long 36864,43520,0,0,36864,44352,0,0,36864,45184,0,0,36864,46016,0,0
.long 36864,46912,0,0,36864,47744,0,0,36864,48576,0,0,36864,49408,0,0
.long 36864,36864,0,0,36864,37696,0,0,36864,38528,0,0,36864,39360,0,0
.long 36864,40192,0,0,36864,41024,0,0,36864,41856,0,0,36864,42688,0,0
.long 36864,43520,0,0,36864,44352,0,0,36864,45184,0,0,36864,46016,0,0
.long 36864,46912,0,0,36864,47744,0,0,36864,48576,0,0,36864,49408,0,0
.long 0,0x3f803f80,0x3f803f80,16256,0,0x3f800000,0x3f803f80,0x3f803f80,0,0,0x3f803f80,0x3f803f80,0,0,0x3f800000,0x3f803f80
.long 0,0,0,0x3f803f80,0,0,0,0x3f800000,0,0,0,0,0,0,0,0
.long 0,0,0,0,0,0,0,0,0,0,0,0,0,0,0,0
.long 0,0,0,0,0,0,0,0,0,0,0,0,0,0,0,0
.long 0,0,0,0,0,0,0,0,16256,0,0,0,0x3f803f80,0,0,0
.long 0x3f803f80,16256,0,0,0x3f803f80,0x3f803f80,0,0,0x3f803f80,0x3f803f80,16256,0,0x3f800000,0x3f803f80,0x3f803f80,0
.long 0,0x3f803f80,0x3f803f80,16256,0,0x3f800000,0x3f803f80,0x3f803f80,0,0,0x3f803f80,0x3f803f80,0,0,0x3f800000,0x3f803f80
.long 0,0,0,0x3f803f80,0,0,0,0x3f800000,0,0,0,0,0,0,0,0
.long 0,0,0,0,0,0,0,0,0,0,0,0,0,0,0,0
.long 0,0,0,0,0,0,0,0,0,0,0,0,0,0,0,0
.long 0,0,0,0,0,0,0,0,16256,0,0,0,0x3f803f80,0,0,0
.long 0x3f803f80,16256,0,0,0x3f803f80,0x3f803f80,0,0,0x3f803f80,0x3f803f80,16256,0,0x3f800000,0x3f803f80,0x3f803f80,0
.long 0,0,0,0,0,0,0,0,0,0,0,0,0,0,0,0
.long 0,0,0,0,0,0,0,0,0,0,0,0,0,0,0,0
.long 0,0,0,0,0,0,0,0,0,0,0,0,0,0,0,0
.long 0,0,0,0,0,0,0,0,0,0,0,0,0,0,0,0
.long 0,0x3f800000,0x3f803f80,0,0,0,0x3f803f80,16256,0,0,0x3f800000,0x3f803f80,0,0,0,0x3f803f80
.long 0,0,0,0x3f800000,0,0,0,0,0,0,0,0,0,0,0,0
.long 0,0,0,0,0,0,0,0,0,0,0,0,0,0,0,0
.long 0,0,0,0,0,0,0,0,0,0,0,0,0,0,0,0
.long 0,0,0,0,0,0,0,0,0,0,0,0,16256,0,0,0
.long 0x3f803f80,0,0,0,0x3f803f80,16256,0,0,0x3f800000,0x3f803f80,0,0,0,0x3f803f80,16256,0
.long 0,0x3f800000,0x3f803f80,0,0,0,0x3f803f80,16256,0,0,0x3f800000,0x3f803f80,0,0,0,0x3f803f80
.long 0,0,0,0x3f800000,0,0,0,0,0,0,0,0,0,0,0,0
.long 0,0,0,0,0,0,0,0,0,0,0,0,0,0,0,0
.long 0,0,0,0,0,0,0,0,0,0,0,0,0,0,0,0
.long 0,0,0,0,0,0,0,0,0,0,0,0,16256,0,0,0
.long 0x3f803f80,0,0,0,0x3f803f80,16256,0,0,0x3f800000,0x3f803f80,0,0,0,0x3f803f80,16256,0
.long 0,0,0,0,0,0,0,0,0,0,0,0,0,0,0,0
.long 0,0,0,0,0,0,0,0,0,0,0,0,0,0,0,0
.long 0,0,0,0,0,0,0,0,0,0,0,0,0,0,0,0
.long 0,0,0,0,0,0,0,0,0,0,0,0,0,0,0,0
.long 0x3f803f80,0x3f803f80,0x3f803f80,0x3f803f80,0x3f800000,0x3f803f80,0x3f803f80,0x3f803f80,0,0x3f803f80,0x3f803f80,0x3f803f80,0,0x3f800000,0x3f803f80,0x3f803f80
.long 0,0,0x3f803f80,0x3f803f80,0,0,0x3f800000,0x3f803f80,0,0,0,0x3f803f80,0,0,0,0x3f800000
.long 0,0,0,0,0,0,0,0,0,0,0,0,0,0,0,0
.long 0,0,0,0,0,0,0,0,0,0,0,0,0,0,0,0
.long 16256,0,0,0,0x3f803f80,0,0,0,0x3f803f80,16256,0,0,0x3f803f80,0x3f803f80,0,0
.long 0x3f803f80,0x3f803f80,16256,0,0x3f803f80,0x3f803f80,0x3f803f80,0,0x3f803f80,0x3f803f80,0x3f803f80,16256,0x3f803f80,0x3f803f80,0x3f803f80,0x3f803f80
.long 0x3f803f80,0x3f803f80,0x3f803f80,0x3f803f80,0x3f800000,0x3f803f80,0x3f803f80,0x3f803f80,0,0x3f803f80,0x3f803f80,0x3f803f80,0,0x3f800000,0x3f803f80,0x3f803f80
.long 0,0,0x3f803f80,0x3f803f80,0,0,0x3f800000,0x3f803f80,0,0,0,0x3f803f80,0,0,0,0x3f800000
.long 0,0,0,0,0,0,0,0,0,0,0,0,0,0,0,0
.long 0,0,0,0,0,0,0,0,0,0,0,0,0,0,0,0
.long 16256,0,0,0,0x3f803f80,0,0,0,0x3f803f80,16256,0,0,0x3f803f80,0x3f803f80,0,0
.long 0x3f803f80,0x3f803f80,16256,0,0x3f803f80,0x3f803f80,0x3f803f80,0,0x3f803f80,0x3f803f80,0x3f803f80,16256,0x3f803f80,0x3f803f80,0x3f803f80,0x3f803f80
.long 0,0,0,0,0,0,0,0,0,0,0,0,0,0,0,0
.long 0,0,0,0,0,0,0,0,0,0,0,0,0,0,0,0
.long 0,0,0,0,0,0,0,0,0,0,0,0,0,0,0,0
.long 0,0,0,0,0,0,0,0,0,0,0,0,0,0,0,0
.long 0x3f800000,0x3f803f80,0x3f803f80,0x3f803f80,0,0x3f803f80,0x3f803f80,0x3f803f80,0,0x3f800000,0x3f803f80,0x3f803f80,0,0,0x3f803f80,0x3f803f80
.long 0,0,0x3f800000,0x3f803f80,0,0,0,0x3f803f80,0,0,0,0x3f800000,0,0,0,0
.long 0,0,0,0,0,0,0,0,0,0,0,0,0,0,0,0
.long 0,0,0,0,0,0,0,0,0,0,0,0,0,0,0,0
.long 0,0,0,0,16256,0,0,0,0x3f803f80,0,0,0,0x3f803f80,16256,0,0
.long 0x3f803f80,0x3f803f80,0,0,0x3f803f80,0x3f803f80,16256,0,0x3f803f80,0x3f803f80,0x3f803f80,0,0x3f803f80,0x3f803f80,0x3f803f80,16256
.long 0x3f800000,0x3f803f80,0x3f803f80,0x3f803f80,0,0x3f803f80,0x3f803f80,0x3f803f80,0,0x3f800000,0x3f803f80,0x3f803f80,0,0,0x3f803f80,0x3f803f80
.long 0,0,0x3f800000,0x3f803f80,0,0,0,0x3f803f80,0,0,0,0x3f800000,0,0,0,0
.long 0,0,0,0,0,0,0,0,0,0,0,0,0,0,0,0
.long 0,0,0,0,0,0,0,0,0,0,0,0,0,0,0,0
.long 0,0,0,0,16256,0,0,0,0x3f803f80,0,0,0,0x3f803f80,16256,0,0
.long 0x3f803f80,0x3f803f80,0,0,0x3f803f80,0x3f803f80,16256,0,0x3f803f80,0x3f803f80,0x3f803f80,0,0x3f803f80,0x3f803f80,0x3f803f80,16256
.long 0,0,0,0,0,0,0,0,0,0,0,0,0,0,0,0
.long 0,0,0,0,0,0,0,0,0,0,0,0,0,0,0,0
.long 0,0,0,0,0,0,0,0,0,0,0,0,0,0,0,0
.long 0,0,0,0,0,0,0,0,0,0,0,0,0,0,0,0
L_code_end:
.section .rodata,"a"
.p2align 6
.amdhsa_kernel sequential_preLN__ssm_conv_s4__geglu_ffn__prompt_kernel
  .amdhsa_next_free_vgpr 512
  .amdhsa_next_free_sgpr 102
  .amdhsa_accum_offset 256
  .amdhsa_group_segment_fixed_size 0
  .amdhsa_kernarg_size 128
  .amdhsa_user_sgpr_count 2
  .amdhsa_user_sgpr_kernarg_segment_ptr 1
  .amdhsa_system_sgpr_workgroup_id_x 1
.end_amdhsa_kernel
```
